```python
import torch

def _softmax(x, axis=-1):
    return torch.softmax(x, dim=axis)
def _gelu(x):
    return torch.nn.functional.gelu(x, approximate="tanh")
def _silu(x):
    return torch.nn.functional.silu(x)
def _sigmoid(x):
    return torch.sigmoid(x)
def _layernorm(x, axis=-1, eps=1e-5):
    m = x.mean(dim=axis, keepdim=True)
    v = x.var(dim=axis, keepdim=True, unbiased=False)
    return (x - m) / torch.sqrt(v + eps)
def _scatter_add(tgt, idx, src, axis=0):
    return tgt.clone().index_add_(axis, idx, src)
def _segment_sum(src, seg, n):
    out = torch.zeros((n,) + src.shape[1:], dtype=src.dtype)
    return out.index_add_(0, seg, src)
def _pad(x, pw):
    flat = tuple(v for pair in reversed(pw) for v in pair)
    return torch.nn.functional.pad(x, flat)

kernel_name = 'gated_mix__linear_attn_block__dense_activation_mish__prompt'

def setup_inputs():

    _w = (lambda a: (lambda t: t.to(torch.bfloat16) if t.is_floating_point() else t)(torch.as_tensor(a)))
    def _A_setup():
        B, S, D = 1, 2048, 512
        return {
            "x": _w((lambda *s: torch.randn(*s, dtype=torch.bfloat16) * 0.05)(B, S, D)),
            "wqkv": _w((lambda *s: torch.randn(*s, dtype=torch.bfloat16) * 0.8)(D, 3 * D)),
            "wo": _w((lambda *s: torch.randn(*s, dtype=torch.bfloat16) * 0.1)(D, D)),
        }
    _A_in = _A_setup()

    def _B_setup():
        B, S, D, F = 1, 2048, 512, 1792
        return {
            "x": _w((lambda *s: torch.randn(*s, dtype=torch.bfloat16) * 0.05)(B, S, D)),
            "w1": _w((lambda *s: torch.randn(*s, dtype=torch.bfloat16) * 12.8)(D, F) * (D ** -0.5)),
            "b1": _w((lambda *s: torch.randn(*s, dtype=torch.bfloat16) * 0.4)(F)),
            "w2": _w((lambda *s: torch.randn(*s, dtype=torch.bfloat16) * 0.05)(F, D) * (F ** -0.5)),
        }
    _B_in = _B_setup()

    return {
        "A_x": _A_in["x"],
        "A_wqkv": _A_in["wqkv"],
        "A_wo": _A_in["wo"],
        "B_x": _B_in["x"],
        "B_w1": _B_in["w1"],
        "B_b1": _B_in["b1"],
        "B_w2": _B_in["w2"],
        "gate_w": _w((lambda *s: torch.randn(*s, dtype=torch.bfloat16) * 0.05)(512) * 16.0),
    }

def reference(A_x, A_wqkv, A_wo, B_x, B_w1, B_b1, B_w2, gate_w):
    def _A_ref(x, wqkv, wo):
        B, S, D = x.shape
        H = 32; Dh = D // H
        qkv = (lambda x, *d: x.permute(*d))((x @ wqkv).reshape(B, S, 3, H, Dh), 2, 0, 3, 1, 4)
        q, k, v = qkv[0], qkv[1], qkv[2]
        phi = lambda t: torch.where(t > 0, t + 1, torch.exp(t)) + 1e-6
        pq, pk = phi(q), phi(k)
        kv = torch.einsum("bhsd,bhse->bhde", pk, v)
        z = torch.einsum("bhsd->bhd", pk)
        num = torch.einsum("bhqd,bhde->bhqe", pq, kv)
        den = torch.einsum("bhqd,bhd->bhq", pq, z)[..., None] + 1e-6
        o = num / den
        return (lambda x, *d: x.permute(*d))(o, 0, 2, 1, 3).reshape(B, S, D) @ wo

    def _B_ref(x, w1, b1, w2):
        h = torch.einsum("bsd,df->bsf", x, w1) + b1
        sp = torch.log1p(torch.exp(-torch.abs(h))) + torch.where(h > 0, h, torch.zeros_like(h))
        act = h * torch.tanh(sp)
        return torch.einsum("bsf,fd->bsd", act, w2)

    x = A_x
    g = _sigmoid((x * gate_w).sum(-1, keepdims=True))
    a = _A_ref(x, A_wqkv, A_wo)
    b = _B_ref(x, B_w1, B_b1, B_w2)
    return g * a + (1 - g) * b
```

```asm
; @launch grid=(256,1,1) block=(512,1,1) lds=163840
.amdgcn_target "amdgcn-amd-amdhsa--gfx950"
.text
.globl gated_mix__linear_attn_block__dense_activation_mish__prompt_kernel
.p2align 8
.type gated_mix__linear_attn_block__dense_activation_mish__prompt_kernel,@function
gated_mix__linear_attn_block__dense_activation_mish__prompt_kernel:
    s_cmp_ge_u32 s2, 256
    s_cbranch_scc1 L_end
    s_load_dwordx4 s[92:95], s[0:1], 0
    s_load_dwordx4 s[96:99], s[0:1], 32
    s_load_dwordx4 s[4:7], s[0:1], 48
    s_load_dwordx2 s[36:37], s[0:1], 72
    s_load_dwordx2 s[20:21], s[0:1], 16
    s_load_dwordx2 s[28:29], s[0:1], 64
    s_load_dwordx2 s[24:25], s[0:1], 80
    s_memrealtime s[86:87]
    v_lshrrev_b32 v3, 6, v0
    v_and_b32 v1, 63, v0
    v_readfirstlane_b32 s40, v3
    s_getpc_b64 s[88:89]
L_pct:
    s_lshr_b32 s61, s2, 3
    s_mov_b32 s91, 0x20000
    s_mul_i32 s61, s61, 1536
    s_mov_b32 s90, L_end-L_pct
    s_and_b32 s89, s89, 0xffff
    s_cmp_eq_u32 s40, 1
    s_cmov_b32 s61, L_Aq-L_pct
    s_cmp_eq_u32 s40, 2
    s_cmov_b32 s61, L_Ah-L_pct
    s_cmp_eq_u32 s40, 3
    s_cmovk_i32 s61, 128
    v_min_u32 v27, 11, v1
    v_lshl_add_u32 v27, v27, 7, s61
    buffer_load_dword v201, v27, s[88:91], 0 offen
    s_and_b32 s60, s2, 7
    s_lshr_b32 s61, s2, 3
    s_lshr_b32 s45, s60, 2
    s_and_b32 s63, s60, 1
    s_and_b32 s62, s61, 7
    s_lshl3_add_u32 s42, s63, s62
    s_lshr_b32 s46, s61, 2
    s_lshr_b32 s44, s61, 4
    s_bfe_u32 s43, s61, 0x10003
    s_and_b32 s62, s60, 6
    s_add_u32 s43, s43, s62
    s_lshr_b32 s3, s60, 1
    s_mul_i32 s3, s3, 2
    s_mul_i32 s60, s63, 6
    s_add_u32 s3, s3, s60
    s_and_b32 s3, s3, 7
    s_xor_b32 s40, s40, 4
    s_and_b32 s41, s40, 3
    v_lshlrev_b32 v2, 4, v1
    s_mov_b32 s15, 0x20000
    s_mov_b32 s35, 0x20000
    s_mov_b32 s10, 0x200000
    s_mov_b32 s11, 0x20000
    s_mov_b32 s65, 0
    s_lshl_b32 s60, s40, 2
    s_add_u32 s60, s60, 147456
    v_mov_b32 v11, s60
    v_mov_b32 v12, 0
    s_lshl3_add_u32 s60, s44, s40
    s_cmp_lt_u32 s60, 4
    s_cbranch_scc1 L_Aq
    s_cmp_lt_u32 s40, 4
    s_cbranch_scc1 L_Ah
    s_mul_i32 s75, s43, 448
    s_and_b32 s63, s43, 1
    s_lshl_b32 s72, s63, 6
    s_add_u32 s72, s72, s75
    s_add_u32 s73, s72, 256
    s_lshl_b32 s60, s43, 7
    s_add_u32 s61, s60, 1024
    s_cmp_eq_u32 s44, 1
    s_cselect_b32 s72, s72, s61
    s_cselect_b32 s73, s60, s73
    s_movk_i32 s80, 1024
    s_movk_i32 s78, 3072
    s_cmovk_i32 s80, 128
    s_cmovk_i32 s78, 3584
    v_lshrrev_b32 v3, 3, v1
    v_and_b32 v4, 7, v1
    v_lshrrev_b32 v5, 4, v1
    s_lshl_b32 s79, s78, 6
    s_lshl_b32 s81, s78, 3
    s_lshl_b32 s14, s78, 9
    v_xor_b32 v6, v4, v5
    v_lshlrev_b32 v6, 4, v6
    v_lshl_add_u32 v16, v3, 10, v6
    v_xor_b32 v17, 0x2040, v16
    s_lshl_b32 s51, s42, 17
    s_lshl_b32 s60, s45, 1
    s_xor_b32 s60, s60, 2
    s_xor_b32 s60, s60, s41
    s_lshl_b32 s60, s60, 15
    s_add_u32 s51, s51, s60
    v_and_b32 v6, 1, v5
    v_lshlrev_b32 v6, 2, v6
    v_xor_b32 v6, v4, v6
    v_lshlrev_b32 v6, 4, v6
    v_mad_u32_u24 v18, s78, v3, v6
    s_add_u32 s82, s81, s80
    s_mul_i32 s60, s41, s81
    s_lshl_b32 s60, s60, 1
    s_add_u32 s72, s72, s60
    s_lshl_b32 s52, s41, 12
    s_lshl_b32 s53, s41, 11
    s_mov_b32 s49, s3
    s_lshl_b32 s59, s49, 7
    s_add_u32 s50, s51, s59
    s_mul_i32 s59, s49, s79
    s_add_u32 s84, s72, s59
    s_mov_b32 s34, 3584
    s_cmp_eq_u32 s44, 1
    s_waitcnt lgkmcnt(0)
    s_mov_b32 s8, s92
    s_mov_b32 s9, s93
    s_cselect_b32 s12, s96, s94
    s_cselect_b32 s13, s97, s95
    s_add_u32 m0, s52, 36864
    s_nop 0
    buffer_load_dwordx4 v16, s[8:11], s50 offen lds
    s_add_u32 m0, s53, 53248
    s_nop 0
    buffer_load_dwordx4 v18, s[12:15], s84 offen lds
    s_add_u32 m0, s53, 61440
    s_add_u32 s59, s84, s80
    buffer_load_dwordx4 v18, s[12:15], s59 offen lds
    s_add_u32 m0, s52, 38912
    s_add_u32 s59, s50, 16384
    buffer_load_dwordx4 v16, s[8:11], s59 offen lds
    s_add_u32 m0, s52, 37888
    s_nop 0
    buffer_load_dwordx4 v17, s[8:11], s50 offen lds
    s_add_u32 m0, s53, 54272
    s_add_u32 s59, s84, s81
    buffer_load_dwordx4 v18, s[12:15], s59 offen lds
    s_add_u32 m0, s53, 62464
    s_add_u32 s59, s84, s82
    buffer_load_dwordx4 v18, s[12:15], s59 offen lds
    s_cmp_lg_u32 s41, 3
    s_cbranch_scc1 L_nom
    s_mov_b32 m0, 148480
    s_mov_b32 s32, s98
    s_mov_b32 s33, s99
    buffer_load_dwordx4 v2, s[32:35], s75 offen lds
L_nom:
    s_add_u32 m0, s52, 39936
    s_add_u32 s59, s50, 16384
    buffer_load_dwordx4 v17, s[8:11], s59 offen lds
    s_add_u32 s49, s49, 1
    s_and_b32 s49, s49, 7
    s_lshl_b32 s59, s49, 7
    s_add_u32 s50, s51, s59
    s_mul_i32 s59, s49, s79
    s_add_u32 s84, s72, s59
    s_add_u32 m0, s52, 73728
    s_nop 0
    buffer_load_dwordx4 v16, s[8:11], s50 offen lds
    s_add_u32 m0, s53, 90112
    s_nop 0
    buffer_load_dwordx4 v18, s[12:15], s84 offen lds
    s_add_u32 m0, s53, 98304
    s_add_u32 s59, s84, s80
    buffer_load_dwordx4 v18, s[12:15], s59 offen lds
    s_add_u32 m0, s52, 75776
    s_add_u32 s59, s50, 16384
    buffer_load_dwordx4 v16, s[8:11], s59 offen lds
    v_bfe_u32 v14, v1, 1, 3
    v_lshrrev_b32 v15, 5, v1
    v_xor_b32 v14, v14, v15
    v_lshlrev_b32 v14, 4, v14
    v_and_b32 v15, 31, v1
    v_lshl_add_u32 v14, v15, 7, v14
    s_lshl_b32 s60, s41, 12
    s_add_u32 s60, s60, 36864
    v_add_u32 v21, s60, v14
    v_xor_b32 v22, 32, v21
    v_xor_b32 v23, 64, v21
    v_xor_b32 v24, 96, v21
    s_setprio 2
    s_cmp_eq_u32 s44, 0
    s_cbranch_scc1 L_Bq
    s_mov_b32 s88, s94
    s_mov_b32 s89, s95
    s_mov_b32 s90, 0x180000
    s_mov_b32 s91, 0x20000
    s_add_u32 m0, s52, 74752
    s_nop 0
    buffer_load_dwordx4 v17, s[8:11], s50 offen lds
    s_add_u32 m0, s53, 91136
    s_add_u32 s59, s84, 28672
    buffer_load_dwordx4 v18, s[12:15], s59 offen lds
    s_waitcnt vmcnt(6)
    s_waitcnt lgkmcnt(0)
    s_barrier
    ds_read_b128 v[128:131], v21
    ds_read_b128 v[132:135], v22
    ds_read_b128 v[136:139], v23
    ds_read_b128 v[140:143], v24
    s_add_u32 m0, s53, 99328
    s_add_u32 s59, s84, 28800
    buffer_load_dwordx4 v18, s[12:15], s59 offen lds
    s_add_u32 m0, s52, 76800
    s_add_u32 s59, s50, 16384
    buffer_load_dwordx4 v17, s[8:11], s59 offen lds
    s_add_u32 s49, s49, 1
    s_and_b32 s49, s49, 7
    s_lshl_b32 s59, s49, 7
    s_add_u32 s50, s51, s59
    s_mul_i32 s59, s49, 229376
    s_add_u32 s84, s72, s59
    s_add_u32 m0, s52, 110592
    s_nop 0
    buffer_load_dwordx4 v16, s[8:11], s50 offen lds
    v_add_u32 v21, 0x9000, v21
    s_add_u32 m0, s53, 126976
    s_nop 0
    buffer_load_dwordx4 v18, s[12:15], s84 offen lds
    v_add_u32 v22, 0x9000, v22
    s_add_u32 m0, s53, 135168
    s_add_u32 s59, s84, 128
    buffer_load_dwordx4 v18, s[12:15], s59 offen lds
    v_add_u32 v23, 0x9000, v23
    s_add_u32 m0, s52, 112640
    s_add_u32 s59, s50, 16384
    buffer_load_dwordx4 v16, s[8:11], s59 offen lds
    v_add_u32 v24, 0x9000, v24
    s_add_u32 m0, s52, 111616
    s_nop 0
    buffer_load_dwordx4 v17, s[8:11], s50 offen lds
    s_add_u32 m0, s53, 128000
    s_add_u32 s59, s84, 28672
    buffer_load_dwordx4 v18, s[12:15], s59 offen lds
    s_add_u32 m0, s53, 136192
    s_add_u32 s59, s84, 28800
    buffer_load_dwordx4 v18, s[12:15], s59 offen lds
    s_mov_b32 s38, 0x100
    s_mov_b32 s39, 0x20000
    s_lshl_b32 s54, s41, 10
    v_mul_u32_u24 v7, 3072, v3
    v_add_u32 v30, v6, v7
    s_mul_i32 s60, s41, 49152
    s_mov_b32 s16, s6
    s_mov_b32 s17, s7
    s_mov_b32 s18, 0x400
    s_mov_b32 s19, 0x20000
    s_mov_b32 m0, 149504
    s_lshl_b32 s61, s3, 7
    v_add_u32 v14, s61, v2
    v_and_b32 v14, 0x3ff, v14
    buffer_load_dwordx4 v14, s[16:19], 0 offen lds
    s_add_u32 s73, s73, s60
    s_mov_b32 s16, s4
    s_mov_b32 s17, s5
    s_mov_b32 s18, 0x1c0000
    s_mov_b32 s19, 0x20000
    s_mov_b32 s22, 0x80000
    s_mov_b32 s23, 0x20000
    s_mov_b32 s26, 0x1100000
    s_mov_b32 s27, 0x20000
    s_mov_b32 s30, 0x200000
    s_mov_b32 s31, 0x20000
    s_mov_b32 s38, 0x100
    s_mov_b32 s39, 0x20000
    ds_write_b32 v11, v12
    s_mov_b32 s66, 0x3fb8aa3b
    s_mov_b32 s67, 0x358637bd
    s_mov_b32 s68, 0.5
    s_waitcnt vmcnt(8)
    s_waitcnt lgkmcnt(0)
    s_barrier
    ds_read_b128 v[144:147], v21
    ds_read_b128 v[148:151], v22
    ds_read_b128 v[152:155], v23
    ds_read_b128 v[156:159], v24
    s_add_u32 m0, s52, 113664
    s_add_u32 s59, s50, 16384
    buffer_load_dwordx4 v17, s[8:11], s59 offen lds
    s_add_u32 s49, s49, 1
    s_and_b32 s49, s49, 7
    s_lshl_b32 s59, s49, 7
    s_add_u32 s50, s51, s59
    s_mul_i32 s59, s49, 229376
    s_add_u32 s84, s72, s59
    s_add_u32 m0, s52, 0
    s_nop 0
    buffer_load_dwordx4 v16, s[8:11], s50 offen lds
    s_add_u32 m0, s53, 16384
    s_nop 0
    buffer_load_dwordx4 v18, s[12:15], s84 offen lds
    v_add_u32 v21, 0x9000, v21
    s_add_u32 m0, s53, 24576
    s_add_u32 s59, s84, 128
    buffer_load_dwordx4 v18, s[12:15], s59 offen lds
    v_add_u32 v22, 0x9000, v22
    s_add_u32 m0, s52, 2048
    s_add_u32 s59, s50, 16384
    buffer_load_dwordx4 v16, s[8:11], s59 offen lds
    v_add_u32 v23, 0x9000, v23
    s_add_u32 m0, s52, 1024
    s_nop 0
    buffer_load_dwordx4 v17, s[8:11], s50 offen lds
    v_add_u32 v24, 0x9000, v24
    s_add_u32 m0, s53, 17408
    s_add_u32 s59, s84, 28672
    buffer_load_dwordx4 v18, s[12:15], s59 offen lds
    s_add_u32 m0, s53, 25600
    s_add_u32 s59, s84, 28800
    buffer_load_dwordx4 v18, s[12:15], s59 offen lds
    s_mov_b32 s70, 0x3fb8aa3b
    s_mov_b32 s69, 0.5
    s_mov_b32 s71, 0x3fb8aa3b
    s_mov_b32 s4, 0x7060500
    s_mov_b32 s5, 0x7060501
    s_mov_b32 s6, 0x7060502
    s_mov_b32 s7, 0x7060503
    s_and_b32 s47, s2, 1
    s_bfe_u32 s60, s2, 0x10001
    s_lshl1_add_u32 s47, s47, s60
    s_bfe_u32 s60, s2, 0x20003
    s_lshl2_add_u32 s47, s47, s60
    s_lshl1_add_u32 s47, s47, s45
    s_and_b32 s48, s43, 3
    v_and_b32 v14, 7, v1
    v_lshlrev_b32 v10, 2, v14
    v_add_u32 v10, 147456, v10
    v_bfe_u32 v15, v1, 4, 1
    v_lshlrev_b32 v15, 2, v15
    v_xor_b32 v14, v14, v15
    v_lshlrev_b32 v14, 4, v14
    v_lshrrev_b32 v15, 3, v1
    v_lshl_add_u32 v20, v15, 10, v14
    s_lshl_b32 s60, s45, 2
    s_add_u32 s60, s60, s41
    s_lshl_b32 s61, s46, 7
    s_mul_i32 s57, s60, 229376
    s_add_u32 s57, s57, s61
    s_lshl_b32 s58, s60, 16
    s_waitcnt vmcnt(7)
    s_waitcnt lgkmcnt(0)
    s_barrier
    ds_read_b128 v[160:163], v21
    ds_read_b128 v[164:167], v22
    ds_read_b128 v[168:171], v23
    ds_read_b128 v[172:175], v24
    s_add_u32 m0, s52, 3072
    s_add_u32 s59, s50, 16384
    buffer_load_dwordx4 v17, s[8:11], s59 offen lds
    s_add_u32 s49, s49, 1
    s_and_b32 s49, s49, 7
    s_lshl_b32 s59, s49, 7
    s_add_u32 s50, s51, s59
    s_mul_i32 s59, s49, 229376
    s_add_u32 s84, s72, s59
    s_add_u32 m0, s52, 36864
    s_nop 0
    buffer_load_dwordx4 v16, s[8:11], s50 offen lds
    s_add_u32 m0, s53, 53248
    s_nop 0
    buffer_load_dwordx4 v18, s[12:15], s84 offen lds
    v_add_u32 v21, 0xfffe5000, v21
    s_add_u32 m0, s53, 61440
    s_add_u32 s59, s84, 128
    buffer_load_dwordx4 v18, s[12:15], s59 offen lds
    v_add_u32 v22, 0xfffe5000, v22
    s_add_u32 m0, s52, 38912
    s_add_u32 s59, s50, 16384
    buffer_load_dwordx4 v16, s[8:11], s59 offen lds
    v_add_u32 v23, 0xfffe5000, v23
    s_add_u32 m0, s52, 37888
    s_nop 0
    buffer_load_dwordx4 v17, s[8:11], s50 offen lds
    v_add_u32 v24, 0xfffe5000, v24
    s_add_u32 m0, s53, 54272
    s_add_u32 s59, s84, 28672
    buffer_load_dwordx4 v18, s[12:15], s59 offen lds
    s_add_u32 m0, s53, 62464
    s_add_u32 s59, s84, 28800
    buffer_load_dwordx4 v18, s[12:15], s59 offen lds
    s_add_u32 s58, s58, s61
    s_and_b32 s62, s41, 1
    s_lshl_b32 s56, s62, 15
    s_add_u32 s56, s56, s57
    s_cmp_eq_u32 s62, 0
    s_cselect_b32 s62, 196608, 0
    s_add_u32 s57, s57, s62
    s_mul_i32 s55, s41, 9216
    v_lshrrev_b32 v14, 5, v1
    v_bfe_u32 v15, v1, 2, 2
    v_lshl_add_u32 v14, v14, 2, v15
    v_lshlrev_b32 v14, 7, v14
    v_bfe_u32 v15, v1, 3, 1
    v_lshl_add_u32 v14, v15, 6, v14
    v_and_b32 v15, 1, v1
    v_lshl_add_u32 v14, v15, 5, v14
    v_and_b32 v15, 16, v1
    v_add_u32 v14, v14, v15
    v_and_b32 v15, 2, v1
    v_lshl_add_u32 v14, v15, 2, v14
    s_lshr_b32 s60, s41, 1
    s_lshl_b32 s61, s60, 6
    v_xor_b32 v14, s61, v14
    s_mul_i32 s61, s60, 18432
    v_add_u32 v4, s61, v14
    v_xor_b32 v3, 64, v4
    s_lshr_b32 s61, s40, 2
    s_lshl_b32 s61, s61, 1
    s_and_b32 s62, s41, 1
    s_waitcnt vmcnt(7)
    s_waitcnt lgkmcnt(0)
    s_barrier
    ds_read_b128 v[176:179], v21
    ds_read_b128 v[180:183], v22
    ds_read_b128 v[184:187], v23
    ds_read_b128 v[188:191], v24
    s_add_u32 m0, s52, 39936
    s_add_u32 s59, s50, 16384
    buffer_load_dwordx4 v17, s[8:11], s59 offen lds
    s_add_u32 s49, s49, 1
    s_and_b32 s49, s49, 7
    s_lshl_b32 s59, s49, 7
    s_add_u32 s50, s51, s59
    s_mul_i32 s59, s49, 229376
    s_add_u32 s84, s72, s59
    s_add_u32 m0, s52, 73728
    s_nop 0
    buffer_load_dwordx4 v16, s[8:11], s50 offen lds
    s_add_u32 m0, s53, 90112
    s_nop 0
    buffer_load_dwordx4 v18, s[12:15], s84 offen lds
    v_add_u32 v21, 0x9000, v21
    s_add_u32 m0, s53, 98304
    s_add_u32 s59, s84, 128
    buffer_load_dwordx4 v18, s[12:15], s59 offen lds
    v_add_u32 v22, 0x9000, v22
    s_add_u32 m0, s52, 75776
    s_add_u32 s59, s50, 16384
    buffer_load_dwordx4 v16, s[8:11], s59 offen lds
    v_add_u32 v23, 0x9000, v23
    s_add_u32 m0, s52, 74752
    s_nop 0
    buffer_load_dwordx4 v17, s[8:11], s50 offen lds
    v_add_u32 v24, 0x9000, v24
    s_add_u32 m0, s53, 91136
    s_add_u32 s59, s84, 28672
    buffer_load_dwordx4 v18, s[12:15], s59 offen lds
    s_add_u32 m0, s53, 99328
    s_add_u32 s59, s84, 28800
    buffer_load_dwordx4 v18, s[12:15], s59 offen lds
    s_add_u32 s61, s61, s62
    s_lshl_b32 s63, s47, 2
    s_add_u32 s61, s61, s63
    s_lshl_b32 s61, s61, 1
    s_add_u32 s61, s61, s60
    s_lshl_b32 s61, s61, 1
    s_mul_i32 s78, s61, 14336
    s_mul_i32 s79, s61, 4096
    s_add_u32 s79, s79, 0x800000
    s_mul_i32 s80, s61, 1024
    s_add_u32 s80, s80, 0xc00000
    s_mul_i32 s81, s61, 128
    s_add_u32 s81, s81, 0xa00000
    s_lshl_b32 s82, s47, 3
    s_add_u32 s82, s82, s46
    s_lshl_b32 s82, s82, 2
    s_add_u32 s82, s82, s41
    s_cmp_lt_u32 s40, 4
    s_cselect_b32 s62, 32, 0
    s_xor_b32 s82, s82, s62
    s_mul_i32 s82, s82, 4096
    s_add_u32 s82, s82, 0xd00000
    v_bfe_u32 v14, v1, 2, 1
    v_mul_u32_u24 v6, 1024, v14
    v_and_b32 v14, 1, v1
    v_lshl_add_u32 v5, v14, 7, v6
    v_lshrrev_b32 v14, 5, v1
    v_bfe_u32 v15, v1, 2, 2
    v_lshl_add_u32 v14, v14, 3, v15
    v_lshlrev_b32 v14, 7, v14
    s_waitcnt vmcnt(7)
    s_waitcnt lgkmcnt(0)
    s_barrier
    ds_read_b128 v[192:195], v21
    ds_read_b128 v[196:199], v22
    ds_read_b128 v[200:203], v23
    ds_read_b128 v[204:207], v24
    buffer_load_dword v7, off, s[36:39], 0 sc1
    s_add_u32 m0, s52, 76800
    s_add_u32 s59, s50, 16384
    buffer_load_dwordx4 v17, s[8:11], s59 offen lds
    s_add_u32 s49, s49, 1
    s_and_b32 s49, s49, 7
    s_lshl_b32 s59, s49, 7
    s_add_u32 s50, s51, s59
    s_mul_i32 s59, s49, 229376
    s_add_u32 s84, s72, s59
    s_add_u32 m0, s52, 110592
    s_nop 0
    buffer_load_dwordx4 v16, s[8:11], s50 offen lds
    v_add_u32 v21, 0x9000, v21
    s_add_u32 m0, s53, 126976
    s_nop 0
    buffer_load_dwordx4 v18, s[12:15], s84 offen lds
    v_add_u32 v22, 0x9000, v22
    s_add_u32 m0, s53, 135168
    s_add_u32 s59, s84, 128
    buffer_load_dwordx4 v18, s[12:15], s59 offen lds
    v_add_u32 v23, 0x9000, v23
    s_add_u32 m0, s52, 112640
    s_add_u32 s59, s50, 16384
    buffer_load_dwordx4 v16, s[8:11], s59 offen lds
    v_add_u32 v24, 0x9000, v24
    s_add_u32 m0, s52, 111616
    s_nop 0
    buffer_load_dwordx4 v17, s[8:11], s50 offen lds
    s_add_u32 m0, s53, 128000
    s_add_u32 s59, s84, 28672
    buffer_load_dwordx4 v18, s[12:15], s59 offen lds
    s_add_u32 m0, s53, 136192
    s_add_u32 s59, s84, 28800
    buffer_load_dwordx4 v18, s[12:15], s59 offen lds
    v_bfe_u32 v15, v1, 3, 1
    v_lshl_add_u32 v14, v15, 6, v14
    v_and_b32 v15, 16, v1
    v_lshl_add_u32 v14, v15, 1, v14
    v_and_b32 v15, 3, v1
    v_lshl_add_u32 v26, v15, 3, v14
    v_add_u32 v26, 36864, v26
    v_xor_b32 v27, 64, v26
    s_lshl1_add_u32 s61, s42, s45
    s_lshl2_add_u32 s61, s61, s41
    s_lshl_b32 s61, s61, 2
    s_add_u32 s61, s61, s48
    s_mul_i32 s76, s61, 1024
    s_add_u32 s76, s76, 0xc00000
    v_lshrrev_b32 v14, 5, v1
    v_lshlrev_b32 v14, 4, v14
    v_add_u32 v25, 149504, v14
    s_mov_b32 s92, 0x100001
    s_mov_b32 s93, 0x100001
    v_pk_mov_b32 v[40:41], 0, 0
    v_pk_mov_b32 v[42:43], 0, 0
    v_pk_mov_b32 v[52:53], 0, 0
    v_pk_mov_b32 v[54:55], 0, 0
    v_pk_mov_b32 v[64:65], 0, 0
    v_pk_mov_b32 v[66:67], 0, 0
    s_mul_i32 s77, s61, 4096
    s_add_u32 s77, s77, 0x800000
    s_mul_i32 s74, s61, 128
    s_add_u32 s74, s74, 0xa00000
    s_waitcnt vmcnt(7)
    s_waitcnt lgkmcnt(0)
    s_barrier
    ds_read_b128 v[208:211], v21
    ds_read_b128 v[212:215], v22
    ds_read_b128 v[216:219], v23
    ds_read_b128 v[220:223], v24
    s_add_u32 m0, s52, 113664
    s_add_u32 s59, s50, 16384
    buffer_load_dwordx4 v17, s[8:11], s59 offen lds
    s_add_u32 s49, s49, 1
    s_and_b32 s49, s49, 7
    s_lshl_b32 s59, s49, 7
    s_add_u32 s50, s51, s59
    s_mul_i32 s59, s49, 229376
    s_add_u32 s84, s72, s59
    s_add_u32 m0, s52, 0
    s_nop 0
    buffer_load_dwordx4 v16, s[8:11], s50 offen lds
    s_add_u32 m0, s53, 16384
    s_nop 0
    buffer_load_dwordx4 v18, s[12:15], s84 offen lds
    v_add_u32 v21, 0x9000, v21
    s_add_u32 m0, s53, 24576
    s_add_u32 s59, s84, 128
    buffer_load_dwordx4 v18, s[12:15], s59 offen lds
    v_add_u32 v22, 0x9000, v22
    s_add_u32 m0, s52, 2048
    s_add_u32 s59, s50, 16384
    buffer_load_dwordx4 v16, s[8:11], s59 offen lds
    v_add_u32 v23, 0x9000, v23
    s_add_u32 m0, s52, 1024
    s_nop 0
    buffer_load_dwordx4 v17, s[8:11], s50 offen lds
    v_add_u32 v24, 0x9000, v24
    s_add_u32 m0, s53, 17408
    s_add_u32 s59, s84, 28672
    buffer_load_dwordx4 v18, s[12:15], s59 offen lds
    s_add_u32 m0, s53, 25600
    s_add_u32 s59, s84, 28800
    buffer_load_dwordx4 v18, s[12:15], s59 offen lds
    s_waitcnt vmcnt(7)
    s_waitcnt lgkmcnt(0)
    s_barrier
    ds_read_b128 v[224:227], v21
    ds_read_b128 v[228:231], v22
    ds_read_b128 v[232:235], v23
    ds_read_b128 v[236:239], v24
    s_add_u32 m0, s52, 3072
    s_add_u32 s59, s50, 16384
    buffer_load_dwordx4 v17, s[8:11], s59 offen lds
    s_mov_b32 s49, s3
    s_mul_i32 s59, s49, 196608
    s_add_u32 s84, s73, s59
    s_add_u32 m0, s53, 36864
    s_nop 0
    buffer_load_dwordx4 v30, s[88:91], s84 offen lds
    s_add_u32 m0, s53, 37888
    s_add_u32 s59, s84, 24576
    buffer_load_dwordx4 v30, s[88:91], s59 offen lds
    v_add_u32 v21, 0xfffe5000, v21
    s_add_u32 s49, s49, 1
    s_and_b32 s49, s49, 7
    s_mul_i32 s59, s49, 196608
    s_add_u32 s84, s73, s59
    s_add_u32 m0, s53, 45056
    s_nop 0
    buffer_load_dwordx4 v30, s[88:91], s84 offen lds
    v_add_u32 v22, 0xfffe5000, v22
    s_add_u32 m0, s53, 46080
    s_add_u32 s59, s84, 24576
    buffer_load_dwordx4 v30, s[88:91], s59 offen lds
    v_add_u32 v23, 0xfffe5000, v23
    s_add_u32 s49, s49, 1
    s_and_b32 s49, s49, 7
    s_mul_i32 s59, s49, 196608
    s_add_u32 s84, s73, s59
    s_add_u32 m0, s53, 53248
    s_nop 0
    buffer_load_dwordx4 v30, s[88:91], s84 offen lds
    v_add_u32 v24, 0xfffe5000, v24
    s_add_u32 m0, s53, 54272
    s_add_u32 s59, s84, 24576
    buffer_load_dwordx4 v30, s[88:91], s59 offen lds
    s_add_u32 s49, s49, 1
    s_and_b32 s49, s49, 7
    s_mul_i32 s59, s49, 196608
    s_add_u32 s84, s73, s59
    s_add_u32 m0, s53, 61440
    s_nop 0
    buffer_load_dwordx4 v30, s[88:91], s84 offen lds
L_tagh:
    v_readfirstlane_b32 s64, v7
    s_cmp_eq_u32 s64, 0
    s_cbranch_scc1 L_tagsh
L_tagkh:
    ds_write_b32 v10, v7 offset:64
    v_readfirstlane_b32 s64, v7
    s_bfe_u32 s96, s64, 0x80000
    s_bfe_u32 s97, s64, 0x80008
    s_bfe_u32 s98, s64, 0x80010
    s_bfe_u32 s99, s64, 0x80018
    s_waitcnt vmcnt(7)
    s_waitcnt lgkmcnt(0)
    s_barrier
    ds_read_b128 v[240:243], v21
    ds_read_b128 v[244:247], v22
    ds_read_b128 v[248:251], v23
    ds_read_b128 v[252:255], v24
    s_add_u32 m0, s53, 62464
    s_add_u32 s59, s84, 24576
    buffer_load_dwordx4 v30, s[88:91], s59 offen lds
    s_add_u32 s49, s49, 1
    s_and_b32 s49, s49, 7
    s_mul_i32 s59, s49, 196608
    s_add_u32 s84, s73, s59
    s_add_u32 m0, s53, 69632
    s_nop 0
    buffer_load_dwordx4 v30, s[88:91], s84 offen lds
    s_add_u32 m0, s53, 70656
    s_add_u32 s59, s84, 24576
    buffer_load_dwordx4 v30, s[88:91], s59 offen lds
    s_add_u32 s49, s49, 1
    s_and_b32 s49, s49, 7
    s_mul_i32 s59, s49, 196608
    s_add_u32 s84, s73, s59
    s_add_u32 m0, s53, 77824
    s_nop 0
    buffer_load_dwordx4 v30, s[88:91], s84 offen lds
    s_add_u32 m0, s53, 78848
    s_add_u32 s59, s84, 24576
    buffer_load_dwordx4 v30, s[88:91], s59 offen lds
    s_add_u32 s49, s49, 1
    s_and_b32 s49, s49, 7
    s_mul_i32 s59, s49, 196608
    s_add_u32 s84, s73, s59
    s_add_u32 m0, s53, 86016
    s_nop 0
    buffer_load_dwordx4 v30, s[88:91], s84 offen lds
    s_add_u32 m0, s53, 87040
    s_add_u32 s59, s84, 24576
    buffer_load_dwordx4 v30, s[88:91], s59 offen lds
    s_add_u32 s49, s49, 1
    s_and_b32 s49, s49, 7
    s_mul_i32 s59, s49, 196608
    s_add_u32 s84, s73, s59
    s_add_u32 m0, s53, 94208
    s_nop 0
    buffer_load_dwordx4 v30, s[88:91], s84 offen lds
    s_waitcnt vmcnt(9)
    s_waitcnt lgkmcnt(0)
    s_barrier
    s_setprio 2
    ds_read_b64_tr_b16 v[32:33], v26 offset:0
    ds_read_b64_tr_b16 v[34:35], v26 offset:512
    ds_read_b64_tr_b16 v[36:37], v27 offset:0
    ds_read_b64_tr_b16 v[38:39], v27 offset:512
    s_mov_b64 exec, s[92:93]
    ds_read_b128 v[40:43], v25 offset:0
    s_mov_b64 exec, -1
    ds_read_b64_tr_b16 v[44:45], v26 offset:2048
    ds_read_b64_tr_b16 v[46:47], v26 offset:2560
    ds_read_b64_tr_b16 v[48:49], v27 offset:2048
    ds_read_b64_tr_b16 v[50:51], v27 offset:2560
    s_mov_b64 exec, s[92:93]
    ds_read_b128 v[52:55], v25 offset:32
    s_mov_b64 exec, -1
    s_waitcnt lgkmcnt(5)
    v_mfma_f32_32x32x16_bf16 v[84:99], v[32:35], v[128:131], 0
    ds_read_b64_tr_b16 v[56:57], v26 offset:4096
    ds_read_b64_tr_b16 v[58:59], v26 offset:4608
    s_add_u32 m0, s53, 95232
    s_add_u32 s59, s84, 24576
    buffer_load_dwordx4 v30, s[88:91], s59 offen lds
    v_mfma_f32_32x32x16_bf16 v[100:115], v[36:39], v[128:131], 0
    ds_read_b64_tr_b16 v[60:61], v27 offset:4096
    ds_read_b64_tr_b16 v[62:63], v27 offset:4608
    v_mfma_f32_16x16x32_bf16 v[68:71], v[40:43], v[128:131], 0
    s_mov_b64 exec, s[92:93]
    ds_read_b128 v[64:67], v25 offset:64
    s_mov_b64 exec, -1
    s_waitcnt lgkmcnt(5)
    v_mfma_f32_32x32x16_bf16 v[84:99], v[44:47], v[132:135], v[84:99]
    ds_read_b64_tr_b16 v[32:33], v26 offset:6144
    ds_read_b64_tr_b16 v[34:35], v26 offset:6656
    s_add_u32 m0, s55, 0
    s_nop 0
    buffer_load_dwordx4 v20, s[16:19], s56 offen lds
    v_mfma_f32_32x32x16_bf16 v[100:115], v[48:51], v[132:135], v[100:115]
    ds_read_b64_tr_b16 v[36:37], v27 offset:6144
    ds_read_b64_tr_b16 v[38:39], v27 offset:6656
    v_mfma_f32_16x16x32_bf16 v[68:71], v[52:55], v[132:135], v[68:71]
    s_mov_b64 exec, s[92:93]
    ds_read_b128 v[40:43], v25 offset:96
    s_mov_b64 exec, -1
    s_waitcnt lgkmcnt(5)
    v_mfma_f32_32x32x16_bf16 v[84:99], v[56:59], v[136:139], v[84:99]
    ds_read_b64_tr_b16 v[44:45], v26 offset:8192
    ds_read_b64_tr_b16 v[46:47], v26 offset:8704
    s_add_u32 m0, s55, 1024
    s_add_u32 s59, s56, 8192
    buffer_load_dwordx4 v20, s[16:19], s59 offen lds
    v_mfma_f32_32x32x16_bf16 v[100:115], v[60:63], v[136:139], v[100:115]
    ds_read_b64_tr_b16 v[48:49], v27 offset:8192
    ds_read_b64_tr_b16 v[50:51], v27 offset:8704
    v_mfma_f32_16x16x32_bf16 v[68:71], v[64:67], v[136:139], v[68:71]
    s_mov_b64 exec, s[92:93]
    ds_read_b128 v[52:55], v25 offset:128
    s_mov_b64 exec, -1
    s_waitcnt lgkmcnt(5)
    v_mfma_f32_32x32x16_bf16 v[84:99], v[32:35], v[140:143], v[84:99]
    ds_read_b64_tr_b16 v[56:57], v26 offset:10240
    ds_read_b64_tr_b16 v[58:59], v26 offset:10752
    s_add_u32 m0, s55, 2048
    s_add_u32 s59, s56, 16384
    buffer_load_dwordx4 v20, s[16:19], s59 offen lds
    v_mfma_f32_32x32x16_bf16 v[100:115], v[36:39], v[140:143], v[100:115]
    ds_read_b64_tr_b16 v[60:61], v27 offset:10240
    ds_read_b64_tr_b16 v[62:63], v27 offset:10752
    v_mfma_f32_16x16x32_bf16 v[68:71], v[40:43], v[140:143], v[68:71]
    s_mov_b64 exec, s[92:93]
    ds_read_b128 v[64:67], v25 offset:160
    s_mov_b64 exec, -1
    s_waitcnt lgkmcnt(5)
    v_mfma_f32_32x32x16_bf16 v[84:99], v[44:47], v[144:147], v[84:99]
    ds_read_b64_tr_b16 v[32:33], v26 offset:12288
    ds_read_b64_tr_b16 v[34:35], v26 offset:12800
    s_add_u32 m0, s55, 3072
    s_add_u32 s59, s56, 24576
    buffer_load_dwordx4 v20, s[16:19], s59 offen lds
    v_mfma_f32_32x32x16_bf16 v[100:115], v[48:51], v[144:147], v[100:115]
    ds_read_b64_tr_b16 v[36:37], v27 offset:12288
    ds_read_b64_tr_b16 v[38:39], v27 offset:12800
    v_mfma_f32_16x16x32_bf16 v[68:71], v[52:55], v[144:147], v[68:71]
    s_mov_b64 exec, s[92:93]
    ds_read_b128 v[40:43], v25 offset:192
    s_mov_b64 exec, -1
    s_waitcnt lgkmcnt(5)
    v_mfma_f32_32x32x16_bf16 v[84:99], v[56:59], v[148:151], v[84:99]
    ds_read_b64_tr_b16 v[44:45], v26 offset:14336
    ds_read_b64_tr_b16 v[46:47], v26 offset:14848
    s_add_u32 m0, s55, 4096
    s_add_u32 s59, s56, 32768
    buffer_load_dwordx4 v20, s[16:19], s59 offen lds
    v_mfma_f32_32x32x16_bf16 v[100:115], v[60:63], v[148:151], v[100:115]
    ds_read_b64_tr_b16 v[48:49], v27 offset:14336
    ds_read_b64_tr_b16 v[50:51], v27 offset:14848
    v_mfma_f32_16x16x32_bf16 v[68:71], v[64:67], v[148:151], v[68:71]
    s_mov_b64 exec, s[92:93]
    ds_read_b128 v[52:55], v25 offset:224
    s_mov_b64 exec, -1
    s_waitcnt lgkmcnt(5)
    v_mfma_f32_32x32x16_bf16 v[84:99], v[32:35], v[152:155], v[84:99]
    ds_read_b64_tr_b16 v[56:57], v26 offset:16384
    ds_read_b64_tr_b16 v[58:59], v26 offset:16896
    s_add_u32 m0, s55, 5120
    s_add_u32 s59, s56, 40960
    buffer_load_dwordx4 v20, s[16:19], s59 offen lds
    v_mfma_f32_32x32x16_bf16 v[100:115], v[36:39], v[152:155], v[100:115]
    ds_read_b64_tr_b16 v[60:61], v27 offset:16384
    ds_read_b64_tr_b16 v[62:63], v27 offset:16896
    v_mfma_f32_16x16x32_bf16 v[68:71], v[40:43], v[152:155], v[68:71]
    s_mov_b64 exec, s[92:93]
    ds_read_b128 v[64:67], v25 offset:256
    s_mov_b64 exec, -1
    s_waitcnt lgkmcnt(5)
    v_mfma_f32_32x32x16_bf16 v[84:99], v[44:47], v[156:159], v[84:99]
    ds_read_b64_tr_b16 v[32:33], v26 offset:18432
    ds_read_b64_tr_b16 v[34:35], v26 offset:18944
    s_add_u32 m0, s55, 6144
    s_add_u32 s59, s56, 49152
    buffer_load_dwordx4 v20, s[16:19], s59 offen lds
    v_mfma_f32_32x32x16_bf16 v[100:115], v[48:51], v[156:159], v[100:115]
    ds_read_b64_tr_b16 v[36:37], v27 offset:18432
    ds_read_b64_tr_b16 v[38:39], v27 offset:18944
    v_mfma_f32_16x16x32_bf16 v[68:71], v[52:55], v[156:159], v[68:71]
    s_mov_b64 exec, s[92:93]
    ds_read_b128 v[40:43], v25 offset:288
    s_mov_b64 exec, -1
    s_waitcnt vmcnt(7)
    v_mov_b32 v12, 1
    ds_write_b32 v11, v12
    s_waitcnt lgkmcnt(6)
    v_mfma_f32_32x32x16_bf16 v[84:99], v[56:59], v[160:163], v[84:99]
    ds_read_b64_tr_b16 v[44:45], v26 offset:20480
    ds_read_b64_tr_b16 v[46:47], v26 offset:20992
    s_add_u32 m0, s55, 7168
    s_add_u32 s59, s56, 57344
    buffer_load_dwordx4 v20, s[16:19], s59 offen lds
    v_mfma_f32_32x32x16_bf16 v[100:115], v[60:63], v[160:163], v[100:115]
    ds_read_b64_tr_b16 v[48:49], v27 offset:20480
    ds_read_b64_tr_b16 v[50:51], v27 offset:20992
    v_mfma_f32_16x16x32_bf16 v[68:71], v[64:67], v[160:163], v[68:71]
    s_mov_b64 exec, s[92:93]
    ds_read_b128 v[52:55], v25 offset:320
    s_mov_b64 exec, -1
    s_waitcnt lgkmcnt(6)
    v_mfma_f32_32x32x16_bf16 v[84:99], v[32:35], v[164:167], v[84:99]
    ds_read_b64_tr_b16 v[56:57], v26 offset:22528
    ds_read_b64_tr_b16 v[58:59], v26 offset:23040
    s_add_u32 m0, s55, 8192
    s_add_u32 s59, s56, 65536
    buffer_load_dwordx4 v20, s[16:19], s59 offen lds
    v_mfma_f32_32x32x16_bf16 v[100:115], v[36:39], v[164:167], v[100:115]
    ds_read_b64_tr_b16 v[60:61], v27 offset:22528
    ds_read_b64_tr_b16 v[62:63], v27 offset:23040
    v_mfma_f32_16x16x32_bf16 v[68:71], v[40:43], v[164:167], v[68:71]
    s_mov_b64 exec, s[92:93]
    ds_read_b128 v[64:67], v25 offset:352
    s_mov_b64 exec, -1
    ds_read_b32 v15, v10
    s_waitcnt lgkmcnt(0)
L_pc0:
    v_cmp_gt_u32 vcc, 1, v15
    s_and_b32 s60, vcc_lo, 240
    s_cbranch_scc0 L_pk0
    s_add_u32 s65, s65, 1
    s_sleep 1
    ds_read_b32 v15, v10
    s_cmp_gt_u32 s65, 1600000
    s_waitcnt lgkmcnt(0)
    s_cbranch_scc0 L_pc0
L_pk0:
    v_mfma_f32_32x32x16_bf16 v[84:99], v[44:47], v[168:171], v[84:99]
    ds_read_b64_tr_b16 v[32:33], v26 offset:24576
    ds_read_b64_tr_b16 v[34:35], v26 offset:25088
    s_add_u32 m0, s55, 110592
    s_add_u32 s59, s56, 188416
    buffer_load_dwordx4 v20, s[16:19], s59 offen lds
    v_mfma_f32_32x32x16_bf16 v[100:115], v[48:51], v[168:171], v[100:115]
    ds_read_b64_tr_b16 v[36:37], v27 offset:24576
    ds_read_b64_tr_b16 v[38:39], v27 offset:25088
    v_mfma_f32_16x16x32_bf16 v[68:71], v[52:55], v[168:171], v[68:71]
    s_mov_b64 exec, s[92:93]
    ds_read_b128 v[40:43], v25 offset:384
    s_mov_b64 exec, -1
    v_mfma_f32_32x32x16_bf16 v[84:99], v[56:59], v[172:175], v[84:99]
    ds_read_b64_tr_b16 v[44:45], v26 offset:26624
    ds_read_b64_tr_b16 v[46:47], v26 offset:27136
    s_add_u32 m0, s55, 111616
    s_nop 0
    buffer_load_dwordx4 v20, s[20:23], s58 offen lds
    v_mfma_f32_32x32x16_bf16 v[100:115], v[60:63], v[172:175], v[100:115]
    ds_read_b64_tr_b16 v[48:49], v27 offset:26624
    ds_read_b64_tr_b16 v[50:51], v27 offset:27136
    v_mfma_f32_16x16x32_bf16 v[68:71], v[64:67], v[172:175], v[68:71]
    s_mov_b64 exec, s[92:93]
    ds_read_b128 v[52:55], v25 offset:416
    s_mov_b64 exec, -1
    s_waitcnt lgkmcnt(5)
    v_mfma_f32_32x32x16_bf16 v[84:99], v[32:35], v[176:179], v[84:99]
    ds_read_b64_tr_b16 v[56:57], v26 offset:28672
    ds_read_b64_tr_b16 v[58:59], v26 offset:29184
    s_add_u32 m0, s55, 112640
    s_add_u32 s59, s58, 8192
    buffer_load_dwordx4 v20, s[20:23], s59 offen lds
    v_mfma_f32_32x32x16_bf16 v[100:115], v[36:39], v[176:179], v[100:115]
    ds_read_b64_tr_b16 v[60:61], v27 offset:28672
    ds_read_b64_tr_b16 v[62:63], v27 offset:29184
    v_mfma_f32_16x16x32_bf16 v[68:71], v[40:43], v[176:179], v[68:71]
    s_mov_b64 exec, s[92:93]
    ds_read_b128 v[64:67], v25 offset:448
    s_mov_b64 exec, -1
    s_waitcnt lgkmcnt(5)
    v_mfma_f32_32x32x16_bf16 v[84:99], v[44:47], v[180:183], v[84:99]
    ds_read_b64_tr_b16 v[32:33], v26 offset:30720
    ds_read_b64_tr_b16 v[34:35], v26 offset:31232
    s_add_u32 m0, s55, 113664
    s_add_u32 s59, s58, 16384
    buffer_load_dwordx4 v20, s[20:23], s59 offen lds
    v_mfma_f32_32x32x16_bf16 v[100:115], v[48:51], v[180:183], v[100:115]
    ds_read_b64_tr_b16 v[36:37], v27 offset:30720
    ds_read_b64_tr_b16 v[38:39], v27 offset:31232
    v_mfma_f32_16x16x32_bf16 v[68:71], v[52:55], v[180:183], v[68:71]
    s_mov_b64 exec, s[92:93]
    ds_read_b128 v[40:43], v25 offset:480
    s_mov_b64 exec, -1
    s_waitcnt lgkmcnt(5)
    v_mfma_f32_32x32x16_bf16 v[84:99], v[56:59], v[184:187], v[84:99]
    ds_read_b64_tr_b16 v[44:45], v26 offset:32768
    ds_read_b64_tr_b16 v[46:47], v26 offset:33280
    s_add_u32 m0, s55, 114688
    s_add_u32 s59, s58, 24576
    buffer_load_dwordx4 v20, s[20:23], s59 offen lds
    v_mfma_f32_32x32x16_bf16 v[100:115], v[60:63], v[184:187], v[100:115]
    ds_read_b64_tr_b16 v[48:49], v27 offset:32768
    ds_read_b64_tr_b16 v[50:51], v27 offset:33280
    v_mfma_f32_16x16x32_bf16 v[68:71], v[64:67], v[184:187], v[68:71]
    s_mov_b64 exec, s[92:93]
    ds_read_b128 v[52:55], v25 offset:512
    s_mov_b64 exec, -1
    s_waitcnt lgkmcnt(5)
    v_mfma_f32_32x32x16_bf16 v[84:99], v[32:35], v[188:191], v[84:99]
    ds_read_b64_tr_b16 v[56:57], v26 offset:34816
    ds_read_b64_tr_b16 v[58:59], v26 offset:35328
    s_add_u32 m0, s55, 115712
    s_add_u32 s59, s58, 32768
    buffer_load_dwordx4 v20, s[20:23], s59 offen lds
    v_mfma_f32_32x32x16_bf16 v[100:115], v[36:39], v[188:191], v[100:115]
    ds_read_b64_tr_b16 v[60:61], v27 offset:34816
    ds_read_b64_tr_b16 v[62:63], v27 offset:35328
    v_mfma_f32_16x16x32_bf16 v[68:71], v[40:43], v[188:191], v[68:71]
    s_mov_b64 exec, s[92:93]
    ds_read_b128 v[64:67], v25 offset:544
    s_mov_b64 exec, -1
    s_waitcnt lgkmcnt(5)
    v_mfma_f32_32x32x16_bf16 v[84:99], v[44:47], v[192:195], v[84:99]
    ds_read_b64_tr_b16 v[32:33], v26 offset:36864
    ds_read_b64_tr_b16 v[34:35], v26 offset:37376
    s_add_u32 m0, s55, 116736
    s_add_u32 s59, s58, 40960
    buffer_load_dwordx4 v20, s[20:23], s59 offen lds
    v_mfma_f32_32x32x16_bf16 v[100:115], v[48:51], v[192:195], v[100:115]
    ds_read_b64_tr_b16 v[36:37], v27 offset:36864
    ds_read_b64_tr_b16 v[38:39], v27 offset:37376
    v_mfma_f32_16x16x32_bf16 v[68:71], v[52:55], v[192:195], v[68:71]
    s_mov_b64 exec, s[92:93]
    ds_read_b128 v[40:43], v25 offset:576
    s_mov_b64 exec, -1
    s_waitcnt lgkmcnt(5)
    v_mov_b32 v12, 2
    ds_write_b32 v11, v12
    v_mfma_f32_32x32x16_bf16 v[84:99], v[56:59], v[196:199], v[84:99]
    ds_read_b64_tr_b16 v[44:45], v26 offset:38912
    ds_read_b64_tr_b16 v[46:47], v26 offset:39424
    s_add_u32 m0, s55, 117760
    s_add_u32 s59, s58, 49152
    buffer_load_dwordx4 v20, s[20:23], s59 offen lds
    v_mfma_f32_32x32x16_bf16 v[100:115], v[60:63], v[196:199], v[100:115]
    ds_read_b64_tr_b16 v[48:49], v27 offset:38912
    ds_read_b64_tr_b16 v[50:51], v27 offset:39424
    v_mfma_f32_16x16x32_bf16 v[68:71], v[64:67], v[196:199], v[68:71]
    s_mov_b64 exec, s[92:93]
    ds_read_b128 v[52:55], v25 offset:608
    s_mov_b64 exec, -1
    s_waitcnt lgkmcnt(6)
    v_mfma_f32_32x32x16_bf16 v[84:99], v[32:35], v[200:203], v[84:99]
    ds_read_b64_tr_b16 v[56:57], v26 offset:40960
    ds_read_b64_tr_b16 v[58:59], v26 offset:41472
    s_add_u32 m0, s55, 118784
    s_add_u32 s59, s58, 57344
    buffer_load_dwordx4 v20, s[20:23], s59 offen lds
    v_mfma_f32_32x32x16_bf16 v[100:115], v[36:39], v[200:203], v[100:115]
    ds_read_b64_tr_b16 v[60:61], v27 offset:40960
    ds_read_b64_tr_b16 v[62:63], v27 offset:41472
    v_mfma_f32_16x16x32_bf16 v[68:71], v[40:43], v[200:203], v[68:71]
    s_mov_b64 exec, s[92:93]
    ds_read_b128 v[64:67], v25 offset:640
    s_mov_b64 exec, -1
    s_waitcnt lgkmcnt(5)
    v_mfma_f32_32x32x16_bf16 v[84:99], v[44:47], v[204:207], v[84:99]
    ds_read_b64_tr_b16 v[32:33], v26 offset:43008
    ds_read_b64_tr_b16 v[34:35], v26 offset:43520
    v_mfma_f32_32x32x16_bf16 v[100:115], v[48:51], v[204:207], v[100:115]
    ds_read_b64_tr_b16 v[36:37], v27 offset:43008
    ds_read_b64_tr_b16 v[38:39], v27 offset:43520
    v_mfma_f32_16x16x32_bf16 v[68:71], v[52:55], v[204:207], v[68:71]
    s_mov_b64 exec, s[92:93]
    ds_read_b128 v[40:43], v25 offset:672
    s_mov_b64 exec, -1
    ds_read_b32 v15, v10
    s_waitcnt lgkmcnt(0)
L_pc1:
    v_cmp_gt_u32 vcc, 2, v15
    s_and_b32 s60, vcc_lo, 240
    s_cbranch_scc0 L_pk1
    s_add_u32 s65, s65, 1
    s_sleep 1
    ds_read_b32 v15, v10
    s_cmp_gt_u32 s65, 1600000
    s_waitcnt lgkmcnt(0)
    s_cbranch_scc0 L_pc1
L_pk1:
    v_mfma_f32_32x32x16_bf16 v[84:99], v[56:59], v[208:211], v[84:99]
    ds_read_b64_tr_b16 v[44:45], v26 offset:45056
    ds_read_b64_tr_b16 v[46:47], v26 offset:45568
    s_add_u32 m0, s55, 36864
    s_add_u32 s59, s56, 73728
    buffer_load_dwordx4 v20, s[16:19], s59 offen lds
    v_mfma_f32_32x32x16_bf16 v[100:115], v[60:63], v[208:211], v[100:115]
    ds_read_b64_tr_b16 v[48:49], v27 offset:45056
    ds_read_b64_tr_b16 v[50:51], v27 offset:45568
    v_mfma_f32_16x16x32_bf16 v[68:71], v[64:67], v[208:211], v[68:71]
    s_mov_b64 exec, s[92:93]
    ds_read_b128 v[52:55], v25 offset:704
    s_mov_b64 exec, -1
    v_mfma_f32_32x32x16_bf16 v[84:99], v[32:35], v[212:215], v[84:99]
    ds_read_b64_tr_b16 v[56:57], v26 offset:47104
    ds_read_b64_tr_b16 v[58:59], v26 offset:47616
    s_add_u32 m0, s55, 37888
    s_add_u32 s59, s56, 81920
    buffer_load_dwordx4 v20, s[16:19], s59 offen lds
    v_mfma_f32_32x32x16_bf16 v[100:115], v[36:39], v[212:215], v[100:115]
    ds_read_b64_tr_b16 v[60:61], v27 offset:47104
    ds_read_b64_tr_b16 v[62:63], v27 offset:47616
    v_mfma_f32_16x16x32_bf16 v[68:71], v[40:43], v[212:215], v[68:71]
    s_mov_b64 exec, s[92:93]
    ds_read_b128 v[64:67], v25 offset:736
    s_mov_b64 exec, -1
    s_waitcnt lgkmcnt(5)
    v_mfma_f32_32x32x16_bf16 v[84:99], v[44:47], v[216:219], v[84:99]
    ds_read_b64_tr_b16 v[32:33], v26 offset:49152
    ds_read_b64_tr_b16 v[34:35], v26 offset:49664
    s_add_u32 m0, s55, 38912
    s_add_u32 s59, s56, 90112
    buffer_load_dwordx4 v20, s[16:19], s59 offen lds
    v_mfma_f32_32x32x16_bf16 v[100:115], v[48:51], v[216:219], v[100:115]
    ds_read_b64_tr_b16 v[36:37], v27 offset:49152
    ds_read_b64_tr_b16 v[38:39], v27 offset:49664
    v_mfma_f32_16x16x32_bf16 v[68:71], v[52:55], v[216:219], v[68:71]
    s_mov_b64 exec, s[92:93]
    ds_read_b128 v[40:43], v25 offset:768
    s_mov_b64 exec, -1
    s_waitcnt lgkmcnt(5)
    v_mfma_f32_32x32x16_bf16 v[84:99], v[56:59], v[220:223], v[84:99]
    ds_read_b64_tr_b16 v[44:45], v26 offset:51200
    ds_read_b64_tr_b16 v[46:47], v26 offset:51712
    s_add_u32 m0, s55, 39936
    s_add_u32 s59, s56, 98304
    buffer_load_dwordx4 v20, s[16:19], s59 offen lds
    v_mfma_f32_32x32x16_bf16 v[100:115], v[60:63], v[220:223], v[100:115]
    ds_read_b64_tr_b16 v[48:49], v27 offset:51200
    ds_read_b64_tr_b16 v[50:51], v27 offset:51712
    v_mfma_f32_16x16x32_bf16 v[68:71], v[64:67], v[220:223], v[68:71]
    s_mov_b64 exec, s[92:93]
    ds_read_b128 v[52:55], v25 offset:800
    s_mov_b64 exec, -1
    s_waitcnt lgkmcnt(5)
    v_mfma_f32_32x32x16_bf16 v[84:99], v[32:35], v[224:227], v[84:99]
    ds_read_b64_tr_b16 v[56:57], v26 offset:53248
    ds_read_b64_tr_b16 v[58:59], v26 offset:53760
    s_add_u32 m0, s55, 40960
    s_add_u32 s59, s56, 106496
    buffer_load_dwordx4 v20, s[16:19], s59 offen lds
    v_mfma_f32_32x32x16_bf16 v[100:115], v[36:39], v[224:227], v[100:115]
    ds_read_b64_tr_b16 v[60:61], v27 offset:53248
    ds_read_b64_tr_b16 v[62:63], v27 offset:53760
    v_mfma_f32_16x16x32_bf16 v[68:71], v[40:43], v[224:227], v[68:71]
    s_mov_b64 exec, s[92:93]
    ds_read_b128 v[64:67], v25 offset:832
    s_mov_b64 exec, -1
    s_waitcnt lgkmcnt(5)
    v_mfma_f32_32x32x16_bf16 v[84:99], v[44:47], v[228:231], v[84:99]
    ds_read_b64_tr_b16 v[32:33], v26 offset:55296
    ds_read_b64_tr_b16 v[34:35], v26 offset:55808
    s_add_u32 m0, s55, 41984
    s_add_u32 s59, s56, 114688
    buffer_load_dwordx4 v20, s[16:19], s59 offen lds
    v_mfma_f32_32x32x16_bf16 v[100:115], v[48:51], v[228:231], v[100:115]
    ds_read_b64_tr_b16 v[36:37], v27 offset:55296
    ds_read_b64_tr_b16 v[38:39], v27 offset:55808
    v_mfma_f32_16x16x32_bf16 v[68:71], v[52:55], v[228:231], v[68:71]
    s_mov_b64 exec, s[92:93]
    ds_read_b128 v[40:43], v25 offset:864
    s_mov_b64 exec, -1
    s_waitcnt lgkmcnt(5)
    v_mfma_f32_32x32x16_bf16 v[84:99], v[56:59], v[232:235], v[84:99]
    ds_read_b64_tr_b16 v[44:45], v26 offset:57344
    ds_read_b64_tr_b16 v[46:47], v26 offset:57856
    s_add_u32 m0, s55, 43008
    s_add_u32 s59, s56, 122880
    buffer_load_dwordx4 v20, s[16:19], s59 offen lds
    v_mfma_f32_32x32x16_bf16 v[100:115], v[60:63], v[232:235], v[100:115]
    ds_read_b64_tr_b16 v[48:49], v27 offset:57344
    ds_read_b64_tr_b16 v[50:51], v27 offset:57856
    v_mfma_f32_16x16x32_bf16 v[68:71], v[64:67], v[232:235], v[68:71]
    s_mov_b64 exec, s[92:93]
    ds_read_b128 v[52:55], v25 offset:896
    s_mov_b64 exec, -1
    s_waitcnt lgkmcnt(5)
    v_mfma_f32_32x32x16_bf16 v[84:99], v[32:35], v[236:239], v[84:99]
    ds_read_b64_tr_b16 v[56:57], v26 offset:59392
    ds_read_b64_tr_b16 v[58:59], v26 offset:59904
    s_add_u32 m0, s55, 44032
    s_nop 0
    buffer_load_dwordx4 v20, s[16:19], s57 offen lds
    v_mfma_f32_32x32x16_bf16 v[100:115], v[36:39], v[236:239], v[100:115]
    ds_read_b64_tr_b16 v[60:61], v27 offset:59392
    ds_read_b64_tr_b16 v[62:63], v27 offset:59904
    v_mfma_f32_16x16x32_bf16 v[68:71], v[40:43], v[236:239], v[68:71]
    s_mov_b64 exec, s[92:93]
    ds_read_b128 v[64:67], v25 offset:928
    s_mov_b64 exec, -1
    s_waitcnt lgkmcnt(5)
    v_mfma_f32_32x32x16_bf16 v[84:99], v[44:47], v[240:243], v[84:99]
    ds_read_b64_tr_b16 v[32:33], v26 offset:61440
    ds_read_b64_tr_b16 v[34:35], v26 offset:61952
    s_add_u32 m0, s55, 45056
    s_add_u32 s59, s57, 8192
    buffer_load_dwordx4 v20, s[16:19], s59 offen lds
    v_mfma_f32_32x32x16_bf16 v[100:115], v[48:51], v[240:243], v[100:115]
    ds_read_b64_tr_b16 v[36:37], v27 offset:61440
    ds_read_b64_tr_b16 v[38:39], v27 offset:61952
    v_mfma_f32_16x16x32_bf16 v[68:71], v[52:55], v[240:243], v[68:71]
    s_mov_b64 exec, s[92:93]
    ds_read_b128 v[40:43], v25 offset:960
    s_mov_b64 exec, -1
    s_waitcnt lgkmcnt(5)
    v_mfma_f32_32x32x16_bf16 v[84:99], v[56:59], v[244:247], v[84:99]
    ds_read_b64_tr_b16 v[44:45], v26 offset:63488
    ds_read_b64_tr_b16 v[46:47], v26 offset:64000
    v_mfma_f32_32x32x16_bf16 v[100:115], v[60:63], v[244:247], v[100:115]
    ds_read_b64_tr_b16 v[48:49], v27 offset:63488
    ds_read_b64_tr_b16 v[50:51], v27 offset:64000
    v_mfma_f32_16x16x32_bf16 v[68:71], v[64:67], v[244:247], v[68:71]
    s_mov_b64 exec, s[92:93]
    ds_read_b128 v[52:55], v25 offset:992
    s_mov_b64 exec, -1
    s_waitcnt lgkmcnt(5)
    v_mfma_f32_32x32x16_bf16 v[84:99], v[32:35], v[248:251], v[84:99]
    v_mfma_f32_32x32x16_bf16 v[100:115], v[36:39], v[248:251], v[100:115]
    v_mfma_f32_16x16x32_bf16 v[68:71], v[40:43], v[248:251], v[68:71]
    s_waitcnt lgkmcnt(0)
    v_mov_b32 v12, 5
    ds_write_b32 v11, v12
    v_mfma_f32_32x32x16_bf16 v[84:99], v[44:47], v[252:255], v[84:99]
    v_mfma_f32_32x32x16_bf16 v[100:115], v[48:51], v[252:255], v[100:115]
    v_mfma_f32_16x16x32_bf16 v[68:71], v[52:55], v[252:255], v[68:71]
    v_lshrrev_b32 v15, 5, v1
    v_lshlrev_b32 v15, 4, v15
    v_and_b32 v14, 31, v1
    v_lshlrev_b32 v125, 2, v14
    v_min_u32 v14, 16, v14
    v_lshl_add_u32 v31, v14, 5, v15
    v_add_u32 v31, 157696, v31
    s_nop 3
    v_mul_f32 v116, s66, v84
    v_mul_f32 v117, s66, v85
    v_mul_f32 v118, s66, v86
    v_mul_f32 v119, s66, v87
    v_mul_f32 v120, s66, v88
    v_mul_f32 v121, s66, v89
    v_mul_f32 v122, s66, v90
    v_mul_f32 v123, s66, v91
    v_exp_f32 v116, v116 clamp
    v_exp_f32 v117, v117 clamp
    v_exp_f32 v118, v118 clamp
    v_exp_f32 v119, v119 clamp
    v_exp_f32 v120, v120 clamp
    v_exp_f32 v121, v121 clamp
    v_exp_f32 v122, v122 clamp
    v_exp_f32 v123, v123 clamp
    v_max_f32 v84, s67, v84
    v_max_f32 v85, s67, v85
    v_max_f32 v86, s67, v86
    v_max_f32 v87, s67, v87
    v_max_f32 v88, s67, v88
    v_max_f32 v89, s67, v89
    v_max_f32 v90, s67, v90
    v_max_f32 v91, s67, v91
    v_add_f32 v116, v116, v84
    v_add_f32 v117, v117, v85
    v_add_f32 v118, v118, v86
    v_add_f32 v119, v119, v87
    v_add_f32 v120, v120, v88
    v_add_f32 v121, v121, v89
    v_add_f32 v122, v122, v90
    v_add_f32 v123, v123, v91
    v_cvt_pk_bf16_f32 v32, v116, v117
    v_cvt_pk_bf16_f32 v33, v118, v119
    v_cvt_pk_bf16_f32 v34, v120, v121
    v_cvt_pk_bf16_f32 v35, v122, v123
    v_mul_f32 v116, s66, v92
    v_mul_f32 v117, s66, v93
    v_mul_f32 v118, s66, v94
    v_mul_f32 v119, s66, v95
    v_cvt_pk_bf16_f32 v124, v68, v68
    v_mul_f32 v120, s66, v96
    v_mul_f32 v121, s66, v97
    v_mul_f32 v122, s66, v98
    v_mul_f32 v123, s66, v99
    v_lshlrev_b32 v124, 16, v124
    v_exp_f32 v116, v116 clamp
    v_exp_f32 v117, v117 clamp
    v_exp_f32 v118, v118 clamp
    v_exp_f32 v119, v119 clamp
    v_mul_f32 v124, s66, v124
    v_exp_f32 v120, v120 clamp
    v_exp_f32 v121, v121 clamp
    v_exp_f32 v122, v122 clamp
    v_exp_f32 v123, v123 clamp
    v_exp_f32 v124, -v124
    v_max_f32 v92, s67, v92
    v_max_f32 v93, s67, v93
    v_max_f32 v94, s67, v94
    v_max_f32 v95, s67, v95
    v_add_f32 v124, 1.0, v124
    v_max_f32 v96, s67, v96
    v_max_f32 v97, s67, v97
    v_max_f32 v98, s67, v98
    v_max_f32 v99, s67, v99
    v_rcp_f32 v124, v124
    v_add_f32 v116, v116, v92
    v_add_f32 v117, v117, v93
    v_add_f32 v118, v118, v94
    v_add_f32 v119, v119, v95
    v_cvt_pk_bf16_f32 v124, v124, v124
    v_add_f32 v120, v120, v96
    v_add_f32 v121, v121, v97
    v_add_f32 v122, v122, v98
    v_add_f32 v123, v123, v99
    v_and_b32 v124, 0xffff0000, v124
    v_cvt_pk_bf16_f32 v36, v116, v117
    v_cvt_pk_bf16_f32 v37, v118, v119
    v_cvt_pk_bf16_f32 v38, v120, v121
    v_cvt_pk_bf16_f32 v39, v122, v123
    s_mov_b32 exec_hi, 0
    buffer_store_dword v124, v125, s[24:27], s74 offen sc1
    s_mov_b64 exec, -1
    v_mul_f32 v116, s66, v100
    v_mul_f32 v117, s66, v101
    v_mul_f32 v118, s66, v102
    v_mul_f32 v119, s66, v103
    v_mul_f32 v120, s66, v104
    v_mul_f32 v121, s66, v105
    v_mul_f32 v122, s66, v106
    v_mul_f32 v123, s66, v107
    v_exp_f32 v116, v116 clamp
    v_exp_f32 v117, v117 clamp
    v_exp_f32 v118, v118 clamp
    v_exp_f32 v119, v119 clamp
    v_exp_f32 v120, v120 clamp
    v_exp_f32 v121, v121 clamp
    v_exp_f32 v122, v122 clamp
    v_exp_f32 v123, v123 clamp
    v_max_f32 v100, s67, v100
    v_max_f32 v101, s67, v101
    v_max_f32 v102, s67, v102
    v_max_f32 v103, s67, v103
    v_max_f32 v104, s67, v104
    v_max_f32 v105, s67, v105
    v_max_f32 v106, s67, v106
    v_max_f32 v107, s67, v107
    v_add_f32 v116, v116, v100
    v_add_f32 v117, v117, v101
    v_add_f32 v118, v118, v102
    v_add_f32 v119, v119, v103
    v_add_f32 v120, v120, v104
    v_add_f32 v121, v121, v105
    v_add_f32 v122, v122, v106
    v_add_f32 v123, v123, v107
    v_cvt_pk_bf16_f32 v40, v116, v117
    v_cvt_pk_bf16_f32 v41, v118, v119
    v_cvt_pk_bf16_f32 v42, v120, v121
    v_cvt_pk_bf16_f32 v43, v122, v123
    v_mul_f32 v116, s66, v108
    v_mul_f32 v117, s66, v109
    v_mul_f32 v118, s66, v110
    v_mul_f32 v119, s66, v111
    v_mul_f32 v120, s66, v112
    v_mul_f32 v121, s66, v113
    v_mul_f32 v122, s66, v114
    v_mul_f32 v123, s66, v115
    v_exp_f32 v116, v116 clamp
    v_exp_f32 v117, v117 clamp
    v_exp_f32 v118, v118 clamp
    v_exp_f32 v119, v119 clamp
    v_exp_f32 v120, v120 clamp
    v_exp_f32 v121, v121 clamp
    v_exp_f32 v122, v122 clamp
    v_exp_f32 v123, v123 clamp
    v_max_f32 v108, s67, v108
    v_max_f32 v109, s67, v109
    v_max_f32 v110, s67, v110
    v_max_f32 v111, s67, v111
    v_max_f32 v112, s67, v112
    v_max_f32 v113, s67, v113
    v_max_f32 v114, s67, v114
    v_max_f32 v115, s67, v115
    v_add_f32 v116, v116, v108
    v_add_f32 v117, v117, v109
    v_add_f32 v118, v118, v110
    v_add_f32 v119, v119, v111
    v_add_f32 v120, v120, v112
    v_add_f32 v121, v121, v113
    v_add_f32 v122, v122, v114
    v_add_f32 v123, v123, v115
    v_cvt_pk_bf16_f32 v44, v116, v117
    v_cvt_pk_bf16_f32 v45, v118, v119
    v_cvt_pk_bf16_f32 v46, v120, v121
    v_cvt_pk_bf16_f32 v47, v122, v123
    s_waitcnt vmcnt(1)
    v_mov_b32 v12, 6
    ds_write_b32 v11, v12
    s_branch L_ko1
L_ko:
    s_sleep 2
L_ko1:
    ds_read_b32 v15, v10
    ds_read_b128 v[68:71], v31 offset:0
    ds_read_b128 v[72:75], v31 offset:576
    ds_read_b128 v[76:79], v31 offset:1152
    ds_read_b128 v[80:83], v31 offset:1728
    s_add_u32 s65, s65, 1
    s_cmp_gt_u32 s65, 1600000
    s_cbranch_scc1 L_kok
    s_waitcnt lgkmcnt(4)
    v_cmp_gt_u32 vcc, 6, v15
    s_and_b32 s60, vcc_lo, 15
    s_cbranch_scc1 L_ko
L_kok:
    s_waitcnt lgkmcnt(3)
    v_mfma_f32_32x32x16_bf16 v[128:143], v[68:71], v[32:35], 0
    s_waitcnt lgkmcnt(2)
    v_mfma_f32_32x32x16_bf16 v[144:159], v[72:75], v[36:39], 0
    s_waitcnt lgkmcnt(1)
    v_mfma_f32_32x32x16_bf16 v[160:175], v[76:79], v[40:43], 0
    s_waitcnt lgkmcnt(0)
    v_mfma_f32_32x32x16_bf16 v[176:191], v[80:83], v[44:47], 0
    s_nop 5
    v_add_f32 v136, s67, v136
    v_rcp_f32 v136, v136
    s_nop 0
    v_mul_f32 v128, v128, v136
    v_mul_f32 v129, v129, v136
    v_mul_f32 v130, v130, v136
    v_mul_f32 v131, v131, v136
    v_mul_f32 v132, v132, v136
    v_mul_f32 v133, v133, v136
    v_mul_f32 v134, v134, v136
    v_mul_f32 v135, v135, v136
    v_cvt_pk_bf16_f32 v140, v128, v129
    v_cvt_pk_bf16_f32 v141, v130, v131
    v_cvt_pk_bf16_f32 v142, v132, v133
    v_cvt_pk_bf16_f32 v143, v134, v135
    buffer_store_dwordx4 v[140:143], v2, s[24:27], s77 offen offset:0 sc1
    v_add_f32 v152, s67, v152
    v_rcp_f32 v152, v152
    s_nop 0
    v_mul_f32 v144, v144, v152
    v_mul_f32 v145, v145, v152
    v_mul_f32 v146, v146, v152
    v_mul_f32 v147, v147, v152
    v_mul_f32 v148, v148, v152
    v_mul_f32 v149, v149, v152
    v_mul_f32 v150, v150, v152
    v_mul_f32 v151, v151, v152
    v_cvt_pk_bf16_f32 v156, v144, v145
    v_cvt_pk_bf16_f32 v157, v146, v147
    v_cvt_pk_bf16_f32 v158, v148, v149
    v_cvt_pk_bf16_f32 v159, v150, v151
    buffer_store_dwordx4 v[156:159], v2, s[24:27], s77 offen offset:1024 sc1
    v_add_f32 v168, s67, v168
    v_rcp_f32 v168, v168
    s_nop 0
    v_mul_f32 v160, v160, v168
    v_mul_f32 v161, v161, v168
    v_mul_f32 v162, v162, v168
    v_mul_f32 v163, v163, v168
    v_mul_f32 v164, v164, v168
    v_mul_f32 v165, v165, v168
    v_mul_f32 v166, v166, v168
    v_mul_f32 v167, v167, v168
    v_cvt_pk_bf16_f32 v172, v160, v161
    v_cvt_pk_bf16_f32 v173, v162, v163
    v_cvt_pk_bf16_f32 v174, v164, v165
    v_cvt_pk_bf16_f32 v175, v166, v167
    buffer_store_dwordx4 v[172:175], v2, s[24:27], s77 offen offset:2048 sc1
    v_add_f32 v184, s67, v184
    v_rcp_f32 v184, v184
    s_nop 0
    v_mul_f32 v176, v176, v184
    v_mul_f32 v177, v177, v184
    v_mul_f32 v178, v178, v184
    v_mul_f32 v179, v179, v184
    v_mul_f32 v180, v180, v184
    v_mul_f32 v181, v181, v184
    v_mul_f32 v182, v182, v184
    v_mul_f32 v183, v183, v184
    v_cvt_pk_bf16_f32 v188, v176, v177
    v_cvt_pk_bf16_f32 v189, v178, v179
    v_cvt_pk_bf16_f32 v190, v180, v181
    v_cvt_pk_bf16_f32 v191, v182, v183
    buffer_store_dwordx4 v[188:191], v2, s[24:27], s77 offen offset:3072 sc1
    v_and_b32 v14, 31, v1
    v_lshlrev_b32 v14, 7, v14
    s_load_dword s8, s[24:25], s80 offset:0 glc
    s_load_dword s9, s[24:25], s80 offset:128 glc
    s_load_dword s10, s[24:25], s80 offset:1024 glc
    s_load_dword s11, s[24:25], s80 offset:1152 glc
    s_waitcnt vmcnt(0)
    buffer_store_dword v7, off, s[24:27], s76 offset:512 sc1
    s_setprio 0
    s_sub_u32 s13, s82, 0xd00000
    s_lshr_b32 s13, s13, 5
    s_add_u32 s13, s13, 0xc80000
    s_lshl_b32 s14, s64, 11
    s_and_b32 s14, s14, 0xffff0000
    ds_read_b32 v15, v10
    s_waitcnt lgkmcnt(0)
L_pc2:
    v_cmp_gt_u32 vcc, 6, v15
    s_and_b32 s60, vcc_lo, 255
    s_cbranch_scc0 L_pk2
    s_add_u32 s65, s65, 1
    s_sleep 1
    ds_read_b32 v15, v10
    s_cmp_gt_u32 s65, 1600000
    s_waitcnt lgkmcnt(0)
    s_cbranch_scc0 L_pc2
L_pk2:
    ds_read_b64_tr_b16 v[80:81], v3 offset:0
    ds_read_b64_tr_b16 v[82:83], v3 offset:1024
    ds_read_b64_tr_b16 v[84:85], v4 offset:0
    ds_read_b64_tr_b16 v[86:87], v4 offset:1024
    ds_read_b64_tr_b16 v[88:89], v3 offset:9216
    ds_read_b64_tr_b16 v[90:91], v3 offset:10240
    ds_read_b64_tr_b16 v[92:93], v4 offset:9216
    ds_read_b64_tr_b16 v[94:95], v4 offset:10240
    ds_read_b64_tr_b16 v[96:97], v3 offset:2048
    ds_read_b64_tr_b16 v[98:99], v3 offset:3072
    ds_read_b64_tr_b16 v[100:101], v4 offset:2048
    ds_read_b64_tr_b16 v[102:103], v4 offset:3072
    ds_read_b64_tr_b16 v[104:105], v3 offset:11264
    ds_read_b64_tr_b16 v[106:107], v3 offset:12288
    ds_read_b64_tr_b16 v[108:109], v4 offset:11264
    ds_read_b64_tr_b16 v[110:111], v4 offset:12288
    s_waitcnt lgkmcnt(0)
    v_mov_b32 v12, 8
    ds_write_b32 v11, v12
    s_mov_b32 s12, 0
L_fc3:
    s_waitcnt lgkmcnt(0)
    s_xor_b32 s8, s8, s64
    s_xor_b32 s9, s9, s64
    s_xor_b32 s10, s10, s64
    s_xor_b32 s11, s11, s64
    s_or_b32 s8, s8, s10
    s_or_b32 s9, s9, s11
    s_or_b32 s8, s8, s9
    s_cbranch_scc0 L_fk3
    s_add_u32 s12, s12, 1
    s_sleep 1
    s_load_dword s8, s[24:25], s80 offset:0 glc
    s_load_dword s9, s[24:25], s80 offset:128 glc
    s_load_dword s10, s[24:25], s80 offset:1024 glc
    s_load_dword s11, s[24:25], s80 offset:1152 glc
    s_cmp_gt_u32 s12, 20
    s_cbranch_scc0 L_fc3
    s_branch L_fv3
L_fk3:
    s_add_u32 s59, s78, 0
    buffer_load_dwordx4 v[112:115], v2, s[24:27], s59 offen offset:0 sc1
    s_add_u32 s59, s78, 12288
    buffer_load_dwordx4 v[116:119], v2, s[24:27], s59 offen offset:2048 sc1
    s_add_u32 s59, s78, 0
    buffer_load_dwordx4 v[120:123], v2, s[24:27], s59 offen offset:1024 sc1
    s_add_u32 s59, s78, 12288
    buffer_load_dwordx4 v[124:127], v2, s[24:27], s59 offen offset:3072 sc1
    s_add_u32 s59, s78, 0
    buffer_load_dwordx4 v[128:131], v2, s[24:27], s59 offen offset:2048 sc1
    s_add_u32 s59, s78, 16384
    buffer_load_dwordx4 v[132:135], v2, s[24:27], s59 offen offset:0 sc1
    s_add_u32 s59, s78, 0
    buffer_load_dwordx4 v[136:139], v2, s[24:27], s59 offen offset:3072 sc1
    s_add_u32 s59, s78, 16384
    buffer_load_dwordx4 v[140:143], v2, s[24:27], s59 offen offset:1024 sc1
    s_add_u32 s59, s78, 4096
    buffer_load_dwordx4 v[144:147], v2, s[24:27], s59 offen offset:0 sc1
    s_add_u32 s59, s78, 16384
    buffer_load_dwordx4 v[148:151], v2, s[24:27], s59 offen offset:2048 sc1
    s_add_u32 s59, s78, 4096
    buffer_load_dwordx4 v[152:155], v2, s[24:27], s59 offen offset:1024 sc1
    s_add_u32 s59, s78, 16384
    buffer_load_dwordx4 v[156:159], v2, s[24:27], s59 offen offset:3072 sc1
    s_xor_b32 s60, s40, 2
    s_lshl_b32 s83, 1, s60
    v_add_u32 v5, s55, v2
    s_waitcnt vmcnt(11)
    v_mfma_f32_32x32x16_bf16 v[16:31], v[80:83], v[112:115], 0
    s_add_u32 s59, s78, 4096
    buffer_load_dwordx4 v[160:163], v2, s[24:27], s59 offen offset:2048 sc1
    v_mfma_f32_32x32x16_bf16 v[32:47], v[84:87], v[112:115], 0
    s_waitcnt vmcnt(11)
    v_mfma_f32_32x32x16_bf16 v[16:31], v[88:91], v[116:119], v[16:31]
    ds_read_b64_tr_b16 v[80:81], v3 offset:4096
    ds_read_b64_tr_b16 v[82:83], v3 offset:5120
    s_add_u32 s59, s78, 20480
    buffer_load_dwordx4 v[164:167], v2, s[24:27], s59 offen offset:0 sc1
    v_mfma_f32_32x32x16_bf16 v[32:47], v[92:95], v[116:119], v[32:47]
    ds_read_b64_tr_b16 v[84:85], v4 offset:4096
    ds_read_b64_tr_b16 v[86:87], v4 offset:5120
    s_waitcnt vmcnt(11)
    v_mfma_f32_32x32x16_bf16 v[16:31], v[96:99], v[120:123], v[16:31]
    ds_read_b64_tr_b16 v[88:89], v3 offset:13312
    ds_read_b64_tr_b16 v[90:91], v3 offset:14336
    s_add_u32 s59, s78, 4096
    buffer_load_dwordx4 v[168:171], v2, s[24:27], s59 offen offset:3072 sc1
    v_mfma_f32_32x32x16_bf16 v[32:47], v[100:103], v[120:123], v[32:47]
    ds_read_b64_tr_b16 v[92:93], v4 offset:13312
    ds_read_b64_tr_b16 v[94:95], v4 offset:14336
    s_load_dword s8, s[24:25], s80 offset:384 glc
    s_load_dword s9, s[24:25], s80 offset:1408 glc
    s_waitcnt vmcnt(11)
    v_mfma_f32_32x32x16_bf16 v[16:31], v[104:107], v[124:127], v[16:31]
    ds_read_b64_tr_b16 v[96:97], v3 offset:6144
    ds_read_b64_tr_b16 v[98:99], v3 offset:7168
    s_add_u32 s59, s78, 20480
    buffer_load_dwordx4 v[172:175], v2, s[24:27], s59 offen offset:1024 sc1
    v_mfma_f32_32x32x16_bf16 v[32:47], v[108:111], v[124:127], v[32:47]
    ds_read_b64_tr_b16 v[100:101], v4 offset:6144
    ds_read_b64_tr_b16 v[102:103], v4 offset:7168
    s_mov_b32 s12, 0
L_fc4:
    s_waitcnt lgkmcnt(0)
    s_xor_b32 s8, s8, s64
    s_xor_b32 s9, s9, s64
    s_or_b32 s8, s8, s9
    s_cbranch_scc0 L_fk4
    s_add_u32 s12, s12, 1
    s_sleep 1
    s_load_dword s8, s[24:25], s80 offset:384 glc
    s_load_dword s9, s[24:25], s80 offset:1408 glc
    s_cmp_gt_u32 s12, 20
    s_cbranch_scc0 L_fc4
    s_branch L_fv4
L_fk4:
    s_waitcnt vmcnt(11)
    v_mfma_f32_32x32x16_bf16 v[16:31], v[80:83], v[128:131], v[16:31]
    ds_read_b64_tr_b16 v[104:105], v3 offset:15360
    ds_read_b64_tr_b16 v[106:107], v3 offset:16384
    s_add_u32 s59, s78, 8192
    buffer_load_dwordx4 v[176:179], v2, s[24:27], s59 offen offset:0 sc1
    v_mfma_f32_32x32x16_bf16 v[32:47], v[84:87], v[128:131], v[32:47]
    ds_read_b64_tr_b16 v[108:109], v4 offset:15360
    ds_read_b64_tr_b16 v[110:111], v4 offset:16384
    s_waitcnt vmcnt(11)
    v_mfma_f32_32x32x16_bf16 v[16:31], v[88:91], v[132:135], v[16:31]
    ds_read_b64_tr_b16 v[80:81], v3 offset:8192
    ds_read_b64_tr_b16 v[82:83], v3 offset:36864
    s_add_u32 s59, s78, 20480
    buffer_load_dwordx4 v[180:183], v2, s[24:27], s59 offen offset:2048 sc1
    v_mfma_f32_32x32x16_bf16 v[32:47], v[92:95], v[132:135], v[32:47]
    ds_read_b64_tr_b16 v[84:85], v4 offset:8192
    ds_read_b64_tr_b16 v[86:87], v4 offset:36864
    buffer_load_dwordx4 v[128:131], v2, s[24:27], s82 offen offset:0 sc1
    buffer_load_dwordx4 v[132:135], v2, s[24:27], s82 offen offset:1024 sc1
    s_waitcnt vmcnt(13)
    v_mfma_f32_32x32x16_bf16 v[16:31], v[96:99], v[136:139], v[16:31]
    ds_read_b64_tr_b16 v[88:89], v3 offset:17408
    ds_read_b64_tr_b16 v[90:91], v3 offset:46080
    s_add_u32 s59, s78, 8192
    buffer_load_dwordx4 v[184:187], v2, s[24:27], s59 offen offset:1024 sc1
    v_mfma_f32_32x32x16_bf16 v[32:47], v[100:103], v[136:139], v[32:47]
    ds_read_b64_tr_b16 v[92:93], v4 offset:17408
    ds_read_b64_tr_b16 v[94:95], v4 offset:46080
    s_load_dword s8, s[24:25], s80 offset:512 glc
    s_load_dword s9, s[24:25], s80 offset:1536 glc
    s_waitcnt vmcnt(13)
    s_waitcnt lgkmcnt(8)
    v_mfma_f32_32x32x16_bf16 v[16:31], v[104:107], v[140:143], v[16:31]
    ds_read_b64_tr_b16 v[96:97], v3 offset:37888
    ds_read_b64_tr_b16 v[98:99], v3 offset:38912
    s_add_u32 s59, s78, 20480
    buffer_load_dwordx4 v[188:191], v2, s[24:27], s59 offen offset:3072 sc1
    v_mfma_f32_32x32x16_bf16 v[32:47], v[108:111], v[140:143], v[32:47]
    ds_read_b64_tr_b16 v[100:101], v4 offset:37888
    ds_read_b64_tr_b16 v[102:103], v4 offset:38912
    s_mov_b32 s12, 0
L_fc5:
    s_waitcnt lgkmcnt(0)
    s_xor_b32 s8, s8, s64
    s_xor_b32 s9, s9, s64
    s_or_b32 s8, s8, s9
    s_cbranch_scc0 L_fk5
    s_add_u32 s12, s12, 1
    s_sleep 1
    s_load_dword s8, s[24:25], s80 offset:512 glc
    s_load_dword s9, s[24:25], s80 offset:1536 glc
    s_cmp_gt_u32 s12, 20
    s_cbranch_scc0 L_fc5
    s_branch L_fv5
L_fk5:
    v_and_b32 v14, 31, v1
    v_lshlrev_b32 v14, 2, v14
    buffer_load_dword v9, v14, s[24:27], s81 offen sc1
    s_waitcnt vmcnt(14)
    v_mfma_f32_32x32x16_bf16 v[16:31], v[80:83], v[144:147], v[16:31]
    ds_read_b64_tr_b16 v[104:105], v3 offset:47104
    ds_read_b64_tr_b16 v[106:107], v3 offset:48128
    s_add_u32 s59, s78, 8192
    buffer_load_dwordx4 v[192:195], v2, s[24:27], s59 offen offset:2048 sc1
    v_mfma_f32_32x32x16_bf16 v[32:47], v[84:87], v[144:147], v[32:47]
    ds_read_b64_tr_b16 v[108:109], v4 offset:47104
    ds_read_b64_tr_b16 v[110:111], v4 offset:48128
    s_waitcnt vmcnt(14)
    v_mfma_f32_32x32x16_bf16 v[16:31], v[88:91], v[148:151], v[16:31]
    ds_read_b64_tr_b16 v[80:81], v3 offset:39936
    ds_read_b64_tr_b16 v[82:83], v3 offset:40960
    s_add_u32 s59, s78, 24576
    buffer_load_dwordx4 v[196:199], v2, s[24:27], s59 offen offset:0 sc1
    v_mfma_f32_32x32x16_bf16 v[32:47], v[92:95], v[148:151], v[32:47]
    ds_read_b64_tr_b16 v[84:85], v4 offset:39936
    ds_read_b64_tr_b16 v[86:87], v4 offset:40960
    s_waitcnt vmcnt(14)
    v_mfma_f32_32x32x16_bf16 v[16:31], v[96:99], v[152:155], v[16:31]
    ds_read_b64_tr_b16 v[88:89], v3 offset:49152
    ds_read_b64_tr_b16 v[90:91], v3 offset:50176
    s_add_u32 s59, s78, 8192
    buffer_load_dwordx4 v[200:203], v2, s[24:27], s59 offen offset:3072 sc1
    v_mfma_f32_32x32x16_bf16 v[32:47], v[100:103], v[152:155], v[32:47]
    ds_read_b64_tr_b16 v[92:93], v4 offset:49152
    ds_read_b64_tr_b16 v[94:95], v4 offset:50176
    s_waitcnt vmcnt(14)
    s_waitcnt lgkmcnt(8)
    v_mov_b32 v12, 9
    ds_write_b32 v11, v12
    v_mfma_f32_32x32x16_bf16 v[16:31], v[104:107], v[156:159], v[16:31]
    ds_read_b64_tr_b16 v[96:97], v3 offset:41984
    ds_read_b64_tr_b16 v[98:99], v3 offset:43008
    s_add_u32 s59, s78, 24576
    buffer_load_dwordx4 v[204:207], v2, s[24:27], s59 offen offset:1024 sc1
    v_mfma_f32_32x32x16_bf16 v[32:47], v[108:111], v[156:159], v[32:47]
    ds_read_b64_tr_b16 v[100:101], v4 offset:41984
    ds_read_b64_tr_b16 v[102:103], v4 offset:43008
    s_waitcnt vmcnt(14)
    s_waitcnt lgkmcnt(9)
    v_mfma_f32_32x32x16_bf16 v[16:31], v[80:83], v[160:163], v[16:31]
    ds_read_b64_tr_b16 v[104:105], v3 offset:51200
    ds_read_b64_tr_b16 v[106:107], v3 offset:52224
    s_add_u32 s59, s78, 12288
    buffer_load_dwordx4 v[208:211], v2, s[24:27], s59 offen offset:0 sc1
    v_mfma_f32_32x32x16_bf16 v[32:47], v[84:87], v[160:163], v[32:47]
    ds_read_b64_tr_b16 v[108:109], v4 offset:51200
    ds_read_b64_tr_b16 v[110:111], v4 offset:52224
    s_waitcnt vmcnt(14)
    s_waitcnt lgkmcnt(9)
    v_mfma_f32_32x32x16_bf16 v[16:31], v[88:91], v[164:167], v[16:31]
    ds_read_b64_tr_b16 v[80:81], v3 offset:44032
    ds_read_b64_tr_b16 v[82:83], v3 offset:45056
    s_add_u32 s59, s78, 24576
    buffer_load_dwordx4 v[212:215], v2, s[24:27], s59 offen offset:2048 sc1
    v_mfma_f32_32x32x16_bf16 v[32:47], v[92:95], v[164:167], v[32:47]
    ds_read_b64_tr_b16 v[84:85], v4 offset:44032
    ds_read_b64_tr_b16 v[86:87], v4 offset:45056
    ds_read_b32 v15, v10
    s_waitcnt vmcnt(14)
    s_waitcnt lgkmcnt(9)
    v_mfma_f32_32x32x16_bf16 v[16:31], v[96:99], v[168:171], v[16:31]
    ds_read_b64_tr_b16 v[88:89], v3 offset:53248
    ds_read_b64_tr_b16 v[90:91], v3 offset:54272
    s_add_u32 s59, s78, 12288
    buffer_load_dwordx4 v[216:219], v2, s[24:27], s59 offen offset:1024 sc1
    v_mfma_f32_32x32x16_bf16 v[32:47], v[100:103], v[168:171], v[32:47]
    ds_read_b64_tr_b16 v[92:93], v4 offset:53248
    ds_read_b64_tr_b16 v[94:95], v4 offset:54272
    s_waitcnt lgkmcnt(4)
L_pc6:
    v_cmp_gt_u32 vcc, 9, v15
    s_and_b32 s60, vcc_lo, 15
    s_cbranch_scc0 L_pk6
    s_add_u32 s65, s65, 1
    s_sleep 1
    ds_read_b32 v15, v10
    s_cmp_gt_u32 s65, 1600000
    s_waitcnt lgkmcnt(0)
    s_cbranch_scc0 L_pc6
L_pk6:
    s_waitcnt vmcnt(14)
    v_mfma_f32_32x32x16_bf16 v[16:31], v[104:107], v[172:175], v[16:31]
    v_add_u32 v3, 73728, v3
    v_add_u32 v4, 73728, v4
    ds_read_b64_tr_b16 v[96:97], v3 offset:0
    s_add_u32 s59, s78, 24576
    buffer_load_dwordx4 v[220:223], v2, s[24:27], s59 offen offset:3072 sc1
    v_mfma_f32_32x32x16_bf16 v[32:47], v[108:111], v[172:175], v[32:47]
    ds_read_b64_tr_b16 v[98:99], v3 offset:1024
    ds_read_b64_tr_b16 v[100:101], v4 offset:0
    ds_read_b64_tr_b16 v[102:103], v4 offset:1024
    s_waitcnt vmcnt(14)
    v_mfma_f32_32x32x16_bf16 v[16:31], v[80:83], v[176:179], v[16:31]
    ds_read_b64_tr_b16 v[104:105], v3 offset:9216
    ds_read_b64_tr_b16 v[106:107], v3 offset:10240
    s_add_u32 s59, s79, 0
    buffer_load_dwordx4 v[224:227], v2, s[24:27], s59 offen offset:0 sc1
    v_mfma_f32_32x32x16_bf16 v[32:47], v[84:87], v[176:179], v[32:47]
    ds_read_b64_tr_b16 v[108:109], v4 offset:9216
    ds_read_b64_tr_b16 v[110:111], v4 offset:10240
    s_waitcnt vmcnt(14)
    s_waitcnt lgkmcnt(8)
    v_mfma_f32_32x32x16_bf16 v[16:31], v[88:91], v[180:183], v[16:31]
    ds_read_b64_tr_b16 v[80:81], v3 offset:2048
    ds_read_b64_tr_b16 v[82:83], v3 offset:3072
    s_add_u32 s59, s79, 4096
    buffer_load_dwordx4 v[228:231], v2, s[24:27], s59 offen offset:0 sc1
    v_mfma_f32_32x32x16_bf16 v[32:47], v[92:95], v[180:183], v[32:47]
    ds_read_b64_tr_b16 v[84:85], v4 offset:2048
    ds_read_b64_tr_b16 v[86:87], v4 offset:3072
    s_waitcnt vmcnt(12)
    s_waitcnt lgkmcnt(8)
    v_mfma_f32_32x32x16_bf16 v[16:31], v[96:99], v[184:187], v[16:31]
    ds_read_b64_tr_b16 v[88:89], v3 offset:11264
    ds_read_b64_tr_b16 v[90:91], v3 offset:12288
    s_add_u32 s59, s79, 0
    buffer_load_dwordx4 v[232:235], v2, s[24:27], s59 offen offset:1024 sc1
    v_mfma_f32_32x32x16_bf16 v[32:47], v[100:103], v[184:187], v[32:47]
    ds_read_b64_tr_b16 v[92:93], v4 offset:11264
    ds_read_b64_tr_b16 v[94:95], v4 offset:12288
    s_waitcnt vmcnt(12)
    s_waitcnt lgkmcnt(8)
    v_mfma_f32_32x32x16_bf16 v[16:31], v[104:107], v[188:191], v[16:31]
    ds_read_b64_tr_b16 v[96:97], v3 offset:4096
    ds_read_b64_tr_b16 v[98:99], v3 offset:5120
    s_add_u32 s59, s79, 4096
    buffer_load_dwordx4 v[236:239], v2, s[24:27], s59 offen offset:1024 sc1
    v_mfma_f32_32x32x16_bf16 v[32:47], v[108:111], v[188:191], v[32:47]
    ds_read_b64_tr_b16 v[100:101], v4 offset:4096
    ds_read_b64_tr_b16 v[102:103], v4 offset:5120
    s_waitcnt vmcnt(11)
    s_waitcnt lgkmcnt(8)
    v_mfma_f32_32x32x16_bf16 v[16:31], v[80:83], v[192:195], v[16:31]
    ds_read_b64_tr_b16 v[104:105], v3 offset:13312
    ds_read_b64_tr_b16 v[106:107], v3 offset:14336
    s_add_u32 s59, s79, 0
    buffer_load_dwordx4 v[240:243], v2, s[24:27], s59 offen offset:2048 sc1
    v_mfma_f32_32x32x16_bf16 v[32:47], v[84:87], v[192:195], v[32:47]
    ds_read_b64_tr_b16 v[108:109], v4 offset:13312
    ds_read_b64_tr_b16 v[110:111], v4 offset:14336
    s_waitcnt vmcnt(11)
    s_waitcnt lgkmcnt(8)
    v_mfma_f32_32x32x16_bf16 v[16:31], v[88:91], v[196:199], v[16:31]
    ds_read_b64_tr_b16 v[80:81], v3 offset:6144
    ds_read_b64_tr_b16 v[82:83], v3 offset:7168
    s_add_u32 s59, s79, 4096
    buffer_load_dwordx4 v[244:247], v2, s[24:27], s59 offen offset:2048 sc1
    v_mfma_f32_32x32x16_bf16 v[32:47], v[92:95], v[196:199], v[32:47]
    ds_read_b64_tr_b16 v[84:85], v4 offset:6144
    ds_read_b64_tr_b16 v[86:87], v4 offset:7168
    s_waitcnt vmcnt(11)
    s_waitcnt lgkmcnt(8)
    v_mfma_f32_32x32x16_bf16 v[16:31], v[96:99], v[200:203], v[16:31]
    ds_read_b64_tr_b16 v[88:89], v3 offset:15360
    ds_read_b64_tr_b16 v[90:91], v3 offset:16384
    s_add_u32 s59, s79, 0
    buffer_load_dwordx4 v[248:251], v2, s[24:27], s59 offen offset:3072 sc1
    v_mfma_f32_32x32x16_bf16 v[32:47], v[100:103], v[200:203], v[32:47]
    ds_read_b64_tr_b16 v[92:93], v4 offset:15360
    ds_read_b64_tr_b16 v[94:95], v4 offset:16384
    s_waitcnt vmcnt(11)
    s_waitcnt lgkmcnt(8)
    v_mfma_f32_32x32x16_bf16 v[16:31], v[104:107], v[204:207], v[16:31]
    ds_read_b64_tr_b16 v[96:97], v3 offset:8192
    ds_read_b64_tr_b16 v[98:99], v3 offset:36864
    s_add_u32 s59, s79, 4096
    buffer_load_dwordx4 v[252:255], v2, s[24:27], s59 offen offset:3072 sc1
    v_mfma_f32_32x32x16_bf16 v[32:47], v[108:111], v[204:207], v[32:47]
    ds_read_b64_tr_b16 v[100:101], v4 offset:8192
    ds_read_b64_tr_b16 v[102:103], v4 offset:36864
    s_waitcnt vmcnt(11)
    s_waitcnt lgkmcnt(8)
    v_mfma_f32_32x32x16_bf16 v[16:31], v[80:83], v[208:211], v[16:31]
    ds_read_b64_tr_b16 v[104:105], v3 offset:17408
    ds_read_b64_tr_b16 v[106:107], v3 offset:46080
    v_mfma_f32_32x32x16_bf16 v[32:47], v[84:87], v[208:211], v[32:47]
    ds_read_b64_tr_b16 v[108:109], v4 offset:17408
    ds_read_b64_tr_b16 v[110:111], v4 offset:46080
    s_waitcnt vmcnt(10)
    s_waitcnt lgkmcnt(8)
    v_mfma_f32_32x32x16_bf16 v[16:31], v[88:91], v[212:215], v[16:31]
    ds_read_b64_tr_b16 v[80:81], v3 offset:37888
    ds_read_b64_tr_b16 v[82:83], v3 offset:38912
    v_mfma_f32_32x32x16_bf16 v[32:47], v[92:95], v[212:215], v[32:47]
    ds_read_b64_tr_b16 v[84:85], v4 offset:37888
    ds_read_b64_tr_b16 v[86:87], v4 offset:38912
    s_waitcnt vmcnt(9)
    s_waitcnt lgkmcnt(8)
    v_mfma_f32_32x32x16_bf16 v[16:31], v[96:99], v[216:219], v[16:31]
    ds_read_b64_tr_b16 v[88:89], v3 offset:47104
    ds_read_b64_tr_b16 v[90:91], v3 offset:48128
    v_mfma_f32_32x32x16_bf16 v[32:47], v[100:103], v[216:219], v[32:47]
    ds_read_b64_tr_b16 v[92:93], v4 offset:47104
    ds_read_b64_tr_b16 v[94:95], v4 offset:48128
    buffer_load_dword v136, off, s[24:27], s13 sc1
    s_waitcnt vmcnt(9)
    s_waitcnt lgkmcnt(8)
    v_mfma_f32_32x32x16_bf16 v[16:31], v[104:107], v[220:223], v[16:31]
    ds_read_b64_tr_b16 v[96:97], v3 offset:39936
    ds_read_b64_tr_b16 v[98:99], v3 offset:40960
    v_mfma_f32_32x32x16_bf16 v[32:47], v[108:111], v[220:223], v[32:47]
    ds_read_b64_tr_b16 v[100:101], v4 offset:39936
    ds_read_b64_tr_b16 v[102:103], v4 offset:40960
    s_waitcnt vmcnt(8)
    s_waitcnt lgkmcnt(8)
    v_mfma_f32_32x32x16_bf16 v[48:63], v[80:83], v[224:227], 0
    ds_read_b64_tr_b16 v[104:105], v3 offset:49152
    ds_read_b64_tr_b16 v[106:107], v3 offset:50176
    v_mfma_f32_32x32x16_bf16 v[64:79], v[84:87], v[224:227], 0
    ds_read_b64_tr_b16 v[108:109], v4 offset:49152
    ds_read_b64_tr_b16 v[110:111], v4 offset:50176
    s_xor_b32 s60, s41, 2
    s_mul_i32 s60, s60, 9216
    v_add_u32 v6, s60, v2
    s_waitcnt vmcnt(7)
    s_waitcnt lgkmcnt(8)
    v_mfma_f32_32x32x16_bf16 v[48:63], v[88:91], v[228:231], v[48:63]
    ds_read_b64_tr_b16 v[80:81], v3 offset:41984
    ds_read_b64_tr_b16 v[82:83], v3 offset:43008
    v_sub_f32 v8, 1.0, v9
    v_cvt_pk_bf16_f32 v8, v8, v8
    v_mfma_f32_32x32x16_bf16 v[64:79], v[92:95], v[228:231], v[64:79]
    ds_read_b64_tr_b16 v[84:85], v4 offset:41984
    ds_read_b64_tr_b16 v[86:87], v4 offset:43008
    v_and_b32 v8, 0xffff0000, v8
    v_mul_f32 v16, v16, v8
    v_mul_f32 v17, v17, v8
    v_and_b32 v14, 31, v1
    v_lshlrev_b32 v14, 10, v14
    v_and_or_b32 v0, v1, 32, v14
    s_lshl_b32 s62, s47, 16
    s_and_b32 s61, s41, 1
    s_lshl_b32 s61, s61, 15
    s_add_u32 s62, s62, s61
    s_lshl_b32 s61, s46, 7
    s_add_u32 s62, s62, s61
    s_lshr_b32 s61, s41, 1
    s_lshl_b32 s61, s61, 6
    s_add_u32 s62, s62, s61
    s_lshr_b32 s63, s83, 4
    s_waitcnt vmcnt(6)
    s_waitcnt lgkmcnt(8)
    v_mfma_f32_32x32x16_bf16 v[48:63], v[96:99], v[232:235], v[48:63]
    ds_read_b64_tr_b16 v[88:89], v3 offset:51200
    ds_read_b64_tr_b16 v[90:91], v3 offset:52224
    v_mul_f32 v18, v18, v8
    v_mul_f32 v19, v19, v8
    v_mul_f32 v20, v20, v8
    v_mfma_f32_32x32x16_bf16 v[64:79], v[100:103], v[232:235], v[64:79]
    ds_read_b64_tr_b16 v[92:93], v4 offset:51200
    ds_read_b64_tr_b16 v[94:95], v4 offset:52224
    v_mul_f32 v21, v21, v8
    v_mul_f32 v22, v22, v8
    v_mul_f32 v23, v23, v8
    s_waitcnt vmcnt(5)
    s_waitcnt lgkmcnt(8)
    v_mfma_f32_32x32x16_bf16 v[48:63], v[104:107], v[236:239], v[48:63]
    ds_read_b64_tr_b16 v[96:97], v3 offset:44032
    ds_read_b64_tr_b16 v[98:99], v3 offset:45056
    v_mul_f32 v24, v24, v8
    v_mul_f32 v25, v25, v8
    v_mul_f32 v26, v26, v8
    v_mfma_f32_32x32x16_bf16 v[64:79], v[108:111], v[236:239], v[64:79]
    ds_read_b64_tr_b16 v[100:101], v4 offset:44032
    ds_read_b64_tr_b16 v[102:103], v4 offset:45056
    v_mul_f32 v27, v27, v8
    v_mul_f32 v28, v28, v8
    v_mul_f32 v29, v29, v8
    s_waitcnt vmcnt(4)
    s_waitcnt lgkmcnt(8)
    v_mfma_f32_32x32x16_bf16 v[48:63], v[80:83], v[240:243], v[48:63]
    ds_read_b64_tr_b16 v[104:105], v3 offset:53248
    ds_read_b64_tr_b16 v[106:107], v3 offset:54272
    v_mul_f32 v30, v30, v8
    v_mul_f32 v31, v31, v8
    v_mul_f32 v32, v32, v8
    v_mfma_f32_32x32x16_bf16 v[64:79], v[84:87], v[240:243], v[64:79]
    ds_read_b64_tr_b16 v[108:109], v4 offset:53248
    ds_read_b64_tr_b16 v[110:111], v4 offset:54272
    v_mul_f32 v33, v33, v8
    v_mul_f32 v34, v34, v8
    v_mul_f32 v35, v35, v8
    s_waitcnt vmcnt(0)
    buffer_load_dwordx4 v[112:115], v2, s[24:27], s82 offen offset:0 sc1
    buffer_load_dwordx4 v[116:119], v2, s[24:27], s82 offen offset:1024 sc1
    s_waitcnt lgkmcnt(8)
    v_mfma_f32_32x32x16_bf16 v[48:63], v[88:91], v[244:247], v[48:63]
    v_mul_f32 v36, v36, v8
    v_mul_f32 v37, v37, v8
    v_mul_f32 v38, v38, v8
    v_mfma_f32_32x32x16_bf16 v[64:79], v[92:95], v[244:247], v[64:79]
    v_mul_f32 v39, v39, v8
    v_mul_f32 v40, v40, v8
    v_mul_f32 v41, v41, v8
    s_waitcnt lgkmcnt(4)
    v_mfma_f32_32x32x16_bf16 v[48:63], v[96:99], v[248:251], v[48:63]
    v_mul_f32 v42, v42, v8
    v_mul_f32 v43, v43, v8
    v_mul_f32 v44, v44, v8
    v_mfma_f32_32x32x16_bf16 v[64:79], v[100:103], v[248:251], v[64:79]
    v_mul_f32 v45, v45, v8
    v_mul_f32 v46, v46, v8
    v_mul_f32 v47, v47, v8
    ds_read_b32 v15, v10
    s_waitcnt lgkmcnt(1)
    v_mfma_f32_32x32x16_bf16 v[48:63], v[104:107], v[252:255], v[48:63]
    v_mfma_f32_32x32x16_bf16 v[64:79], v[108:111], v[252:255], v[64:79]
    s_waitcnt lgkmcnt(0)
L_pc7:
    v_cmp_gt_u32 vcc, 11, v15
    s_and_b32 s60, vcc_lo, s63
    s_cbranch_scc0 L_pk7
    s_add_u32 s65, s65, 1
    s_sleep 1
    ds_read_b32 v15, v10
    s_cmp_gt_u32 s65, 1600000
    s_waitcnt lgkmcnt(0)
    s_cbranch_scc0 L_pc7
L_pk7:
    s_nop 9
    v_pk_fma_f32 v[16:17], v[48:49], v[8:9], v[16:17] op_sel:[0,1,0]
    v_pk_fma_f32 v[18:19], v[50:51], v[8:9], v[18:19] op_sel:[0,1,0]
    ds_write_b128 v5, v[16:19] offset:0
    v_pk_fma_f32 v[20:21], v[52:53], v[8:9], v[20:21] op_sel:[0,1,0]
    v_pk_fma_f32 v[22:23], v[54:55], v[8:9], v[22:23] op_sel:[0,1,0]
    ds_write_b128 v5, v[20:23] offset:1024
    v_pk_fma_f32 v[24:25], v[56:57], v[8:9], v[24:25] op_sel:[0,1,0]
    v_pk_fma_f32 v[26:27], v[58:59], v[8:9], v[26:27] op_sel:[0,1,0]
    ds_write_b128 v5, v[24:27] offset:2048
    v_pk_fma_f32 v[28:29], v[60:61], v[8:9], v[28:29] op_sel:[0,1,0]
    v_pk_fma_f32 v[30:31], v[62:63], v[8:9], v[30:31] op_sel:[0,1,0]
    ds_write_b128 v5, v[28:31] offset:3072
    v_mov_b32 v12, 10
    ds_write_b32 v11, v12
    v_pk_fma_f32 v[32:33], v[64:65], v[8:9], v[32:33] op_sel:[0,1,0]
    v_pk_fma_f32 v[34:35], v[66:67], v[8:9], v[34:35] op_sel:[0,1,0]
    v_pk_fma_f32 v[36:37], v[68:69], v[8:9], v[36:37] op_sel:[0,1,0]
    v_pk_fma_f32 v[38:39], v[70:71], v[8:9], v[38:39] op_sel:[0,1,0]
    v_pk_fma_f32 v[40:41], v[72:73], v[8:9], v[40:41] op_sel:[0,1,0]
    v_pk_fma_f32 v[42:43], v[74:75], v[8:9], v[42:43] op_sel:[0,1,0]
    v_pk_fma_f32 v[44:45], v[76:77], v[8:9], v[44:45] op_sel:[0,1,0]
    v_pk_fma_f32 v[46:47], v[78:79], v[8:9], v[46:47] op_sel:[0,1,0]
L_cb11:
    ds_read_b32 v15, v10
    ds_read_b128 v[48:51], v6 offset:0
    ds_read_b128 v[52:55], v6 offset:1024
    ds_read_b128 v[56:59], v6 offset:2048
    ds_read_b128 v[60:63], v6 offset:3072
    s_add_u32 s65, s65, 1
    s_cmp_gt_u32 s65, 1600000
    s_cbranch_scc1 L_cbk11
    s_waitcnt lgkmcnt(4)
    v_cmp_gt_u32 vcc, 10, v15
    s_and_b32 s60, vcc_lo, s83
    s_cbranch_scc1 L_cb11
L_cbk11:
    s_waitcnt lgkmcnt(3)
    v_pk_add_f32 v[32:33], v[32:33], v[48:49]
    v_pk_add_f32 v[34:35], v[34:35], v[50:51]
    s_waitcnt lgkmcnt(2)
    v_pk_add_f32 v[36:37], v[36:37], v[52:53]
    v_pk_add_f32 v[38:39], v[38:39], v[54:55]
    s_waitcnt lgkmcnt(1)
    v_pk_add_f32 v[40:41], v[40:41], v[56:57]
    v_pk_add_f32 v[42:43], v[42:43], v[58:59]
    s_waitcnt lgkmcnt(0)
    v_pk_add_f32 v[44:45], v[44:45], v[60:61]
    v_pk_add_f32 v[46:47], v[46:47], v[62:63]
    v_mov_b32 v5, 0
    v_mov_b32 v15, 0xffff0000
L_pr11:
    s_waitcnt vmcnt(0)
    v_xor_b32 v144, v112, v128
    v_xor_b32 v145, v113, v129
    v_xor_b32 v146, v114, v130
    v_xor_b32 v147, v115, v131
    v_xor_b32 v148, v116, v132
    v_xor_b32 v149, v117, v133
    v_xor_b32 v150, v118, v134
    v_xor_b32 v151, v119, v135
    v_min3_u32 v14, v144, v145, v146
    v_min3_u32 v147, v147, v148, v149
    v_min3_u32 v14, v14, v150, v151
    v_min_u32 v14, v14, v147
    v_cmp_eq_u32 vcc, 0, v14
    s_cbranch_vccz L_prk11
    v_cmp_eq_u32 vcc, s64, v136
    s_add_u32 s65, s65, 8
    s_cbranch_vccnz L_prk11
    v_mov_b32 v136, v5
    buffer_load_dwordx4 v[112:115], v2, s[24:27], s82 offen offset:0 sc1
    buffer_load_dwordx4 v[116:119], v2, s[24:27], s82 offen offset:1024 sc1
    buffer_load_dword v5, off, s[24:27], s13 sc1
    s_cmp_gt_u32 s65, 1600000
    s_cbranch_scc0 L_pr11
    s_waitcnt vmcnt(0)
L_prk11:
    v_lshlrev_b32 v48, 16, v112
    v_bitop3_b32 v49, v112, s14, v15 bitop3:0x28
    v_lshlrev_b32 v50, 16, v113
    v_bitop3_b32 v51, v113, s14, v15 bitop3:0x28
    v_pk_add_f32 v[32:33], v[32:33], v[48:49]
    v_pk_add_f32 v[34:35], v[34:35], v[50:51]
    v_cvt_pk_bf16_f32 v80, v32, v33
    v_cvt_pk_bf16_f32 v81, v34, v35
    v_lshlrev_b32 v52, 16, v114
    v_bitop3_b32 v53, v114, s14, v15 bitop3:0x28
    v_lshlrev_b32 v54, 16, v115
    v_bitop3_b32 v55, v115, s14, v15 bitop3:0x28
    v_pk_add_f32 v[36:37], v[36:37], v[52:53]
    v_pk_add_f32 v[38:39], v[38:39], v[54:55]
    v_cvt_pk_bf16_f32 v82, v36, v37
    v_cvt_pk_bf16_f32 v83, v38, v39
    buffer_store_dwordx4 v[80:83], v0, s[28:31], s62 offen offset:0
    v_lshlrev_b32 v56, 16, v116
    v_bitop3_b32 v57, v116, s14, v15 bitop3:0x28
    v_lshlrev_b32 v58, 16, v117
    v_bitop3_b32 v59, v117, s14, v15 bitop3:0x28
    v_pk_add_f32 v[40:41], v[40:41], v[56:57]
    v_pk_add_f32 v[42:43], v[42:43], v[58:59]
    v_cvt_pk_bf16_f32 v84, v40, v41
    v_cvt_pk_bf16_f32 v85, v42, v43
    v_lshlrev_b32 v60, 16, v118
    v_bitop3_b32 v61, v118, s14, v15 bitop3:0x28
    v_lshlrev_b32 v62, 16, v119
    v_bitop3_b32 v63, v119, s14, v15 bitop3:0x28
    v_pk_add_f32 v[44:45], v[44:45], v[60:61]
    v_pk_add_f32 v[46:47], v[46:47], v[62:63]
    v_cvt_pk_bf16_f32 v86, v44, v45
    v_cvt_pk_bf16_f32 v87, v46, v47
    buffer_store_dwordx4 v[84:87], v0, s[28:31], s62 offen offset:16
    s_waitcnt vmcnt(0)
    s_endpgm
L_tagsh:
    s_add_u32 s65, s65, 8
    s_cmp_gt_u32 s65, 1600000
    s_cbranch_scc1 L_tagkh
    s_sleep 1
    buffer_load_dword v7, off, s[36:39], 0 sc1
    s_waitcnt vmcnt(0)
    s_branch L_tagh
L_fv3:
    s_waitcnt lgkmcnt(0)
    s_add_u32 s65, s65, 8
    s_cmp_gt_u32 s65, 1600000
    s_cbranch_scc1 L_fk3
    buffer_load_dword v8, v5, s[24:27], s80 offen sc1
    s_waitcnt vmcnt(0)
    v_cmp_ne_u32 vcc, s64, v8
    s_cbranch_vccz L_fk3
    s_sleep 1
    s_branch L_fv3
L_fv4:
    s_waitcnt lgkmcnt(0)
    s_add_u32 s65, s65, 8
    s_cmp_gt_u32 s65, 1600000
    s_cbranch_scc1 L_fk4
    buffer_load_dword v8, v6, s[24:27], s80 offen offset:384 sc1
    s_waitcnt vmcnt(0)
    v_cmp_ne_u32 vcc, s64, v8
    s_cbranch_vccz L_fk4
    s_sleep 1
    s_branch L_fv4
L_fv5:
    s_waitcnt lgkmcnt(0)
    s_add_u32 s65, s65, 8
    s_cmp_gt_u32 s65, 1600000
    s_cbranch_scc1 L_fk5
    buffer_load_dword v8, v6, s[24:27], s80 offen offset:512 sc1
    s_waitcnt vmcnt(0)
    v_cmp_ne_u32 vcc, s64, v8
    s_cbranch_vccz L_fk5
    s_sleep 1
    s_branch L_fv5
L_Bq:
    s_mov_b32 s88, s96
    s_mov_b32 s89, s97
    s_mov_b32 s90, 0x1c0000
    s_mov_b32 s91, 0x20000
    s_add_u32 m0, s52, 74752
    s_nop 0
    buffer_load_dwordx4 v17, s[8:11], s50 offen lds
    s_add_u32 m0, s53, 91136
    s_add_u32 s59, s84, 24576
    buffer_load_dwordx4 v18, s[12:15], s59 offen lds
    s_waitcnt vmcnt(6)
    s_waitcnt lgkmcnt(0)
    s_barrier
    ds_read_b128 v[128:131], v21
    ds_read_b128 v[132:135], v22
    ds_read_b128 v[136:139], v23
    ds_read_b128 v[140:143], v24
    s_add_u32 m0, s53, 99328
    s_add_u32 s59, s84, 25600
    buffer_load_dwordx4 v18, s[12:15], s59 offen lds
    s_add_u32 m0, s52, 76800
    s_add_u32 s59, s50, 16384
    buffer_load_dwordx4 v17, s[8:11], s59 offen lds
    s_add_u32 s49, s49, 1
    s_and_b32 s49, s49, 7
    s_lshl_b32 s59, s49, 7
    s_add_u32 s50, s51, s59
    s_mul_i32 s59, s49, 196608
    s_add_u32 s84, s72, s59
    s_add_u32 m0, s52, 110592
    s_nop 0
    buffer_load_dwordx4 v16, s[8:11], s50 offen lds
    v_add_u32 v21, 0x9000, v21
    s_add_u32 m0, s53, 126976
    s_nop 0
    buffer_load_dwordx4 v18, s[12:15], s84 offen lds
    v_add_u32 v22, 0x9000, v22
    s_add_u32 m0, s53, 135168
    s_add_u32 s59, s84, 1024
    buffer_load_dwordx4 v18, s[12:15], s59 offen lds
    v_add_u32 v23, 0x9000, v23
    s_add_u32 m0, s52, 112640
    s_add_u32 s59, s50, 16384
    buffer_load_dwordx4 v16, s[8:11], s59 offen lds
    v_add_u32 v24, 0x9000, v24
    s_add_u32 m0, s52, 111616
    s_nop 0
    buffer_load_dwordx4 v17, s[8:11], s50 offen lds
    s_add_u32 m0, s53, 128000
    s_add_u32 s59, s84, 24576
    buffer_load_dwordx4 v18, s[12:15], s59 offen lds
    s_add_u32 m0, s53, 136192
    s_add_u32 s59, s84, 25600
    buffer_load_dwordx4 v18, s[12:15], s59 offen lds
    s_mov_b32 s38, 0x100
    s_mov_b32 s39, 0x20000
    s_lshl_b32 s60, s2, 3
    s_add_u32 s60, s60, s40
    s_cmp_lg_u32 s60, 4
    s_cbranch_scc1 L_notag
    s_or_b32 s60, s86, 16
    s_andn2_b32 s60, s60, 15
    v_mov_b32 v14, s60
    buffer_store_dword v14, off, s[36:39], 0 sc1
L_notag:
    s_lshl_b32 s54, s41, 10
    s_cmp_eq_u32 s63, 0
    s_cselect_b32 s74, 384, 0
    s_add_u32 s74, s74, s75
    v_mul_u32_u24 v7, 3584, v3
    v_add_u32 v30, v6, v7
    s_mul_i32 s60, s41, 57344
    v_lshrrev_b32 v7, 2, v1
    v_mul_u32_u24 v7, 3584, v7
    v_and_b32 v8, 3, v1
    v_lshl_add_u32 v19, v8, 4, v7
    s_sub_u32 s100, s74, s75
    s_sub_u32 s101, s73, s75
    s_add_u32 s74, s74, s60
    s_add_u32 s73, s73, s60
    s_mov_b32 s16, s4
    s_mov_b32 s17, s5
    s_mov_b32 s18, 0x1c0000
    s_mov_b32 s19, 0x20000
    s_mov_b32 s22, 0x80000
    s_mov_b32 s23, 0x20000
    s_mov_b32 s26, 0x1100000
    s_mov_b32 s27, 0x20000
    s_mov_b32 s30, 0x200000
    s_mov_b32 s31, 0x20000
    s_mov_b32 s38, 0x100
    s_mov_b32 s39, 0x20000
    ds_write_b32 v11, v12
    s_waitcnt vmcnt(7)
    s_waitcnt lgkmcnt(0)
    s_barrier
    ds_read_b128 v[144:147], v21
    ds_read_b128 v[148:151], v22
    ds_read_b128 v[152:155], v23
    ds_read_b128 v[156:159], v24
    s_add_u32 m0, s52, 113664
    s_add_u32 s59, s50, 16384
    buffer_load_dwordx4 v17, s[8:11], s59 offen lds
    s_add_u32 s49, s49, 1
    s_and_b32 s49, s49, 7
    s_lshl_b32 s59, s49, 7
    s_add_u32 s50, s51, s59
    s_mul_i32 s59, s49, 196608
    s_add_u32 s84, s72, s59
    s_add_u32 m0, s52, 0
    s_nop 0
    buffer_load_dwordx4 v16, s[8:11], s50 offen lds
    s_add_u32 m0, s53, 16384
    s_nop 0
    buffer_load_dwordx4 v18, s[12:15], s84 offen lds
    v_add_u32 v21, 0x9000, v21
    s_add_u32 m0, s53, 24576
    s_add_u32 s59, s84, 1024
    buffer_load_dwordx4 v18, s[12:15], s59 offen lds
    v_add_u32 v22, 0x9000, v22
    s_add_u32 m0, s52, 2048
    s_add_u32 s59, s50, 16384
    buffer_load_dwordx4 v16, s[8:11], s59 offen lds
    v_add_u32 v23, 0x9000, v23
    s_add_u32 m0, s52, 1024
    s_nop 0
    buffer_load_dwordx4 v17, s[8:11], s50 offen lds
    v_add_u32 v24, 0x9000, v24
    s_add_u32 m0, s53, 17408
    s_add_u32 s59, s84, 24576
    buffer_load_dwordx4 v18, s[12:15], s59 offen lds
    s_add_u32 m0, s53, 25600
    s_add_u32 s59, s84, 25600
    buffer_load_dwordx4 v18, s[12:15], s59 offen lds
    s_mov_b32 s66, 0x3fb8aa3b
    s_mov_b32 s67, 0x358637bd
    s_mov_b32 s68, 0.5
    s_mov_b32 s70, 0x3fb8aa3b
    s_mov_b32 s69, 0.5
    s_mov_b32 s71, 0x3fb8aa3b
    s_mov_b32 s4, 0x7060500
    s_mov_b32 s5, 0x7060501
    s_mov_b32 s6, 0x7060502
    s_mov_b32 s7, 0x7060503
    s_and_b32 s47, s2, 1
    s_bfe_u32 s60, s2, 0x10001
    s_lshl1_add_u32 s47, s47, s60
    s_bfe_u32 s60, s2, 0x20003
    s_lshl2_add_u32 s47, s47, s60
    s_lshl1_add_u32 s47, s47, s45
    s_and_b32 s48, s43, 3
    v_and_b32 v14, 7, v1
    v_lshlrev_b32 v10, 2, v14
    v_add_u32 v10, 147456, v10
    v_bfe_u32 v15, v1, 4, 1
    v_lshlrev_b32 v15, 2, v15
    v_xor_b32 v14, v14, v15
    v_lshlrev_b32 v14, 4, v14
    v_lshrrev_b32 v15, 3, v1
    v_lshl_add_u32 v20, v15, 10, v14
    s_lshl_b32 s60, s45, 2
    s_add_u32 s60, s60, s41
    s_lshl_b32 s61, s46, 7
    s_mul_i32 s57, s60, 229376
    s_add_u32 s57, s57, s61
    s_lshl_b32 s58, s60, 16
    s_add_u32 s58, s58, s61
    s_waitcnt vmcnt(7)
    s_waitcnt lgkmcnt(0)
    s_barrier
    ds_read_b128 v[160:163], v21
    ds_read_b128 v[164:167], v22
    ds_read_b128 v[168:171], v23
    ds_read_b128 v[172:175], v24
    s_add_u32 m0, s52, 3072
    s_add_u32 s59, s50, 16384
    buffer_load_dwordx4 v17, s[8:11], s59 offen lds
    s_add_u32 s49, s49, 1
    s_and_b32 s49, s49, 7
    s_lshl_b32 s59, s49, 7
    s_add_u32 s50, s51, s59
    s_mul_i32 s59, s49, 196608
    s_add_u32 s84, s72, s59
    s_add_u32 m0, s52, 36864
    s_nop 0
    buffer_load_dwordx4 v16, s[8:11], s50 offen lds
    s_add_u32 m0, s53, 53248
    s_nop 0
    buffer_load_dwordx4 v18, s[12:15], s84 offen lds
    v_add_u32 v21, 0xfffe5000, v21
    s_add_u32 m0, s53, 61440
    s_add_u32 s59, s84, 1024
    buffer_load_dwordx4 v18, s[12:15], s59 offen lds
    v_add_u32 v22, 0xfffe5000, v22
    s_add_u32 m0, s52, 38912
    s_add_u32 s59, s50, 16384
    buffer_load_dwordx4 v16, s[8:11], s59 offen lds
    v_add_u32 v23, 0xfffe5000, v23
    s_add_u32 m0, s52, 37888
    s_nop 0
    buffer_load_dwordx4 v17, s[8:11], s50 offen lds
    v_add_u32 v24, 0xfffe5000, v24
    s_add_u32 m0, s53, 54272
    s_add_u32 s59, s84, 24576
    buffer_load_dwordx4 v18, s[12:15], s59 offen lds
    s_add_u32 m0, s53, 62464
    s_add_u32 s59, s84, 25600
    buffer_load_dwordx4 v18, s[12:15], s59 offen lds
    s_and_b32 s62, s41, 1
    s_lshl_b32 s56, s62, 15
    s_add_u32 s56, s56, s57
    s_cmp_eq_u32 s62, 0
    s_cselect_b32 s62, 196608, 0
    s_add_u32 s57, s57, s62
    s_mul_i32 s55, s41, 9216
    v_lshrrev_b32 v14, 5, v1
    v_bfe_u32 v15, v1, 2, 2
    v_lshl_add_u32 v14, v14, 2, v15
    v_lshlrev_b32 v14, 7, v14
    v_bfe_u32 v15, v1, 3, 1
    v_lshl_add_u32 v14, v15, 6, v14
    v_and_b32 v15, 1, v1
    v_lshl_add_u32 v14, v15, 5, v14
    v_and_b32 v15, 16, v1
    v_add_u32 v14, v14, v15
    v_and_b32 v15, 2, v1
    v_lshl_add_u32 v14, v15, 2, v14
    s_lshr_b32 s60, s41, 1
    s_lshl_b32 s61, s60, 6
    v_xor_b32 v14, s61, v14
    s_mul_i32 s61, s60, 18432
    v_add_u32 v4, s61, v14
    v_xor_b32 v3, 64, v4
    s_lshr_b32 s61, s40, 2
    s_lshl_b32 s61, s61, 1
    s_and_b32 s62, s41, 1
    s_add_u32 s61, s61, s62
    s_lshl_b32 s63, s47, 2
    s_add_u32 s61, s61, s63
    s_lshl_b32 s61, s61, 1
    s_add_u32 s61, s61, s60
    s_waitcnt vmcnt(7)
    s_waitcnt lgkmcnt(0)
    s_barrier
    ds_read_b128 v[176:179], v21
    ds_read_b128 v[180:183], v22
    ds_read_b128 v[184:187], v23
    ds_read_b128 v[188:191], v24
    s_add_u32 m0, s52, 39936
    s_add_u32 s59, s50, 16384
    buffer_load_dwordx4 v17, s[8:11], s59 offen lds
    s_add_u32 s49, s49, 1
    s_and_b32 s49, s49, 7
    s_lshl_b32 s59, s49, 7
    s_add_u32 s50, s51, s59
    s_mul_i32 s59, s49, 196608
    s_add_u32 s84, s72, s59
    s_add_u32 m0, s52, 73728
    s_nop 0
    buffer_load_dwordx4 v16, s[8:11], s50 offen lds
    s_add_u32 m0, s53, 90112
    s_nop 0
    buffer_load_dwordx4 v18, s[12:15], s84 offen lds
    v_add_u32 v21, 0x9000, v21
    s_add_u32 m0, s53, 98304
    s_add_u32 s59, s84, 1024
    buffer_load_dwordx4 v18, s[12:15], s59 offen lds
    v_add_u32 v22, 0x9000, v22
    s_add_u32 m0, s52, 75776
    s_add_u32 s59, s50, 16384
    buffer_load_dwordx4 v16, s[8:11], s59 offen lds
    v_add_u32 v23, 0x9000, v23
    s_add_u32 m0, s52, 74752
    s_nop 0
    buffer_load_dwordx4 v17, s[8:11], s50 offen lds
    v_add_u32 v24, 0x9000, v24
    s_add_u32 m0, s53, 91136
    s_add_u32 s59, s84, 24576
    buffer_load_dwordx4 v18, s[12:15], s59 offen lds
    s_add_u32 m0, s53, 99328
    s_add_u32 s59, s84, 25600
    buffer_load_dwordx4 v18, s[12:15], s59 offen lds
    s_lshl_b32 s61, s61, 1
    s_mul_i32 s78, s61, 14336
    s_mul_i32 s79, s61, 4096
    s_add_u32 s79, s79, 0x800000
    s_mul_i32 s80, s61, 1024
    s_add_u32 s80, s80, 0xc00000
    s_mul_i32 s81, s61, 128
    s_add_u32 s81, s81, 0xa00000
    s_lshl_b32 s82, s47, 3
    s_add_u32 s82, s82, s46
    s_lshl_b32 s82, s82, 2
    s_add_u32 s82, s82, s41
    s_cmp_lt_u32 s40, 4
    s_cselect_b32 s62, 32, 0
    s_xor_b32 s82, s82, s62
    s_mul_i32 s82, s82, 4096
    s_add_u32 s82, s82, 0xd00000
    v_bfe_u32 v14, v1, 2, 1
    v_mul_u32_u24 v6, 1024, v14
    v_and_b32 v14, 1, v1
    v_lshl_add_u32 v5, v14, 7, v6
    v_lshrrev_b32 v14, 5, v1
    v_bfe_u32 v15, v1, 2, 2
    v_lshl_add_u32 v14, v14, 3, v15
    v_lshlrev_b32 v14, 7, v14
    v_bfe_u32 v15, v1, 3, 1
    v_lshl_add_u32 v14, v15, 6, v14
    v_and_b32 v15, 16, v1
    v_lshl_add_u32 v14, v15, 1, v14
    v_and_b32 v15, 3, v1
    v_lshl_add_u32 v26, v15, 3, v14
    v_add_u32 v26, 36864, v26
    v_xor_b32 v27, 64, v26
    s_lshl1_add_u32 s61, s42, s45
    s_waitcnt vmcnt(7)
    s_waitcnt lgkmcnt(0)
    s_barrier
    ds_read_b128 v[192:195], v21
    ds_read_b128 v[196:199], v22
    ds_read_b128 v[200:203], v23
    ds_read_b128 v[204:207], v24
    buffer_load_dword v7, off, s[36:39], 0 sc1
    s_add_u32 m0, s52, 76800
    s_add_u32 s59, s50, 16384
    buffer_load_dwordx4 v17, s[8:11], s59 offen lds
    s_add_u32 s49, s49, 1
    s_and_b32 s49, s49, 7
    s_lshl_b32 s59, s49, 7
    s_add_u32 s50, s51, s59
    s_mul_i32 s59, s49, 196608
    s_add_u32 s84, s72, s59
    s_add_u32 m0, s52, 110592
    s_nop 0
    buffer_load_dwordx4 v16, s[8:11], s50 offen lds
    v_add_u32 v21, 0x9000, v21
    s_add_u32 m0, s53, 126976
    s_nop 0
    buffer_load_dwordx4 v18, s[12:15], s84 offen lds
    v_add_u32 v22, 0x9000, v22
    s_add_u32 m0, s53, 135168
    s_add_u32 s59, s84, 1024
    buffer_load_dwordx4 v18, s[12:15], s59 offen lds
    v_add_u32 v23, 0x9000, v23
    s_add_u32 m0, s52, 112640
    s_add_u32 s59, s50, 16384
    buffer_load_dwordx4 v16, s[8:11], s59 offen lds
    v_add_u32 v24, 0x9000, v24
    s_add_u32 m0, s52, 111616
    s_nop 0
    buffer_load_dwordx4 v17, s[8:11], s50 offen lds
    s_add_u32 m0, s53, 128000
    s_add_u32 s59, s84, 24576
    buffer_load_dwordx4 v18, s[12:15], s59 offen lds
    s_add_u32 m0, s53, 136192
    s_add_u32 s59, s84, 25600
    buffer_load_dwordx4 v18, s[12:15], s59 offen lds
    s_lshl2_add_u32 s61, s61, s41
    s_lshl_b32 s61, s61, 2
    s_add_u32 s61, s61, s48
    s_mul_i32 s76, s61, 1024
    s_add_u32 s76, s76, 0xc00000
    v_lshrrev_b32 v14, 5, v1
    v_bfe_u32 v15, v1, 2, 2
    v_lshl_add_u32 v14, v14, 3, v15
    v_lshlrev_b32 v14, 6, v14
    v_and_b32 v15, 16, v1
    v_lshl_add_u32 v14, v15, 1, v14
    v_and_b32 v15, 3, v1
    v_lshl_add_u32 v25, v15, 3, v14
    v_add_u32 v25, 36864, v25
    v_add_u32 v25, 0x10000, v25
    s_mul_i32 s77, s61, 14336
    s_add_u32 s77, s77, 0x2000
    v_pk_mov_b32 v[32:33], 0, 0
    v_pk_mov_b32 v[34:35], 0, 0
    v_pk_mov_b32 v[36:37], 0, 0
    v_pk_mov_b32 v[38:39], 0, 0
    v_pk_mov_b32 v[40:41], 0, 0
    v_pk_mov_b32 v[42:43], 0, 0
    v_pk_mov_b32 v[44:45], 0, 0
    v_pk_mov_b32 v[46:47], 0, 0
    v_cmp_gt_u32 vcc, 32, v1
    v_mov_b32 v14, 0x3f80
    v_and_b32 v15, 31, v1
    v_cndmask_b32 v32, 0, v14, vcc
    v_lshlrev_b32 v14, 1, v15
    v_add_u32 v14, 148480, v14
    v_add_u32 v28, s100, v14
    v_add_u32 v29, s101, v14
    s_waitcnt vmcnt(7)
    s_waitcnt lgkmcnt(0)
    s_barrier
    ds_read_u16 v36, v28
    ds_read_u16 v40, v29 offset:0
    ds_read_u16 v44, v29 offset:64
    ds_read_b128 v[208:211], v21
    ds_read_b128 v[212:215], v22
    ds_read_b128 v[216:219], v23
    ds_read_b128 v[220:223], v24
    s_add_u32 m0, s52, 113664
    s_add_u32 s59, s50, 16384
    buffer_load_dwordx4 v17, s[8:11], s59 offen lds
    s_add_u32 s49, s49, 1
    s_and_b32 s49, s49, 7
    s_lshl_b32 s59, s49, 7
    s_add_u32 s50, s51, s59
    s_mul_i32 s59, s49, 196608
    s_add_u32 s84, s72, s59
    s_add_u32 m0, s52, 0
    s_nop 0
    buffer_load_dwordx4 v16, s[8:11], s50 offen lds
    s_waitcnt lgkmcnt(4)
    s_add_u32 m0, s53, 16384
    s_nop 0
    buffer_load_dwordx4 v18, s[12:15], s84 offen lds
    v_mfma_f32_32x32x16_bf16 v[84:99], v[40:43], v[32:35], 0
    v_mfma_f32_32x32x16_bf16 v[100:115], v[44:47], v[32:35], 0
    s_add_u32 m0, s53, 24576
    s_add_u32 s59, s84, 1024
    buffer_load_dwordx4 v18, s[12:15], s59 offen lds
    v_mfma_f32_32x32x16_bf16 v[68:83], v[36:39], v[32:35], 0
    s_add_u32 m0, s52, 2048
    s_add_u32 s59, s50, 16384
    buffer_load_dwordx4 v16, s[8:11], s59 offen lds
    v_add_u32 v21, 0x9000, v21
    v_add_u32 v22, 0x9000, v22
    s_add_u32 m0, s52, 1024
    s_nop 0
    buffer_load_dwordx4 v17, s[8:11], s50 offen lds
    v_add_u32 v23, 0x9000, v23
    v_add_u32 v24, 0x9000, v24
    s_add_u32 m0, s53, 17408
    s_add_u32 s59, s84, 24576
    buffer_load_dwordx4 v18, s[12:15], s59 offen lds
    s_add_u32 m0, s53, 25600
    s_add_u32 s59, s84, 25600
    buffer_load_dwordx4 v18, s[12:15], s59 offen lds
    s_waitcnt vmcnt(7)
    s_waitcnt lgkmcnt(0)
    s_barrier
    ds_read_b128 v[224:227], v21
    ds_read_b128 v[228:231], v22
    ds_read_b128 v[232:235], v23
    ds_read_b128 v[236:239], v24
    s_add_u32 m0, s52, 3072
    s_add_u32 s59, s50, 16384
    buffer_load_dwordx4 v17, s[8:11], s59 offen lds
    s_mov_b32 s49, s3
    s_mul_i32 s59, s49, 229376
    s_add_u32 s84, s73, s59
    s_add_u32 m0, s53, 36864
    s_nop 0
    buffer_load_dwordx4 v30, s[88:91], s84 offen lds
    s_add_u32 m0, s53, 37888
    s_add_u32 s59, s84, 28672
    buffer_load_dwordx4 v30, s[88:91], s59 offen lds
    v_add_u32 v21, 0xfffe5000, v21
    s_add_u32 s49, s49, 1
    s_and_b32 s49, s49, 7
    s_mul_i32 s59, s49, 229376
    s_add_u32 s84, s73, s59
    s_add_u32 m0, s53, 45056
    s_nop 0
    buffer_load_dwordx4 v30, s[88:91], s84 offen lds
    v_add_u32 v22, 0xfffe5000, v22
    s_add_u32 m0, s53, 46080
    s_add_u32 s59, s84, 28672
    buffer_load_dwordx4 v30, s[88:91], s59 offen lds
    v_add_u32 v23, 0xfffe5000, v23
    s_add_u32 s49, s49, 1
    s_and_b32 s49, s49, 7
    s_mul_i32 s59, s49, 229376
    s_add_u32 s84, s73, s59
    s_add_u32 m0, s53, 53248
    s_nop 0
    buffer_load_dwordx4 v30, s[88:91], s84 offen lds
    v_add_u32 v24, 0xfffe5000, v24
    s_add_u32 m0, s53, 54272
    s_add_u32 s59, s84, 28672
    buffer_load_dwordx4 v30, s[88:91], s59 offen lds
    s_add_u32 s49, s49, 1
    s_and_b32 s49, s49, 7
    s_mul_i32 s59, s49, 229376
    s_add_u32 s84, s73, s59
    s_add_u32 m0, s53, 61440
    s_nop 0
    buffer_load_dwordx4 v30, s[88:91], s84 offen lds
L_tagq:
    v_readfirstlane_b32 s64, v7
    s_cmp_eq_u32 s64, 0
    s_cbranch_scc1 L_tagsq
L_tagkq:
    ds_write_b32 v10, v7 offset:64
    v_readfirstlane_b32 s64, v7
    s_bfe_u32 s96, s64, 0x80000
    s_bfe_u32 s97, s64, 0x80008
    s_bfe_u32 s98, s64, 0x80010
    s_bfe_u32 s99, s64, 0x80018
    s_waitcnt vmcnt(7)
    s_waitcnt lgkmcnt(0)
    s_barrier
    ds_read_b128 v[240:243], v21
    ds_read_b128 v[244:247], v22
    ds_read_b128 v[248:251], v23
    ds_read_b128 v[252:255], v24
    s_add_u32 m0, s53, 62464
    s_add_u32 s59, s84, 28672
    buffer_load_dwordx4 v30, s[88:91], s59 offen lds
    s_add_u32 s49, s49, 1
    s_and_b32 s49, s49, 7
    s_mul_i32 s59, s49, 229376
    s_add_u32 s84, s73, s59
    s_add_u32 m0, s53, 69632
    s_nop 0
    buffer_load_dwordx4 v30, s[88:91], s84 offen lds
    s_add_u32 m0, s53, 70656
    s_add_u32 s59, s84, 28672
    buffer_load_dwordx4 v30, s[88:91], s59 offen lds
    s_add_u32 s49, s49, 1
    s_and_b32 s49, s49, 7
    s_mul_i32 s59, s49, 229376
    s_add_u32 s84, s73, s59
    s_add_u32 m0, s53, 77824
    s_nop 0
    buffer_load_dwordx4 v30, s[88:91], s84 offen lds
    s_add_u32 m0, s53, 78848
    s_add_u32 s59, s84, 28672
    buffer_load_dwordx4 v30, s[88:91], s59 offen lds
    s_add_u32 s49, s49, 1
    s_and_b32 s49, s49, 7
    s_mul_i32 s59, s49, 229376
    s_add_u32 s84, s73, s59
    s_add_u32 m0, s53, 86016
    s_nop 0
    buffer_load_dwordx4 v30, s[88:91], s84 offen lds
    s_add_u32 m0, s53, 87040
    s_add_u32 s59, s84, 28672
    buffer_load_dwordx4 v30, s[88:91], s59 offen lds
    s_add_u32 s49, s49, 1
    s_and_b32 s49, s49, 7
    s_mul_i32 s59, s49, 229376
    s_add_u32 s84, s73, s59
    s_add_u32 m0, s53, 94208
    s_nop 0
    buffer_load_dwordx4 v30, s[88:91], s84 offen lds
    s_waitcnt vmcnt(9)
    s_waitcnt lgkmcnt(0)
    s_barrier
    s_setprio 2
    ds_read_b64_tr_b16 v[32:33], v26 offset:0
    ds_read_b64_tr_b16 v[34:35], v26 offset:512
    ds_read_b64_tr_b16 v[36:37], v27 offset:0
    ds_read_b64_tr_b16 v[38:39], v27 offset:512
    ds_read_b64_tr_b16 v[40:41], v26 offset:2048
    ds_read_b64_tr_b16 v[42:43], v26 offset:2560
    ds_read_b64_tr_b16 v[44:45], v27 offset:2048
    ds_read_b64_tr_b16 v[46:47], v27 offset:2560
    s_waitcnt lgkmcnt(4)
    v_mfma_f32_32x32x16_bf16 v[84:99], v[32:35], v[128:131], v[84:99]
    ds_read_b64_tr_b16 v[48:49], v26 offset:4096
    ds_read_b64_tr_b16 v[50:51], v26 offset:4608
    s_add_u32 m0, s53, 95232
    s_add_u32 s59, s84, 28672
    buffer_load_dwordx4 v30, s[88:91], s59 offen lds
    v_mfma_f32_32x32x16_bf16 v[100:115], v[36:39], v[128:131], v[100:115]
    ds_read_b64_tr_b16 v[52:53], v27 offset:4096
    ds_read_b64_tr_b16 v[54:55], v27 offset:4608
    s_waitcnt lgkmcnt(4)
    v_mfma_f32_32x32x16_bf16 v[84:99], v[40:43], v[132:135], v[84:99]
    ds_read_b64_tr_b16 v[32:33], v26 offset:6144
    ds_read_b64_tr_b16 v[34:35], v26 offset:6656
    s_mov_b32 s49, s3
    s_mul_i32 s59, s49, 229376
    s_add_u32 s84, s74, s59
    s_add_u32 m0, s54, 102400
    s_nop 0
    buffer_load_dwordx4 v19, s[88:91], s84 offen lds
    v_mfma_f32_32x32x16_bf16 v[100:115], v[44:47], v[132:135], v[100:115]
    ds_read_b64_tr_b16 v[36:37], v27 offset:6144
    ds_read_b64_tr_b16 v[38:39], v27 offset:6656
    s_waitcnt lgkmcnt(4)
    v_mfma_f32_32x32x16_bf16 v[84:99], v[48:51], v[136:139], v[84:99]
    ds_read_b64_tr_b16 v[40:41], v26 offset:8192
    ds_read_b64_tr_b16 v[42:43], v26 offset:8704
    s_add_u32 s49, s49, 1
    s_and_b32 s49, s49, 7
    s_mul_i32 s59, s49, 229376
    s_add_u32 s84, s74, s59
    s_add_u32 m0, s54, 106496
    s_nop 0
    buffer_load_dwordx4 v19, s[88:91], s84 offen lds
    v_mfma_f32_32x32x16_bf16 v[100:115], v[52:55], v[136:139], v[100:115]
    ds_read_b64_tr_b16 v[44:45], v27 offset:8192
    ds_read_b64_tr_b16 v[46:47], v27 offset:8704
    s_waitcnt lgkmcnt(4)
    v_mfma_f32_32x32x16_bf16 v[84:99], v[32:35], v[140:143], v[84:99]
    ds_read_b64_tr_b16 v[48:49], v26 offset:10240
    ds_read_b64_tr_b16 v[50:51], v26 offset:10752
    s_add_u32 s49, s49, 1
    s_and_b32 s49, s49, 7
    s_mul_i32 s59, s49, 229376
    s_add_u32 s84, s74, s59
    s_add_u32 m0, s54, 110592
    s_nop 0
    buffer_load_dwordx4 v19, s[88:91], s84 offen lds
    v_mfma_f32_32x32x16_bf16 v[100:115], v[36:39], v[140:143], v[100:115]
    ds_read_b64_tr_b16 v[52:53], v27 offset:10240
    ds_read_b64_tr_b16 v[54:55], v27 offset:10752
    s_waitcnt lgkmcnt(4)
    v_mfma_f32_32x32x16_bf16 v[84:99], v[40:43], v[144:147], v[84:99]
    ds_read_b64_tr_b16 v[32:33], v26 offset:12288
    ds_read_b64_tr_b16 v[34:35], v26 offset:12800
    s_add_u32 s49, s49, 1
    s_and_b32 s49, s49, 7
    s_mul_i32 s59, s49, 229376
    s_add_u32 s84, s74, s59
    s_add_u32 m0, s54, 114688
    s_nop 0
    buffer_load_dwordx4 v19, s[88:91], s84 offen lds
    v_mfma_f32_32x32x16_bf16 v[100:115], v[44:47], v[144:147], v[100:115]
    ds_read_b64_tr_b16 v[36:37], v27 offset:12288
    ds_read_b64_tr_b16 v[38:39], v27 offset:12800
    s_waitcnt lgkmcnt(4)
    v_mfma_f32_32x32x16_bf16 v[84:99], v[48:51], v[148:151], v[84:99]
    ds_read_b64_tr_b16 v[40:41], v26 offset:14336
    ds_read_b64_tr_b16 v[42:43], v26 offset:14848
    s_add_u32 s49, s49, 1
    s_and_b32 s49, s49, 7
    s_mul_i32 s59, s49, 229376
    s_add_u32 s84, s74, s59
    s_add_u32 m0, s54, 118784
    s_nop 0
    buffer_load_dwordx4 v19, s[88:91], s84 offen lds
    v_mfma_f32_32x32x16_bf16 v[100:115], v[52:55], v[148:151], v[100:115]
    ds_read_b64_tr_b16 v[44:45], v27 offset:14336
    ds_read_b64_tr_b16 v[46:47], v27 offset:14848
    s_waitcnt lgkmcnt(4)
    v_mfma_f32_32x32x16_bf16 v[84:99], v[32:35], v[152:155], v[84:99]
    ds_read_b64_tr_b16 v[48:49], v26 offset:16384
    ds_read_b64_tr_b16 v[50:51], v26 offset:16896
    s_add_u32 s49, s49, 1
    s_and_b32 s49, s49, 7
    s_mul_i32 s59, s49, 229376
    s_add_u32 s84, s74, s59
    s_add_u32 m0, s54, 122880
    s_nop 0
    buffer_load_dwordx4 v19, s[88:91], s84 offen lds
    v_mfma_f32_32x32x16_bf16 v[100:115], v[36:39], v[152:155], v[100:115]
    ds_read_b64_tr_b16 v[52:53], v27 offset:16384
    ds_read_b64_tr_b16 v[54:55], v27 offset:16896
    s_waitcnt lgkmcnt(4)
    v_mfma_f32_32x32x16_bf16 v[84:99], v[40:43], v[156:159], v[84:99]
    ds_read_b64_tr_b16 v[32:33], v26 offset:18432
    ds_read_b64_tr_b16 v[34:35], v26 offset:18944
    s_add_u32 s49, s49, 1
    s_and_b32 s49, s49, 7
    s_mul_i32 s59, s49, 229376
    s_add_u32 s84, s74, s59
    s_add_u32 m0, s54, 126976
    s_nop 0
    buffer_load_dwordx4 v19, s[88:91], s84 offen lds
    v_mfma_f32_32x32x16_bf16 v[100:115], v[44:47], v[156:159], v[100:115]
    ds_read_b64_tr_b16 v[36:37], v27 offset:18432
    ds_read_b64_tr_b16 v[38:39], v27 offset:18944
    s_waitcnt vmcnt(7)
    v_mov_b32 v12, 1
    ds_write_b32 v11, v12
    s_waitcnt lgkmcnt(5)
    v_mfma_f32_32x32x16_bf16 v[84:99], v[48:51], v[160:163], v[84:99]
    ds_read_b64_tr_b16 v[40:41], v26 offset:20480
    ds_read_b64_tr_b16 v[42:43], v26 offset:20992
    s_add_u32 s49, s49, 1
    s_and_b32 s49, s49, 7
    s_mul_i32 s59, s49, 229376
    s_add_u32 s84, s74, s59
    s_add_u32 m0, s54, 131072
    s_nop 0
    buffer_load_dwordx4 v19, s[88:91], s84 offen lds
    v_mfma_f32_32x32x16_bf16 v[100:115], v[52:55], v[160:163], v[100:115]
    ds_read_b64_tr_b16 v[44:45], v27 offset:20480
    ds_read_b64_tr_b16 v[46:47], v27 offset:20992
    s_waitcnt lgkmcnt(5)
    v_mfma_f32_32x32x16_bf16 v[84:99], v[32:35], v[164:167], v[84:99]
    ds_read_b64_tr_b16 v[48:49], v26 offset:22528
    ds_read_b64_tr_b16 v[50:51], v26 offset:23040
    v_mfma_f32_32x32x16_bf16 v[100:115], v[36:39], v[164:167], v[100:115]
    ds_read_b64_tr_b16 v[52:53], v27 offset:22528
    ds_read_b64_tr_b16 v[54:55], v27 offset:23040
    ds_read_b32 v15, v10
    s_waitcnt lgkmcnt(0)
L_pc8:
    v_cmp_gt_u32 vcc, 1, v15
    s_and_b32 s60, vcc_lo, 240
    s_cbranch_scc0 L_pk8
    s_add_u32 s65, s65, 1
    s_sleep 1
    ds_read_b32 v15, v10
    s_cmp_gt_u32 s65, 1600000
    s_waitcnt lgkmcnt(0)
    s_cbranch_scc0 L_pc8
L_pk8:
    v_mfma_f32_32x32x16_bf16 v[84:99], v[40:43], v[168:171], v[84:99]
    ds_read_b64_tr_b16 v[32:33], v26 offset:24576
    ds_read_b64_tr_b16 v[34:35], v26 offset:25088
    v_mfma_f32_32x32x16_bf16 v[100:115], v[44:47], v[168:171], v[100:115]
    ds_read_b64_tr_b16 v[36:37], v27 offset:24576
    ds_read_b64_tr_b16 v[38:39], v27 offset:25088
    v_mfma_f32_32x32x16_bf16 v[84:99], v[48:51], v[172:175], v[84:99]
    ds_read_b64_tr_b16 v[40:41], v26 offset:26624
    ds_read_b64_tr_b16 v[42:43], v26 offset:27136
    v_mfma_f32_32x32x16_bf16 v[100:115], v[52:55], v[172:175], v[100:115]
    ds_read_b64_tr_b16 v[44:45], v27 offset:26624
    ds_read_b64_tr_b16 v[46:47], v27 offset:27136
    s_waitcnt lgkmcnt(4)
    v_mfma_f32_32x32x16_bf16 v[84:99], v[32:35], v[176:179], v[84:99]
    ds_read_b64_tr_b16 v[48:49], v26 offset:28672
    ds_read_b64_tr_b16 v[50:51], v26 offset:29184
    v_mfma_f32_32x32x16_bf16 v[100:115], v[36:39], v[176:179], v[100:115]
    ds_read_b64_tr_b16 v[52:53], v27 offset:28672
    ds_read_b64_tr_b16 v[54:55], v27 offset:29184
    s_waitcnt lgkmcnt(4)
    v_mfma_f32_32x32x16_bf16 v[84:99], v[40:43], v[180:183], v[84:99]
    ds_read_b64_tr_b16 v[32:33], v26 offset:30720
    ds_read_b64_tr_b16 v[34:35], v26 offset:31232
    v_mfma_f32_32x32x16_bf16 v[100:115], v[44:47], v[180:183], v[100:115]
    ds_read_b64_tr_b16 v[36:37], v27 offset:30720
    ds_read_b64_tr_b16 v[38:39], v27 offset:31232
    s_waitcnt lgkmcnt(4)
    v_mfma_f32_32x32x16_bf16 v[84:99], v[48:51], v[184:187], v[84:99]
    ds_read_b64_tr_b16 v[40:41], v26 offset:32768
    ds_read_b64_tr_b16 v[42:43], v26 offset:33280
    v_mfma_f32_32x32x16_bf16 v[100:115], v[52:55], v[184:187], v[100:115]
    ds_read_b64_tr_b16 v[44:45], v27 offset:32768
    ds_read_b64_tr_b16 v[46:47], v27 offset:33280
    s_waitcnt lgkmcnt(4)
    v_mfma_f32_32x32x16_bf16 v[84:99], v[32:35], v[188:191], v[84:99]
    ds_read_b64_tr_b16 v[48:49], v26 offset:34816
    ds_read_b64_tr_b16 v[50:51], v26 offset:35328
    v_mfma_f32_32x32x16_bf16 v[100:115], v[36:39], v[188:191], v[100:115]
    ds_read_b64_tr_b16 v[52:53], v27 offset:34816
    ds_read_b64_tr_b16 v[54:55], v27 offset:35328
    s_waitcnt lgkmcnt(4)
    v_mfma_f32_32x32x16_bf16 v[84:99], v[40:43], v[192:195], v[84:99]
    ds_read_b64_tr_b16 v[32:33], v26 offset:36864
    ds_read_b64_tr_b16 v[34:35], v26 offset:37376
    v_mfma_f32_32x32x16_bf16 v[100:115], v[44:47], v[192:195], v[100:115]
    ds_read_b64_tr_b16 v[36:37], v27 offset:36864
    ds_read_b64_tr_b16 v[38:39], v27 offset:37376
    s_waitcnt lgkmcnt(4)
    v_mov_b32 v12, 2
    ds_write_b32 v11, v12
    v_mfma_f32_32x32x16_bf16 v[84:99], v[48:51], v[196:199], v[84:99]
    ds_read_b64_tr_b16 v[40:41], v26 offset:38912
    ds_read_b64_tr_b16 v[42:43], v26 offset:39424
    v_mfma_f32_32x32x16_bf16 v[100:115], v[52:55], v[196:199], v[100:115]
    ds_read_b64_tr_b16 v[44:45], v27 offset:38912
    ds_read_b64_tr_b16 v[46:47], v27 offset:39424
    s_waitcnt lgkmcnt(5)
    v_mfma_f32_32x32x16_bf16 v[84:99], v[32:35], v[200:203], v[84:99]
    ds_read_b64_tr_b16 v[48:49], v26 offset:40960
    ds_read_b64_tr_b16 v[50:51], v26 offset:41472
    v_mfma_f32_32x32x16_bf16 v[100:115], v[36:39], v[200:203], v[100:115]
    ds_read_b64_tr_b16 v[52:53], v27 offset:40960
    ds_read_b64_tr_b16 v[54:55], v27 offset:41472
    s_waitcnt lgkmcnt(4)
    v_mfma_f32_32x32x16_bf16 v[84:99], v[40:43], v[204:207], v[84:99]
    ds_read_b64_tr_b16 v[32:33], v26 offset:43008
    ds_read_b64_tr_b16 v[34:35], v26 offset:43520
    v_mfma_f32_32x32x16_bf16 v[100:115], v[44:47], v[204:207], v[100:115]
    ds_read_b64_tr_b16 v[36:37], v27 offset:43008
    ds_read_b64_tr_b16 v[38:39], v27 offset:43520
    s_waitcnt lgkmcnt(4)
    v_mfma_f32_32x32x16_bf16 v[84:99], v[48:51], v[208:211], v[84:99]
    ds_read_b64_tr_b16 v[40:41], v26 offset:45056
    ds_read_b64_tr_b16 v[42:43], v26 offset:45568
    v_mfma_f32_32x32x16_bf16 v[100:115], v[52:55], v[208:211], v[100:115]
    ds_read_b64_tr_b16 v[44:45], v27 offset:45056
    ds_read_b64_tr_b16 v[46:47], v27 offset:45568
    s_waitcnt lgkmcnt(4)
    v_mfma_f32_32x32x16_bf16 v[84:99], v[32:35], v[212:215], v[84:99]
    ds_read_b64_tr_b16 v[48:49], v26 offset:47104
    ds_read_b64_tr_b16 v[50:51], v26 offset:47616
    v_mfma_f32_32x32x16_bf16 v[100:115], v[36:39], v[212:215], v[100:115]
    ds_read_b64_tr_b16 v[52:53], v27 offset:47104
    ds_read_b64_tr_b16 v[54:55], v27 offset:47616
    s_waitcnt lgkmcnt(4)
    v_mfma_f32_32x32x16_bf16 v[84:99], v[40:43], v[216:219], v[84:99]
    ds_read_b64_tr_b16 v[32:33], v26 offset:49152
    ds_read_b64_tr_b16 v[34:35], v26 offset:49664
    v_mfma_f32_32x32x16_bf16 v[100:115], v[44:47], v[216:219], v[100:115]
    ds_read_b64_tr_b16 v[36:37], v27 offset:49152
    ds_read_b64_tr_b16 v[38:39], v27 offset:49664
    s_waitcnt lgkmcnt(4)
    v_mfma_f32_32x32x16_bf16 v[84:99], v[48:51], v[220:223], v[84:99]
    ds_read_b64_tr_b16 v[40:41], v26 offset:51200
    ds_read_b64_tr_b16 v[42:43], v26 offset:51712
    v_mfma_f32_32x32x16_bf16 v[100:115], v[52:55], v[220:223], v[100:115]
    ds_read_b64_tr_b16 v[44:45], v27 offset:51200
    ds_read_b64_tr_b16 v[46:47], v27 offset:51712
    s_waitcnt lgkmcnt(4)
    v_mfma_f32_32x32x16_bf16 v[84:99], v[32:35], v[224:227], v[84:99]
    ds_read_b64_tr_b16 v[48:49], v26 offset:53248
    ds_read_b64_tr_b16 v[50:51], v26 offset:53760
    v_mfma_f32_32x32x16_bf16 v[100:115], v[36:39], v[224:227], v[100:115]
    ds_read_b64_tr_b16 v[52:53], v27 offset:53248
    ds_read_b64_tr_b16 v[54:55], v27 offset:53760
    s_waitcnt lgkmcnt(4)
    v_mfma_f32_32x32x16_bf16 v[84:99], v[40:43], v[228:231], v[84:99]
    ds_read_b64_tr_b16 v[32:33], v26 offset:55296
    ds_read_b64_tr_b16 v[34:35], v26 offset:55808
    v_mfma_f32_32x32x16_bf16 v[100:115], v[44:47], v[228:231], v[100:115]
    ds_read_b64_tr_b16 v[36:37], v27 offset:55296
    ds_read_b64_tr_b16 v[38:39], v27 offset:55808
    s_waitcnt lgkmcnt(4)
    v_mfma_f32_32x32x16_bf16 v[84:99], v[48:51], v[232:235], v[84:99]
    ds_read_b64_tr_b16 v[40:41], v26 offset:57344
    ds_read_b64_tr_b16 v[42:43], v26 offset:57856
    v_mfma_f32_32x32x16_bf16 v[100:115], v[52:55], v[232:235], v[100:115]
    ds_read_b64_tr_b16 v[44:45], v27 offset:57344
    ds_read_b64_tr_b16 v[46:47], v27 offset:57856
    s_waitcnt lgkmcnt(4)
    v_mfma_f32_32x32x16_bf16 v[84:99], v[32:35], v[236:239], v[84:99]
    ds_read_b64_tr_b16 v[48:49], v26 offset:59392
    ds_read_b64_tr_b16 v[50:51], v26 offset:59904
    v_mfma_f32_32x32x16_bf16 v[100:115], v[36:39], v[236:239], v[100:115]
    ds_read_b64_tr_b16 v[52:53], v27 offset:59392
    ds_read_b64_tr_b16 v[54:55], v27 offset:59904
    s_waitcnt vmcnt(0)
    v_mov_b32 v12, 3
    ds_write_b32 v11, v12
    s_waitcnt lgkmcnt(5)
    v_mfma_f32_32x32x16_bf16 v[84:99], v[40:43], v[240:243], v[84:99]
    ds_read_b64_tr_b16 v[32:33], v26 offset:61440
    ds_read_b64_tr_b16 v[34:35], v26 offset:61952
    v_mfma_f32_32x32x16_bf16 v[100:115], v[44:47], v[240:243], v[100:115]
    ds_read_b64_tr_b16 v[36:37], v27 offset:61440
    ds_read_b64_tr_b16 v[38:39], v27 offset:61952
    s_waitcnt lgkmcnt(5)
    v_mfma_f32_32x32x16_bf16 v[84:99], v[48:51], v[244:247], v[84:99]
    ds_read_b64_tr_b16 v[40:41], v26 offset:63488
    ds_read_b64_tr_b16 v[42:43], v26 offset:64000
    v_mfma_f32_32x32x16_bf16 v[100:115], v[52:55], v[244:247], v[100:115]
    ds_read_b64_tr_b16 v[44:45], v27 offset:63488
    ds_read_b64_tr_b16 v[46:47], v27 offset:64000
    ds_read_b32 v15, v10
    s_waitcnt lgkmcnt(0)
L_pc9:
    v_cmp_gt_u32 vcc, 3, v15
    s_and_b32 s60, vcc_lo, 240
    s_cbranch_scc0 L_pk9
    s_add_u32 s65, s65, 1
    s_sleep 1
    ds_read_b32 v15, v10
    s_cmp_gt_u32 s65, 1600000
    s_waitcnt lgkmcnt(0)
    s_cbranch_scc0 L_pc9
L_pk9:
    v_mfma_f32_32x32x16_bf16 v[84:99], v[32:35], v[248:251], v[84:99]
    ds_read_b64_tr_b16 v[64:65], v25 offset:0
    ds_read_b64_tr_b16 v[66:67], v25 offset:256
    v_mfma_f32_32x32x16_bf16 v[100:115], v[36:39], v[248:251], v[100:115]
    v_mfma_f32_32x32x16_bf16 v[84:99], v[40:43], v[252:255], v[84:99]
    ds_read_b64_tr_b16 v[56:57], v25 offset:1024
    ds_read_b64_tr_b16 v[58:59], v25 offset:1280
    v_mfma_f32_32x32x16_bf16 v[100:115], v[44:47], v[252:255], v[100:115]
    s_waitcnt lgkmcnt(2)
    v_mfma_f32_32x32x16_bf16 v[68:83], v[64:67], v[128:131], v[68:83]
    ds_read_b64_tr_b16 v[60:61], v25 offset:2048
    ds_read_b64_tr_b16 v[62:63], v25 offset:2304
    s_nop 3
    s_add_u32 s59, s77, 2048
    v_min_u32 v14, 47, v1
    v_lshlrev_b32 v14, 7, v14
    v_mul_f32 v32, s66, v84
    v_mul_f32 v33, s66, v85
    v_mul_f32 v34, s66, v86
    v_mul_f32 v35, s66, v87
    s_waitcnt lgkmcnt(2)
    v_mfma_f32_32x32x16_bf16 v[68:83], v[56:59], v[132:135], v[68:83]
    ds_read_b64_tr_b16 v[64:65], v25 offset:3072
    ds_read_b64_tr_b16 v[66:67], v25 offset:3328
    v_mul_f32 v36, s66, v88
    v_mul_f32 v37, s66, v89
    v_mul_f32 v38, s66, v90
    v_mul_f32 v39, s66, v91
    v_exp_f32 v32, v32
    v_exp_f32 v33, v33
    v_exp_f32 v34, v34
    s_waitcnt lgkmcnt(2)
    v_mfma_f32_32x32x16_bf16 v[68:83], v[60:63], v[136:139], v[68:83]
    ds_read_b64_tr_b16 v[56:57], v25 offset:4096
    ds_read_b64_tr_b16 v[58:59], v25 offset:4352
    v_exp_f32 v35, v35
    v_exp_f32 v36, v36
    v_exp_f32 v37, v37
    v_exp_f32 v38, v38
    v_exp_f32 v39, v39
    v_fma_f32 v40, v32, 0.5, 1.0
    v_fma_f32 v41, v33, 0.5, 1.0
    s_waitcnt lgkmcnt(2)
    v_mfma_f32_32x32x16_bf16 v[68:83], v[64:67], v[140:143], v[68:83]
    ds_read_b64_tr_b16 v[60:61], v25 offset:5120
    ds_read_b64_tr_b16 v[62:63], v25 offset:5376
    v_fma_f32 v42, v34, 0.5, 1.0
    v_fma_f32 v43, v35, 0.5, 1.0
    v_fma_f32 v44, v36, 0.5, 1.0
    v_fma_f32 v45, v37, 0.5, 1.0
    v_fma_f32 v46, v38, 0.5, 1.0
    v_fma_f32 v47, v39, 0.5, 1.0
    v_fma_f32 v40, v40, v32, 1.0
    s_waitcnt lgkmcnt(2)
    v_mfma_f32_32x32x16_bf16 v[68:83], v[56:59], v[144:147], v[68:83]
    ds_read_b64_tr_b16 v[64:65], v25 offset:6144
    ds_read_b64_tr_b16 v[66:67], v25 offset:6400
    v_fma_f32 v41, v41, v33, 1.0
    v_fma_f32 v42, v42, v34, 1.0
    v_fma_f32 v43, v43, v35, 1.0
    v_fma_f32 v44, v44, v36, 1.0
    v_fma_f32 v45, v45, v37, 1.0
    v_fma_f32 v46, v46, v38, 1.0
    v_fma_f32 v47, v47, v39, 1.0
    s_waitcnt lgkmcnt(2)
    v_mfma_f32_32x32x16_bf16 v[68:83], v[60:63], v[148:151], v[68:83]
    ds_read_b64_tr_b16 v[56:57], v25 offset:7168
    ds_read_b64_tr_b16 v[58:59], v25 offset:7424
    v_rcp_f32 v40, v40
    v_rcp_f32 v41, v41
    v_rcp_f32 v42, v42
    v_rcp_f32 v43, v43
    v_rcp_f32 v44, v44
    v_rcp_f32 v45, v45
    v_rcp_f32 v46, v46
    s_waitcnt lgkmcnt(2)
    v_mfma_f32_32x32x16_bf16 v[68:83], v[64:67], v[152:155], v[68:83]
    ds_read_b64_tr_b16 v[60:61], v25 offset:8192
    ds_read_b64_tr_b16 v[62:63], v25 offset:8448
    v_rcp_f32 v47, v47
    v_fma_f32 v40, -v40, v84, v84
    v_fma_f32 v41, -v41, v85, v85
    v_fma_f32 v42, -v42, v86, v86
    v_fma_f32 v43, -v43, v87, v87
    v_fma_f32 v44, -v44, v88, v88
    v_fma_f32 v45, -v45, v89, v89
    s_waitcnt lgkmcnt(2)
    v_mov_b32 v12, 4
    ds_write_b32 v11, v12
    v_mfma_f32_32x32x16_bf16 v[68:83], v[56:59], v[156:159], v[68:83]
    ds_read_b64_tr_b16 v[64:65], v25 offset:9216
    ds_read_b64_tr_b16 v[66:67], v25 offset:9472
    v_fma_f32 v46, -v46, v90, v90
    v_fma_f32 v47, -v47, v91, v91
    v_cvt_pk_bf16_f32 v48, v40, v41
    v_cvt_pk_bf16_f32 v49, v42, v43
    v_cvt_pk_bf16_f32 v50, v44, v45
    v_cvt_pk_bf16_f32 v51, v46, v47
    buffer_store_dwordx4 v[48:51], v2, s[24:27], s59 offen offset:0 sc1
    s_waitcnt lgkmcnt(3)
    v_mfma_f32_32x32x16_bf16 v[68:83], v[60:63], v[160:163], v[68:83]
    ds_read_b64_tr_b16 v[56:57], v25 offset:10240
    ds_read_b64_tr_b16 v[58:59], v25 offset:10496
    v_mul_f32 v32, s66, v92
    v_mul_f32 v33, s66, v93
    v_mul_f32 v34, s66, v94
    v_mul_f32 v35, s66, v95
    v_mul_f32 v36, s66, v96
    v_mul_f32 v37, s66, v97
    v_mul_f32 v38, s66, v98
    s_waitcnt lgkmcnt(2)
    v_mfma_f32_32x32x16_bf16 v[68:83], v[64:67], v[164:167], v[68:83]
    ds_read_b64_tr_b16 v[60:61], v25 offset:11264
    ds_read_b64_tr_b16 v[62:63], v25 offset:11520
    v_mul_f32 v39, s66, v99
    v_exp_f32 v32, v32
    v_exp_f32 v33, v33
    v_exp_f32 v34, v34
    v_exp_f32 v35, v35
    v_exp_f32 v36, v36
    v_exp_f32 v37, v37
    s_waitcnt lgkmcnt(2)
    v_mfma_f32_32x32x16_bf16 v[68:83], v[56:59], v[168:171], v[68:83]
    ds_read_b64_tr_b16 v[64:65], v25 offset:12288
    ds_read_b64_tr_b16 v[66:67], v25 offset:12544
    v_exp_f32 v38, v38
    v_exp_f32 v39, v39
    v_fma_f32 v40, v32, 0.5, 1.0
    v_fma_f32 v41, v33, 0.5, 1.0
    v_fma_f32 v42, v34, 0.5, 1.0
    v_fma_f32 v43, v35, 0.5, 1.0
    v_fma_f32 v44, v36, 0.5, 1.0
    s_waitcnt lgkmcnt(2)
    v_mfma_f32_32x32x16_bf16 v[68:83], v[60:63], v[172:175], v[68:83]
    ds_read_b64_tr_b16 v[56:57], v25 offset:13312
    ds_read_b64_tr_b16 v[58:59], v25 offset:13568
    v_fma_f32 v45, v37, 0.5, 1.0
    v_fma_f32 v46, v38, 0.5, 1.0
    v_fma_f32 v47, v39, 0.5, 1.0
    v_fma_f32 v40, v40, v32, 1.0
    v_fma_f32 v41, v41, v33, 1.0
    v_fma_f32 v42, v42, v34, 1.0
    v_fma_f32 v43, v43, v35, 1.0
    s_waitcnt lgkmcnt(2)
    v_mfma_f32_32x32x16_bf16 v[68:83], v[64:67], v[176:179], v[68:83]
    ds_read_b64_tr_b16 v[60:61], v25 offset:14336
    ds_read_b64_tr_b16 v[62:63], v25 offset:14592
    v_fma_f32 v44, v44, v36, 1.0
    v_fma_f32 v45, v45, v37, 1.0
    v_fma_f32 v46, v46, v38, 1.0
    v_fma_f32 v47, v47, v39, 1.0
    v_rcp_f32 v40, v40
    v_rcp_f32 v41, v41
    v_rcp_f32 v42, v42
    s_waitcnt lgkmcnt(2)
    v_mfma_f32_32x32x16_bf16 v[68:83], v[56:59], v[180:183], v[68:83]
    ds_read_b64_tr_b16 v[64:65], v25 offset:15360
    ds_read_b64_tr_b16 v[66:67], v25 offset:15616
    v_rcp_f32 v43, v43
    v_rcp_f32 v44, v44
    v_rcp_f32 v45, v45
    v_rcp_f32 v46, v46
    v_rcp_f32 v47, v47
    v_fma_f32 v40, -v40, v92, v92
    v_fma_f32 v41, -v41, v93, v93
    s_waitcnt lgkmcnt(2)
    v_mfma_f32_32x32x16_bf16 v[68:83], v[60:63], v[184:187], v[68:83]
    ds_read_b64_tr_b16 v[56:57], v25 offset:16384
    ds_read_b64_tr_b16 v[58:59], v25 offset:16640
    v_fma_f32 v42, -v42, v94, v94
    v_fma_f32 v43, -v43, v95, v95
    v_fma_f32 v44, -v44, v96, v96
    v_fma_f32 v45, -v45, v97, v97
    v_fma_f32 v46, -v46, v98, v98
    v_fma_f32 v47, -v47, v99, v99
    v_cvt_pk_bf16_f32 v52, v40, v41
    s_waitcnt lgkmcnt(2)
    v_mfma_f32_32x32x16_bf16 v[68:83], v[64:67], v[188:191], v[68:83]
    ds_read_b64_tr_b16 v[60:61], v25 offset:17408
    ds_read_b64_tr_b16 v[62:63], v25 offset:17664
    v_cvt_pk_bf16_f32 v53, v42, v43
    v_cvt_pk_bf16_f32 v54, v44, v45
    v_cvt_pk_bf16_f32 v55, v46, v47
    buffer_store_dwordx4 v[52:55], v2, s[24:27], s59 offen offset:1024 sc1
    v_mul_f32 v32, s66, v100
    v_mul_f32 v33, s66, v101
    v_mul_f32 v34, s66, v102
    s_waitcnt lgkmcnt(2)
    v_mfma_f32_32x32x16_bf16 v[68:83], v[56:59], v[192:195], v[68:83]
    ds_read_b64_tr_b16 v[64:65], v25 offset:18432
    ds_read_b64_tr_b16 v[66:67], v25 offset:18688
    v_mul_f32 v35, s66, v103
    v_mul_f32 v36, s66, v104
    v_mul_f32 v37, s66, v105
    v_mul_f32 v38, s66, v106
    v_mul_f32 v39, s66, v107
    v_exp_f32 v32, v32
    v_exp_f32 v33, v33
    s_waitcnt lgkmcnt(2)
    v_mfma_f32_32x32x16_bf16 v[68:83], v[60:63], v[196:199], v[68:83]
    ds_read_b64_tr_b16 v[56:57], v25 offset:19456
    ds_read_b64_tr_b16 v[58:59], v25 offset:19712
    v_exp_f32 v34, v34
    v_exp_f32 v35, v35
    v_exp_f32 v36, v36
    v_exp_f32 v37, v37
    v_exp_f32 v38, v38
    v_exp_f32 v39, v39
    v_fma_f32 v40, v32, 0.5, 1.0
    s_waitcnt lgkmcnt(2)
    v_mfma_f32_32x32x16_bf16 v[68:83], v[64:67], v[200:203], v[68:83]
    ds_read_b64_tr_b16 v[60:61], v25 offset:20480
    ds_read_b64_tr_b16 v[62:63], v25 offset:20736
    v_fma_f32 v41, v33, 0.5, 1.0
    v_fma_f32 v42, v34, 0.5, 1.0
    v_fma_f32 v43, v35, 0.5, 1.0
    v_fma_f32 v44, v36, 0.5, 1.0
    v_fma_f32 v45, v37, 0.5, 1.0
    v_fma_f32 v46, v38, 0.5, 1.0
    v_fma_f32 v47, v39, 0.5, 1.0
    s_waitcnt lgkmcnt(2)
    v_mfma_f32_32x32x16_bf16 v[68:83], v[56:59], v[204:207], v[68:83]
    ds_read_b64_tr_b16 v[64:65], v25 offset:21504
    ds_read_b64_tr_b16 v[66:67], v25 offset:21760
    v_fma_f32 v40, v40, v32, 1.0
    v_fma_f32 v41, v41, v33, 1.0
    v_fma_f32 v42, v42, v34, 1.0
    v_fma_f32 v43, v43, v35, 1.0
    v_fma_f32 v44, v44, v36, 1.0
    v_fma_f32 v45, v45, v37, 1.0
    v_fma_f32 v46, v46, v38, 1.0
    s_waitcnt lgkmcnt(2)
    v_mfma_f32_32x32x16_bf16 v[68:83], v[60:63], v[208:211], v[68:83]
    ds_read_b64_tr_b16 v[56:57], v25 offset:22528
    ds_read_b64_tr_b16 v[58:59], v25 offset:22784
    v_fma_f32 v47, v47, v39, 1.0
    v_rcp_f32 v40, v40
    v_rcp_f32 v41, v41
    v_rcp_f32 v42, v42
    v_rcp_f32 v43, v43
    v_rcp_f32 v44, v44
    v_rcp_f32 v45, v45
    s_waitcnt lgkmcnt(2)
    v_mfma_f32_32x32x16_bf16 v[68:83], v[64:67], v[212:215], v[68:83]
    ds_read_b64_tr_b16 v[60:61], v25 offset:23552
    ds_read_b64_tr_b16 v[62:63], v25 offset:23808
    v_rcp_f32 v46, v46
    v_rcp_f32 v47, v47
    v_fma_f32 v40, -v40, v100, v100
    v_fma_f32 v41, -v41, v101, v101
    v_fma_f32 v42, -v42, v102, v102
    v_fma_f32 v43, -v43, v103, v103
    v_fma_f32 v44, -v44, v104, v104
    s_waitcnt lgkmcnt(2)
    v_mfma_f32_32x32x16_bf16 v[68:83], v[56:59], v[216:219], v[68:83]
    ds_read_b64_tr_b16 v[64:65], v25 offset:24576
    ds_read_b64_tr_b16 v[66:67], v25 offset:24832
    v_fma_f32 v45, -v45, v105, v105
    v_fma_f32 v46, -v46, v106, v106
    v_fma_f32 v47, -v47, v107, v107
    v_cvt_pk_bf16_f32 v48, v40, v41
    v_cvt_pk_bf16_f32 v49, v42, v43
    v_cvt_pk_bf16_f32 v50, v44, v45
    v_cvt_pk_bf16_f32 v51, v46, v47
    s_waitcnt lgkmcnt(2)
    v_mfma_f32_32x32x16_bf16 v[68:83], v[60:63], v[220:223], v[68:83]
    ds_read_b64_tr_b16 v[56:57], v25 offset:25600
    ds_read_b64_tr_b16 v[58:59], v25 offset:25856
    buffer_store_dwordx4 v[48:51], v2, s[24:27], s59 offen offset:2048 sc1
    v_mul_f32 v32, s66, v108
    v_mul_f32 v33, s66, v109
    v_mul_f32 v34, s66, v110
    v_mul_f32 v35, s66, v111
    v_mul_f32 v36, s66, v112
    v_mul_f32 v37, s66, v113
    s_waitcnt lgkmcnt(2)
    v_mfma_f32_32x32x16_bf16 v[68:83], v[64:67], v[224:227], v[68:83]
    ds_read_b64_tr_b16 v[60:61], v25 offset:26624
    ds_read_b64_tr_b16 v[62:63], v25 offset:26880
    v_mul_f32 v38, s66, v114
    v_mul_f32 v39, s66, v115
    v_exp_f32 v32, v32
    v_exp_f32 v33, v33
    v_exp_f32 v34, v34
    v_exp_f32 v35, v35
    v_exp_f32 v36, v36
    s_waitcnt lgkmcnt(2)
    v_mfma_f32_32x32x16_bf16 v[68:83], v[56:59], v[228:231], v[68:83]
    ds_read_b64_tr_b16 v[64:65], v25 offset:27648
    ds_read_b64_tr_b16 v[66:67], v25 offset:27904
    v_exp_f32 v37, v37
    v_exp_f32 v38, v38
    v_exp_f32 v39, v39
    v_fma_f32 v40, v32, 0.5, 1.0
    v_fma_f32 v41, v33, 0.5, 1.0
    v_fma_f32 v42, v34, 0.5, 1.0
    v_fma_f32 v43, v35, 0.5, 1.0
    s_waitcnt lgkmcnt(2)
    v_mfma_f32_32x32x16_bf16 v[68:83], v[60:63], v[232:235], v[68:83]
    ds_read_b64_tr_b16 v[56:57], v25 offset:28672
    ds_read_b64_tr_b16 v[58:59], v25 offset:28928
    v_fma_f32 v44, v36, 0.5, 1.0
    v_fma_f32 v45, v37, 0.5, 1.0
    v_fma_f32 v46, v38, 0.5, 1.0
    v_fma_f32 v47, v39, 0.5, 1.0
    v_fma_f32 v40, v40, v32, 1.0
    v_fma_f32 v41, v41, v33, 1.0
    v_fma_f32 v42, v42, v34, 1.0
    s_waitcnt lgkmcnt(2)
    v_mfma_f32_32x32x16_bf16 v[68:83], v[64:67], v[236:239], v[68:83]
    ds_read_b64_tr_b16 v[60:61], v25 offset:29696
    ds_read_b64_tr_b16 v[62:63], v25 offset:29952
    v_fma_f32 v43, v43, v35, 1.0
    v_fma_f32 v44, v44, v36, 1.0
    v_fma_f32 v45, v45, v37, 1.0
    v_fma_f32 v46, v46, v38, 1.0
    v_fma_f32 v47, v47, v39, 1.0
    v_rcp_f32 v40, v40
    v_rcp_f32 v41, v41
    s_waitcnt lgkmcnt(2)
    v_mfma_f32_32x32x16_bf16 v[68:83], v[56:59], v[240:243], v[68:83]
    ds_read_b64_tr_b16 v[64:65], v25 offset:30720
    ds_read_b64_tr_b16 v[66:67], v25 offset:30976
    v_rcp_f32 v42, v42
    v_rcp_f32 v43, v43
    v_rcp_f32 v44, v44
    v_rcp_f32 v45, v45
    v_rcp_f32 v46, v46
    v_rcp_f32 v47, v47
    v_fma_f32 v40, -v40, v108, v108
    s_waitcnt lgkmcnt(2)
    v_mfma_f32_32x32x16_bf16 v[68:83], v[60:63], v[244:247], v[68:83]
    ds_read_b64_tr_b16 v[56:57], v25 offset:31744
    ds_read_b64_tr_b16 v[58:59], v25 offset:32000
    v_fma_f32 v41, -v41, v109, v109
    v_fma_f32 v42, -v42, v110, v110
    v_fma_f32 v43, -v43, v111, v111
    v_fma_f32 v44, -v44, v112, v112
    v_fma_f32 v45, -v45, v113, v113
    v_fma_f32 v46, -v46, v114, v114
    v_fma_f32 v47, -v47, v115, v115
    s_waitcnt lgkmcnt(2)
    v_mfma_f32_32x32x16_bf16 v[68:83], v[64:67], v[248:251], v[68:83]
    v_cvt_pk_bf16_f32 v52, v40, v41
    v_cvt_pk_bf16_f32 v53, v42, v43
    v_cvt_pk_bf16_f32 v54, v44, v45
    v_cvt_pk_bf16_f32 v55, v46, v47
    buffer_store_dwordx4 v[52:55], v2, s[24:27], s59 offen offset:3072 sc1
    s_waitcnt lgkmcnt(0)
    v_mov_b32 v12, 5
    ds_write_b32 v11, v12
    v_mfma_f32_32x32x16_bf16 v[68:83], v[56:59], v[252:255], v[68:83]
    s_nop 11
    v_pk_mul_f32 v[32:33], v[68:69], s[70:71]
    v_pk_mul_f32 v[34:35], v[70:71], s[70:71]
    v_pk_mul_f32 v[36:37], v[72:73], s[70:71]
    v_pk_mul_f32 v[38:39], v[74:75], s[70:71]
    v_exp_f32 v32, v32
    v_exp_f32 v33, v33
    v_exp_f32 v34, v34
    v_exp_f32 v35, v35
    v_exp_f32 v36, v36
    v_exp_f32 v37, v37
    v_exp_f32 v38, v38
    v_exp_f32 v39, v39
    v_pk_fma_f32 v[40:41], v[32:33], s[68:69], 1.0 op_sel_hi:[1,1,0]
    v_pk_fma_f32 v[42:43], v[34:35], s[68:69], 1.0 op_sel_hi:[1,1,0]
    v_pk_fma_f32 v[44:45], v[36:37], s[68:69], 1.0 op_sel_hi:[1,1,0]
    v_pk_fma_f32 v[46:47], v[38:39], s[68:69], 1.0 op_sel_hi:[1,1,0]
    v_pk_fma_f32 v[40:41], v[40:41], v[32:33], 1.0 op_sel_hi:[1,1,0]
    v_pk_fma_f32 v[42:43], v[42:43], v[34:35], 1.0 op_sel_hi:[1,1,0]
    v_pk_fma_f32 v[44:45], v[44:45], v[36:37], 1.0 op_sel_hi:[1,1,0]
    v_pk_fma_f32 v[46:47], v[46:47], v[38:39], 1.0 op_sel_hi:[1,1,0]
    v_rcp_f32 v40, v40
    v_rcp_f32 v41, v41
    v_rcp_f32 v42, v42
    v_rcp_f32 v43, v43
    v_rcp_f32 v44, v44
    v_rcp_f32 v45, v45
    v_rcp_f32 v46, v46
    v_rcp_f32 v47, v47
    v_pk_fma_f32 v[40:41], v[40:41], v[68:69], v[68:69] neg_lo:[1,0,0] neg_hi:[1,0,0]
    v_pk_fma_f32 v[42:43], v[42:43], v[70:71], v[70:71] neg_lo:[1,0,0] neg_hi:[1,0,0]
    v_pk_fma_f32 v[44:45], v[44:45], v[72:73], v[72:73] neg_lo:[1,0,0] neg_hi:[1,0,0]
    v_pk_fma_f32 v[46:47], v[46:47], v[74:75], v[74:75] neg_lo:[1,0,0] neg_hi:[1,0,0]
    v_cvt_pk_bf16_f32 v48, v40, v41
    v_cvt_pk_bf16_f32 v49, v42, v43
    v_cvt_pk_bf16_f32 v50, v44, v45
    v_cvt_pk_bf16_f32 v51, v46, v47
    buffer_store_dwordx4 v[48:51], v2, s[24:27], s77 offen offset:0 sc1
    v_pk_mul_f32 v[32:33], v[76:77], s[70:71]
    v_pk_mul_f32 v[34:35], v[78:79], s[70:71]
    v_pk_mul_f32 v[36:37], v[80:81], s[70:71]
    v_pk_mul_f32 v[38:39], v[82:83], s[70:71]
    v_exp_f32 v32, v32
    v_exp_f32 v33, v33
    v_exp_f32 v34, v34
    v_exp_f32 v35, v35
    v_exp_f32 v36, v36
    v_exp_f32 v37, v37
    v_exp_f32 v38, v38
    v_exp_f32 v39, v39
    v_pk_fma_f32 v[40:41], v[32:33], s[68:69], 1.0 op_sel_hi:[1,1,0]
    v_pk_fma_f32 v[42:43], v[34:35], s[68:69], 1.0 op_sel_hi:[1,1,0]
    v_pk_fma_f32 v[44:45], v[36:37], s[68:69], 1.0 op_sel_hi:[1,1,0]
    v_pk_fma_f32 v[46:47], v[38:39], s[68:69], 1.0 op_sel_hi:[1,1,0]
    v_pk_fma_f32 v[40:41], v[40:41], v[32:33], 1.0 op_sel_hi:[1,1,0]
    v_pk_fma_f32 v[42:43], v[42:43], v[34:35], 1.0 op_sel_hi:[1,1,0]
    v_pk_fma_f32 v[44:45], v[44:45], v[36:37], 1.0 op_sel_hi:[1,1,0]
    v_pk_fma_f32 v[46:47], v[46:47], v[38:39], 1.0 op_sel_hi:[1,1,0]
    v_rcp_f32 v40, v40
    v_rcp_f32 v41, v41
    v_rcp_f32 v42, v42
    v_rcp_f32 v43, v43
    v_rcp_f32 v44, v44
    v_rcp_f32 v45, v45
    v_rcp_f32 v46, v46
    v_rcp_f32 v47, v47
    v_pk_fma_f32 v[40:41], v[40:41], v[76:77], v[76:77] neg_lo:[1,0,0] neg_hi:[1,0,0]
    v_pk_fma_f32 v[42:43], v[42:43], v[78:79], v[78:79] neg_lo:[1,0,0] neg_hi:[1,0,0]
    v_pk_fma_f32 v[44:45], v[44:45], v[80:81], v[80:81] neg_lo:[1,0,0] neg_hi:[1,0,0]
    v_pk_fma_f32 v[46:47], v[46:47], v[82:83], v[82:83] neg_lo:[1,0,0] neg_hi:[1,0,0]
    v_cvt_pk_bf16_f32 v52, v40, v41
    v_cvt_pk_bf16_f32 v53, v42, v43
    v_cvt_pk_bf16_f32 v54, v44, v45
    v_cvt_pk_bf16_f32 v55, v46, v47
    buffer_store_dwordx4 v[52:55], v2, s[24:27], s77 offen offset:1024 sc1
    v_mov_b32 v12, 6
    ds_write_b32 v11, v12
    s_load_dword s8, s[24:25], s80 offset:0 glc
    s_load_dword s9, s[24:25], s80 offset:128 glc
    s_load_dword s10, s[24:25], s80 offset:1024 glc
    s_load_dword s11, s[24:25], s80 offset:1152 glc
    s_waitcnt vmcnt(0)
    buffer_store_dword v7, off, s[24:27], s76 offset:384 sc1
    s_setprio 0
    s_sub_u32 s13, s82, 0xd00000
    s_lshr_b32 s13, s13, 5
    s_add_u32 s13, s13, 0xc80000
    s_lshl_b32 s14, s64, 11
    s_and_b32 s14, s14, 0xffff0000
    ds_read_b32 v15, v10
    s_waitcnt lgkmcnt(0)
L_pc10:
    v_cmp_gt_u32 vcc, 6, v15
    s_and_b32 s60, vcc_lo, 15
    s_cbranch_scc0 L_pk10
    s_add_u32 s65, s65, 1
    s_sleep 1
    ds_read_b32 v15, v10
    s_cmp_gt_u32 s65, 1600000
    s_waitcnt lgkmcnt(0)
    s_cbranch_scc0 L_pc10
L_pk10:
    ds_read_b64_tr_b16 v[80:81], v3 offset:0
    ds_read_b64_tr_b16 v[82:83], v3 offset:1024
    ds_read_b64_tr_b16 v[84:85], v4 offset:0
    ds_read_b64_tr_b16 v[86:87], v4 offset:1024
    ds_read_b64_tr_b16 v[88:89], v3 offset:9216
    ds_read_b64_tr_b16 v[90:91], v3 offset:10240
    ds_read_b64_tr_b16 v[92:93], v4 offset:9216
    ds_read_b64_tr_b16 v[94:95], v4 offset:10240
    ds_read_b64_tr_b16 v[96:97], v3 offset:2048
    ds_read_b64_tr_b16 v[98:99], v3 offset:3072
    ds_read_b64_tr_b16 v[100:101], v4 offset:2048
    ds_read_b64_tr_b16 v[102:103], v4 offset:3072
    ds_read_b64_tr_b16 v[104:105], v3 offset:11264
    ds_read_b64_tr_b16 v[106:107], v3 offset:12288
    ds_read_b64_tr_b16 v[108:109], v4 offset:11264
    ds_read_b64_tr_b16 v[110:111], v4 offset:12288
    s_waitcnt lgkmcnt(0)
    v_mov_b32 v12, 8
    ds_write_b32 v11, v12
    s_mov_b32 s12, 0
L_fc11:
    s_waitcnt lgkmcnt(0)
    s_xor_b32 s8, s8, s64
    s_xor_b32 s9, s9, s64
    s_xor_b32 s10, s10, s64
    s_xor_b32 s11, s11, s64
    s_or_b32 s8, s8, s10
    s_or_b32 s9, s9, s11
    s_or_b32 s8, s8, s9
    s_cbranch_scc0 L_fk11
    s_add_u32 s12, s12, 1
    s_sleep 1
    s_load_dword s8, s[24:25], s80 offset:0 glc
    s_load_dword s9, s[24:25], s80 offset:128 glc
    s_load_dword s10, s[24:25], s80 offset:1024 glc
    s_load_dword s11, s[24:25], s80 offset:1152 glc
    s_cmp_gt_u32 s12, 20
    s_cbranch_scc0 L_fc11
    s_branch L_fv11
L_fk11:
    s_add_u32 s59, s78, 0
    buffer_load_dwordx4 v[112:115], v2, s[24:27], s59 offen offset:0 sc1
    s_add_u32 s59, s78, 12288
    buffer_load_dwordx4 v[116:119], v2, s[24:27], s59 offen offset:2048 sc1
    s_add_u32 s59, s78, 0
    buffer_load_dwordx4 v[120:123], v2, s[24:27], s59 offen offset:1024 sc1
    s_add_u32 s59, s78, 12288
    buffer_load_dwordx4 v[124:127], v2, s[24:27], s59 offen offset:3072 sc1
    s_add_u32 s59, s78, 0
    buffer_load_dwordx4 v[128:131], v2, s[24:27], s59 offen offset:2048 sc1
    s_add_u32 s59, s78, 16384
    buffer_load_dwordx4 v[132:135], v2, s[24:27], s59 offen offset:0 sc1
    s_add_u32 s59, s78, 0
    buffer_load_dwordx4 v[136:139], v2, s[24:27], s59 offen offset:3072 sc1
    s_add_u32 s59, s78, 16384
    buffer_load_dwordx4 v[140:143], v2, s[24:27], s59 offen offset:1024 sc1
    s_add_u32 s59, s78, 4096
    buffer_load_dwordx4 v[144:147], v2, s[24:27], s59 offen offset:0 sc1
    s_add_u32 s59, s78, 16384
    buffer_load_dwordx4 v[148:151], v2, s[24:27], s59 offen offset:2048 sc1
    s_add_u32 s59, s78, 4096
    buffer_load_dwordx4 v[152:155], v2, s[24:27], s59 offen offset:1024 sc1
    s_add_u32 s59, s78, 16384
    buffer_load_dwordx4 v[156:159], v2, s[24:27], s59 offen offset:3072 sc1
    s_xor_b32 s60, s40, 2
    s_lshl_b32 s83, 1, s60
    v_add_u32 v5, s55, v2
    s_waitcnt vmcnt(11)
    v_mfma_f32_32x32x16_bf16 v[16:31], v[80:83], v[112:115], 0
    s_add_u32 s59, s78, 4096
    buffer_load_dwordx4 v[160:163], v2, s[24:27], s59 offen offset:2048 sc1
    v_mfma_f32_32x32x16_bf16 v[32:47], v[84:87], v[112:115], 0
    s_waitcnt vmcnt(11)
    v_mfma_f32_32x32x16_bf16 v[16:31], v[88:91], v[116:119], v[16:31]
    ds_read_b64_tr_b16 v[80:81], v3 offset:4096
    ds_read_b64_tr_b16 v[82:83], v3 offset:5120
    s_add_u32 s59, s78, 20480
    buffer_load_dwordx4 v[164:167], v2, s[24:27], s59 offen offset:0 sc1
    v_mfma_f32_32x32x16_bf16 v[32:47], v[92:95], v[116:119], v[32:47]
    ds_read_b64_tr_b16 v[84:85], v4 offset:4096
    ds_read_b64_tr_b16 v[86:87], v4 offset:5120
    s_waitcnt vmcnt(11)
    v_mfma_f32_32x32x16_bf16 v[16:31], v[96:99], v[120:123], v[16:31]
    ds_read_b64_tr_b16 v[88:89], v3 offset:13312
    ds_read_b64_tr_b16 v[90:91], v3 offset:14336
    s_add_u32 s59, s78, 4096
    buffer_load_dwordx4 v[168:171], v2, s[24:27], s59 offen offset:3072 sc1
    v_mfma_f32_32x32x16_bf16 v[32:47], v[100:103], v[120:123], v[32:47]
    ds_read_b64_tr_b16 v[92:93], v4 offset:13312
    ds_read_b64_tr_b16 v[94:95], v4 offset:14336
    s_load_dword s8, s[24:25], s80 offset:384 glc
    s_load_dword s9, s[24:25], s80 offset:1408 glc
    s_waitcnt vmcnt(11)
    v_mfma_f32_32x32x16_bf16 v[16:31], v[104:107], v[124:127], v[16:31]
    ds_read_b64_tr_b16 v[96:97], v3 offset:6144
    ds_read_b64_tr_b16 v[98:99], v3 offset:7168
    s_add_u32 s59, s78, 20480
    buffer_load_dwordx4 v[172:175], v2, s[24:27], s59 offen offset:1024 sc1
    v_mfma_f32_32x32x16_bf16 v[32:47], v[108:111], v[124:127], v[32:47]
    ds_read_b64_tr_b16 v[100:101], v4 offset:6144
    ds_read_b64_tr_b16 v[102:103], v4 offset:7168
    s_mov_b32 s12, 0
L_fc12:
    s_waitcnt lgkmcnt(0)
    s_xor_b32 s8, s8, s64
    s_xor_b32 s9, s9, s64
    s_or_b32 s8, s8, s9
    s_cbranch_scc0 L_fk12
    s_add_u32 s12, s12, 1
    s_sleep 1
    s_load_dword s8, s[24:25], s80 offset:384 glc
    s_load_dword s9, s[24:25], s80 offset:1408 glc
    s_cmp_gt_u32 s12, 20
    s_cbranch_scc0 L_fc12
    s_branch L_fv12
L_fk12:
    s_waitcnt vmcnt(11)
    v_mfma_f32_32x32x16_bf16 v[16:31], v[80:83], v[128:131], v[16:31]
    ds_read_b64_tr_b16 v[104:105], v3 offset:15360
    ds_read_b64_tr_b16 v[106:107], v3 offset:16384
    s_add_u32 s59, s78, 8192
    buffer_load_dwordx4 v[176:179], v2, s[24:27], s59 offen offset:0 sc1
    v_mfma_f32_32x32x16_bf16 v[32:47], v[84:87], v[128:131], v[32:47]
    ds_read_b64_tr_b16 v[108:109], v4 offset:15360
    ds_read_b64_tr_b16 v[110:111], v4 offset:16384
    s_waitcnt vmcnt(11)
    v_mfma_f32_32x32x16_bf16 v[16:31], v[88:91], v[132:135], v[16:31]
    ds_read_b64_tr_b16 v[80:81], v3 offset:8192
    ds_read_b64_tr_b16 v[82:83], v3 offset:36864
    s_add_u32 s59, s78, 20480
    buffer_load_dwordx4 v[180:183], v2, s[24:27], s59 offen offset:2048 sc1
    v_mfma_f32_32x32x16_bf16 v[32:47], v[92:95], v[132:135], v[32:47]
    ds_read_b64_tr_b16 v[84:85], v4 offset:8192
    ds_read_b64_tr_b16 v[86:87], v4 offset:36864
    buffer_load_dwordx4 v[128:131], v2, s[24:27], s82 offen offset:0 sc1
    buffer_load_dwordx4 v[132:135], v2, s[24:27], s82 offen offset:1024 sc1
    s_waitcnt vmcnt(13)
    v_mfma_f32_32x32x16_bf16 v[16:31], v[96:99], v[136:139], v[16:31]
    ds_read_b64_tr_b16 v[88:89], v3 offset:17408
    ds_read_b64_tr_b16 v[90:91], v3 offset:46080
    s_add_u32 s59, s78, 8192
    buffer_load_dwordx4 v[184:187], v2, s[24:27], s59 offen offset:1024 sc1
    v_mfma_f32_32x32x16_bf16 v[32:47], v[100:103], v[136:139], v[32:47]
    ds_read_b64_tr_b16 v[92:93], v4 offset:17408
    ds_read_b64_tr_b16 v[94:95], v4 offset:46080
    s_waitcnt vmcnt(13)
    s_waitcnt lgkmcnt(8)
    v_mfma_f32_32x32x16_bf16 v[16:31], v[104:107], v[140:143], v[16:31]
    ds_read_b64_tr_b16 v[96:97], v3 offset:37888
    ds_read_b64_tr_b16 v[98:99], v3 offset:38912
    s_add_u32 s59, s78, 20480
    buffer_load_dwordx4 v[188:191], v2, s[24:27], s59 offen offset:3072 sc1
    v_mfma_f32_32x32x16_bf16 v[32:47], v[108:111], v[140:143], v[32:47]
    ds_read_b64_tr_b16 v[100:101], v4 offset:37888
    ds_read_b64_tr_b16 v[102:103], v4 offset:38912
    s_waitcnt vmcnt(13)
    s_waitcnt lgkmcnt(8)
    v_mfma_f32_32x32x16_bf16 v[16:31], v[80:83], v[144:147], v[16:31]
    ds_read_b64_tr_b16 v[104:105], v3 offset:47104
    ds_read_b64_tr_b16 v[106:107], v3 offset:48128
    s_add_u32 s59, s78, 8192
    buffer_load_dwordx4 v[192:195], v2, s[24:27], s59 offen offset:2048 sc1
    v_mfma_f32_32x32x16_bf16 v[32:47], v[84:87], v[144:147], v[32:47]
    ds_read_b64_tr_b16 v[108:109], v4 offset:47104
    ds_read_b64_tr_b16 v[110:111], v4 offset:48128
    s_waitcnt vmcnt(13)
    s_waitcnt lgkmcnt(8)
    v_mfma_f32_32x32x16_bf16 v[16:31], v[88:91], v[148:151], v[16:31]
    ds_read_b64_tr_b16 v[80:81], v3 offset:39936
    ds_read_b64_tr_b16 v[82:83], v3 offset:40960
    s_add_u32 s59, s78, 24576
    buffer_load_dwordx4 v[196:199], v2, s[24:27], s59 offen offset:0 sc1
    v_mfma_f32_32x32x16_bf16 v[32:47], v[92:95], v[148:151], v[32:47]
    ds_read_b64_tr_b16 v[84:85], v4 offset:39936
    ds_read_b64_tr_b16 v[86:87], v4 offset:40960
    s_waitcnt vmcnt(13)
    s_waitcnt lgkmcnt(8)
    v_mfma_f32_32x32x16_bf16 v[16:31], v[96:99], v[152:155], v[16:31]
    ds_read_b64_tr_b16 v[88:89], v3 offset:49152
    ds_read_b64_tr_b16 v[90:91], v3 offset:50176
    s_add_u32 s59, s78, 8192
    buffer_load_dwordx4 v[200:203], v2, s[24:27], s59 offen offset:3072 sc1
    v_mfma_f32_32x32x16_bf16 v[32:47], v[100:103], v[152:155], v[32:47]
    ds_read_b64_tr_b16 v[92:93], v4 offset:49152
    ds_read_b64_tr_b16 v[94:95], v4 offset:50176
    s_load_dword s8, s[24:25], s80 offset:512 glc
    s_load_dword s9, s[24:25], s80 offset:1536 glc
    s_waitcnt vmcnt(13)
    s_waitcnt lgkmcnt(8)
    v_mov_b32 v12, 9
    ds_write_b32 v11, v12
    v_mfma_f32_32x32x16_bf16 v[16:31], v[104:107], v[156:159], v[16:31]
    ds_read_b64_tr_b16 v[96:97], v3 offset:41984
    ds_read_b64_tr_b16 v[98:99], v3 offset:43008
    s_add_u32 s59, s78, 24576
    buffer_load_dwordx4 v[204:207], v2, s[24:27], s59 offen offset:1024 sc1
    v_mfma_f32_32x32x16_bf16 v[32:47], v[108:111], v[156:159], v[32:47]
    ds_read_b64_tr_b16 v[100:101], v4 offset:41984
    ds_read_b64_tr_b16 v[102:103], v4 offset:43008
    s_mov_b32 s12, 0
L_fc13:
    s_waitcnt lgkmcnt(0)
    s_xor_b32 s8, s8, s64
    s_xor_b32 s9, s9, s64
    s_or_b32 s8, s8, s9
    s_cbranch_scc0 L_fk13
    s_add_u32 s12, s12, 1
    s_sleep 1
    s_load_dword s8, s[24:25], s80 offset:512 glc
    s_load_dword s9, s[24:25], s80 offset:1536 glc
    s_cmp_gt_u32 s12, 20
    s_cbranch_scc0 L_fc13
    s_branch L_fv13
L_fk13:
    v_and_b32 v14, 31, v1
    v_lshlrev_b32 v14, 2, v14
    buffer_load_dword v9, v14, s[24:27], s81 offen sc1
    s_waitcnt vmcnt(14)
    v_mfma_f32_32x32x16_bf16 v[16:31], v[80:83], v[160:163], v[16:31]
    ds_read_b64_tr_b16 v[104:105], v3 offset:51200
    ds_read_b64_tr_b16 v[106:107], v3 offset:52224
    s_add_u32 s59, s78, 12288
    buffer_load_dwordx4 v[208:211], v2, s[24:27], s59 offen offset:0 sc1
    v_mfma_f32_32x32x16_bf16 v[32:47], v[84:87], v[160:163], v[32:47]
    ds_read_b64_tr_b16 v[108:109], v4 offset:51200
    ds_read_b64_tr_b16 v[110:111], v4 offset:52224
    s_waitcnt vmcnt(14)
    v_mfma_f32_32x32x16_bf16 v[16:31], v[88:91], v[164:167], v[16:31]
    ds_read_b64_tr_b16 v[80:81], v3 offset:44032
    ds_read_b64_tr_b16 v[82:83], v3 offset:45056
    s_add_u32 s59, s78, 24576
    buffer_load_dwordx4 v[212:215], v2, s[24:27], s59 offen offset:2048 sc1
    v_mfma_f32_32x32x16_bf16 v[32:47], v[92:95], v[164:167], v[32:47]
    ds_read_b64_tr_b16 v[84:85], v4 offset:44032
    ds_read_b64_tr_b16 v[86:87], v4 offset:45056
    ds_read_b32 v15, v10
    s_waitcnt vmcnt(14)
    v_mfma_f32_32x32x16_bf16 v[16:31], v[96:99], v[168:171], v[16:31]
    ds_read_b64_tr_b16 v[88:89], v3 offset:53248
    ds_read_b64_tr_b16 v[90:91], v3 offset:54272
    s_add_u32 s59, s78, 12288
    buffer_load_dwordx4 v[216:219], v2, s[24:27], s59 offen offset:1024 sc1
    v_mfma_f32_32x32x16_bf16 v[32:47], v[100:103], v[168:171], v[32:47]
    ds_read_b64_tr_b16 v[92:93], v4 offset:53248
    ds_read_b64_tr_b16 v[94:95], v4 offset:54272
    s_waitcnt lgkmcnt(4)
L_pc14:
    v_cmp_gt_u32 vcc, 9, v15
    s_and_b32 s60, vcc_lo, 15
    s_cbranch_scc0 L_pk14
    s_add_u32 s65, s65, 1
    s_sleep 1
    ds_read_b32 v15, v10
    s_cmp_gt_u32 s65, 1600000
    s_waitcnt lgkmcnt(0)
    s_cbranch_scc0 L_pc14
L_pk14:
    s_waitcnt vmcnt(14)
    v_mfma_f32_32x32x16_bf16 v[16:31], v[104:107], v[172:175], v[16:31]
    v_add_u32 v3, 73728, v3
    v_add_u32 v4, 73728, v4
    ds_read_b64_tr_b16 v[96:97], v3 offset:0
    s_add_u32 s59, s78, 24576
    buffer_load_dwordx4 v[220:223], v2, s[24:27], s59 offen offset:3072 sc1
    v_mfma_f32_32x32x16_bf16 v[32:47], v[108:111], v[172:175], v[32:47]
    ds_read_b64_tr_b16 v[98:99], v3 offset:1024
    ds_read_b64_tr_b16 v[100:101], v4 offset:0
    ds_read_b64_tr_b16 v[102:103], v4 offset:1024
    s_waitcnt vmcnt(14)
    v_mfma_f32_32x32x16_bf16 v[16:31], v[80:83], v[176:179], v[16:31]
    ds_read_b64_tr_b16 v[104:105], v3 offset:9216
    ds_read_b64_tr_b16 v[106:107], v3 offset:10240
    s_add_u32 s59, s79, 0
    buffer_load_dwordx4 v[224:227], v2, s[24:27], s59 offen offset:0 sc1
    v_mfma_f32_32x32x16_bf16 v[32:47], v[84:87], v[176:179], v[32:47]
    ds_read_b64_tr_b16 v[108:109], v4 offset:9216
    ds_read_b64_tr_b16 v[110:111], v4 offset:10240
    s_waitcnt vmcnt(14)
    s_waitcnt lgkmcnt(8)
    v_mfma_f32_32x32x16_bf16 v[16:31], v[88:91], v[180:183], v[16:31]
    ds_read_b64_tr_b16 v[80:81], v3 offset:2048
    ds_read_b64_tr_b16 v[82:83], v3 offset:3072
    s_add_u32 s59, s79, 4096
    buffer_load_dwordx4 v[228:231], v2, s[24:27], s59 offen offset:0 sc1
    v_mfma_f32_32x32x16_bf16 v[32:47], v[92:95], v[180:183], v[32:47]
    ds_read_b64_tr_b16 v[84:85], v4 offset:2048
    ds_read_b64_tr_b16 v[86:87], v4 offset:3072
    s_waitcnt vmcnt(12)
    s_waitcnt lgkmcnt(8)
    v_mfma_f32_32x32x16_bf16 v[16:31], v[96:99], v[184:187], v[16:31]
    ds_read_b64_tr_b16 v[88:89], v3 offset:11264
    ds_read_b64_tr_b16 v[90:91], v3 offset:12288
    s_add_u32 s59, s79, 0
    buffer_load_dwordx4 v[232:235], v2, s[24:27], s59 offen offset:1024 sc1
    v_mfma_f32_32x32x16_bf16 v[32:47], v[100:103], v[184:187], v[32:47]
    ds_read_b64_tr_b16 v[92:93], v4 offset:11264
    ds_read_b64_tr_b16 v[94:95], v4 offset:12288
    s_waitcnt vmcnt(12)
    s_waitcnt lgkmcnt(8)
    v_mfma_f32_32x32x16_bf16 v[16:31], v[104:107], v[188:191], v[16:31]
    ds_read_b64_tr_b16 v[96:97], v3 offset:4096
    ds_read_b64_tr_b16 v[98:99], v3 offset:5120
    s_add_u32 s59, s79, 4096
    buffer_load_dwordx4 v[236:239], v2, s[24:27], s59 offen offset:1024 sc1
    v_mfma_f32_32x32x16_bf16 v[32:47], v[108:111], v[188:191], v[32:47]
    ds_read_b64_tr_b16 v[100:101], v4 offset:4096
    ds_read_b64_tr_b16 v[102:103], v4 offset:5120
    s_waitcnt vmcnt(12)
    s_waitcnt lgkmcnt(8)
    v_mfma_f32_32x32x16_bf16 v[16:31], v[80:83], v[192:195], v[16:31]
    ds_read_b64_tr_b16 v[104:105], v3 offset:13312
    ds_read_b64_tr_b16 v[106:107], v3 offset:14336
    s_add_u32 s59, s79, 0
    buffer_load_dwordx4 v[240:243], v2, s[24:27], s59 offen offset:2048 sc1
    v_mfma_f32_32x32x16_bf16 v[32:47], v[84:87], v[192:195], v[32:47]
    ds_read_b64_tr_b16 v[108:109], v4 offset:13312
    ds_read_b64_tr_b16 v[110:111], v4 offset:14336
    s_waitcnt vmcnt(12)
    s_waitcnt lgkmcnt(8)
    v_mfma_f32_32x32x16_bf16 v[16:31], v[88:91], v[196:199], v[16:31]
    ds_read_b64_tr_b16 v[80:81], v3 offset:6144
    ds_read_b64_tr_b16 v[82:83], v3 offset:7168
    s_add_u32 s59, s79, 4096
    buffer_load_dwordx4 v[244:247], v2, s[24:27], s59 offen offset:2048 sc1
    v_mfma_f32_32x32x16_bf16 v[32:47], v[92:95], v[196:199], v[32:47]
    ds_read_b64_tr_b16 v[84:85], v4 offset:6144
    ds_read_b64_tr_b16 v[86:87], v4 offset:7168
    s_waitcnt vmcnt(12)
    s_waitcnt lgkmcnt(8)
    v_mfma_f32_32x32x16_bf16 v[16:31], v[96:99], v[200:203], v[16:31]
    ds_read_b64_tr_b16 v[88:89], v3 offset:15360
    ds_read_b64_tr_b16 v[90:91], v3 offset:16384
    s_add_u32 s59, s79, 0
    buffer_load_dwordx4 v[248:251], v2, s[24:27], s59 offen offset:3072 sc1
    v_mfma_f32_32x32x16_bf16 v[32:47], v[100:103], v[200:203], v[32:47]
    ds_read_b64_tr_b16 v[92:93], v4 offset:15360
    ds_read_b64_tr_b16 v[94:95], v4 offset:16384
    s_waitcnt vmcnt(12)
    s_waitcnt lgkmcnt(8)
    v_mfma_f32_32x32x16_bf16 v[16:31], v[104:107], v[204:207], v[16:31]
    ds_read_b64_tr_b16 v[96:97], v3 offset:8192
    ds_read_b64_tr_b16 v[98:99], v3 offset:36864
    s_add_u32 s59, s79, 4096
    buffer_load_dwordx4 v[252:255], v2, s[24:27], s59 offen offset:3072 sc1
    v_mfma_f32_32x32x16_bf16 v[32:47], v[108:111], v[204:207], v[32:47]
    ds_read_b64_tr_b16 v[100:101], v4 offset:8192
    ds_read_b64_tr_b16 v[102:103], v4 offset:36864
    s_waitcnt vmcnt(11)
    s_waitcnt lgkmcnt(8)
    v_mfma_f32_32x32x16_bf16 v[16:31], v[80:83], v[208:211], v[16:31]
    ds_read_b64_tr_b16 v[104:105], v3 offset:17408
    ds_read_b64_tr_b16 v[106:107], v3 offset:46080
    v_mfma_f32_32x32x16_bf16 v[32:47], v[84:87], v[208:211], v[32:47]
    ds_read_b64_tr_b16 v[108:109], v4 offset:17408
    ds_read_b64_tr_b16 v[110:111], v4 offset:46080
    s_waitcnt vmcnt(10)
    s_waitcnt lgkmcnt(8)
    v_mfma_f32_32x32x16_bf16 v[16:31], v[88:91], v[212:215], v[16:31]
    ds_read_b64_tr_b16 v[80:81], v3 offset:37888
    ds_read_b64_tr_b16 v[82:83], v3 offset:38912
    v_mfma_f32_32x32x16_bf16 v[32:47], v[92:95], v[212:215], v[32:47]
    ds_read_b64_tr_b16 v[84:85], v4 offset:37888
    ds_read_b64_tr_b16 v[86:87], v4 offset:38912
    s_waitcnt vmcnt(9)
    s_waitcnt lgkmcnt(8)
    v_mfma_f32_32x32x16_bf16 v[16:31], v[96:99], v[216:219], v[16:31]
    ds_read_b64_tr_b16 v[88:89], v3 offset:47104
    ds_read_b64_tr_b16 v[90:91], v3 offset:48128
    v_mfma_f32_32x32x16_bf16 v[32:47], v[100:103], v[216:219], v[32:47]
    ds_read_b64_tr_b16 v[92:93], v4 offset:47104
    ds_read_b64_tr_b16 v[94:95], v4 offset:48128
    buffer_load_dword v136, off, s[24:27], s13 sc1
    s_waitcnt vmcnt(9)
    s_waitcnt lgkmcnt(8)
    v_mfma_f32_32x32x16_bf16 v[16:31], v[104:107], v[220:223], v[16:31]
    ds_read_b64_tr_b16 v[96:97], v3 offset:39936
    ds_read_b64_tr_b16 v[98:99], v3 offset:40960
    v_mfma_f32_32x32x16_bf16 v[32:47], v[108:111], v[220:223], v[32:47]
    ds_read_b64_tr_b16 v[100:101], v4 offset:39936
    ds_read_b64_tr_b16 v[102:103], v4 offset:40960
    s_waitcnt vmcnt(8)
    s_waitcnt lgkmcnt(8)
    v_mfma_f32_32x32x16_bf16 v[48:63], v[80:83], v[224:227], 0
    ds_read_b64_tr_b16 v[104:105], v3 offset:49152
    ds_read_b64_tr_b16 v[106:107], v3 offset:50176
    v_mfma_f32_32x32x16_bf16 v[64:79], v[84:87], v[224:227], 0
    ds_read_b64_tr_b16 v[108:109], v4 offset:49152
    ds_read_b64_tr_b16 v[110:111], v4 offset:50176
    s_xor_b32 s60, s41, 2
    s_mul_i32 s60, s60, 9216
    v_add_u32 v6, s60, v2
    s_waitcnt vmcnt(7)
    s_waitcnt lgkmcnt(8)
    v_mfma_f32_32x32x16_bf16 v[48:63], v[88:91], v[228:231], v[48:63]
    ds_read_b64_tr_b16 v[80:81], v3 offset:41984
    ds_read_b64_tr_b16 v[82:83], v3 offset:43008
    v_sub_f32 v8, 1.0, v9
    v_cvt_pk_bf16_f32 v8, v8, v8
    v_mfma_f32_32x32x16_bf16 v[64:79], v[92:95], v[228:231], v[64:79]
    ds_read_b64_tr_b16 v[84:85], v4 offset:41984
    ds_read_b64_tr_b16 v[86:87], v4 offset:43008
    v_and_b32 v8, 0xffff0000, v8
    v_mul_f32 v16, v16, v8
    v_mul_f32 v17, v17, v8
    v_and_b32 v14, 31, v1
    v_lshlrev_b32 v14, 10, v14
    v_and_or_b32 v0, v1, 32, v14
    s_lshl_b32 s62, s47, 16
    s_and_b32 s61, s41, 1
    s_lshl_b32 s61, s61, 15
    s_add_u32 s62, s62, s61
    s_lshl_b32 s61, s46, 7
    s_add_u32 s62, s62, s61
    s_lshr_b32 s61, s41, 1
    s_lshl_b32 s61, s61, 6
    s_add_u32 s62, s62, s61
    s_lshr_b32 s63, s83, 4
    s_waitcnt vmcnt(6)
    s_waitcnt lgkmcnt(8)
    v_mfma_f32_32x32x16_bf16 v[48:63], v[96:99], v[232:235], v[48:63]
    ds_read_b64_tr_b16 v[88:89], v3 offset:51200
    ds_read_b64_tr_b16 v[90:91], v3 offset:52224
    v_mul_f32 v18, v18, v8
    v_mul_f32 v19, v19, v8
    v_mul_f32 v20, v20, v8
    v_mfma_f32_32x32x16_bf16 v[64:79], v[100:103], v[232:235], v[64:79]
    ds_read_b64_tr_b16 v[92:93], v4 offset:51200
    ds_read_b64_tr_b16 v[94:95], v4 offset:52224
    v_mul_f32 v21, v21, v8
    v_mul_f32 v22, v22, v8
    v_mul_f32 v23, v23, v8
    s_waitcnt vmcnt(5)
    s_waitcnt lgkmcnt(8)
    v_mfma_f32_32x32x16_bf16 v[48:63], v[104:107], v[236:239], v[48:63]
    ds_read_b64_tr_b16 v[96:97], v3 offset:44032
    ds_read_b64_tr_b16 v[98:99], v3 offset:45056
    v_mul_f32 v24, v24, v8
    v_mul_f32 v25, v25, v8
    v_mul_f32 v26, v26, v8
    v_mfma_f32_32x32x16_bf16 v[64:79], v[108:111], v[236:239], v[64:79]
    ds_read_b64_tr_b16 v[100:101], v4 offset:44032
    ds_read_b64_tr_b16 v[102:103], v4 offset:45056
    v_mul_f32 v27, v27, v8
    v_mul_f32 v28, v28, v8
    v_mul_f32 v29, v29, v8
    s_waitcnt vmcnt(4)
    s_waitcnt lgkmcnt(8)
    v_mfma_f32_32x32x16_bf16 v[48:63], v[80:83], v[240:243], v[48:63]
    ds_read_b64_tr_b16 v[104:105], v3 offset:53248
    ds_read_b64_tr_b16 v[106:107], v3 offset:54272
    v_mul_f32 v30, v30, v8
    v_mul_f32 v31, v31, v8
    v_mul_f32 v32, v32, v8
    v_mfma_f32_32x32x16_bf16 v[64:79], v[84:87], v[240:243], v[64:79]
    ds_read_b64_tr_b16 v[108:109], v4 offset:53248
    ds_read_b64_tr_b16 v[110:111], v4 offset:54272
    v_mul_f32 v33, v33, v8
    v_mul_f32 v34, v34, v8
    v_mul_f32 v35, v35, v8
    s_waitcnt vmcnt(0)
    buffer_load_dwordx4 v[112:115], v2, s[24:27], s82 offen offset:0 sc1
    buffer_load_dwordx4 v[116:119], v2, s[24:27], s82 offen offset:1024 sc1
    s_waitcnt lgkmcnt(8)
    v_mfma_f32_32x32x16_bf16 v[48:63], v[88:91], v[244:247], v[48:63]
    v_mul_f32 v36, v36, v8
    v_mul_f32 v37, v37, v8
    v_mul_f32 v38, v38, v8
    v_mfma_f32_32x32x16_bf16 v[64:79], v[92:95], v[244:247], v[64:79]
    v_mul_f32 v39, v39, v8
    v_mul_f32 v40, v40, v8
    v_mul_f32 v41, v41, v8
    s_waitcnt lgkmcnt(4)
    v_mfma_f32_32x32x16_bf16 v[48:63], v[96:99], v[248:251], v[48:63]
    v_mul_f32 v42, v42, v8
    v_mul_f32 v43, v43, v8
    v_mul_f32 v44, v44, v8
    v_mfma_f32_32x32x16_bf16 v[64:79], v[100:103], v[248:251], v[64:79]
    v_mul_f32 v45, v45, v8
    v_mul_f32 v46, v46, v8
    v_mul_f32 v47, v47, v8
    ds_read_b32 v15, v10
    s_waitcnt lgkmcnt(1)
    v_mfma_f32_32x32x16_bf16 v[48:63], v[104:107], v[252:255], v[48:63]
    v_mfma_f32_32x32x16_bf16 v[64:79], v[108:111], v[252:255], v[64:79]
    s_waitcnt lgkmcnt(0)
L_pc15:
    v_cmp_gt_u32 vcc, 11, v15
    s_and_b32 s60, vcc_lo, s63
    s_cbranch_scc0 L_pk15
    s_add_u32 s65, s65, 1
    s_sleep 1
    ds_read_b32 v15, v10
    s_cmp_gt_u32 s65, 1600000
    s_waitcnt lgkmcnt(0)
    s_cbranch_scc0 L_pc15
L_pk15:
    s_nop 9
    v_pk_fma_f32 v[16:17], v[48:49], v[8:9], v[16:17] op_sel:[0,1,0]
    v_pk_fma_f32 v[18:19], v[50:51], v[8:9], v[18:19] op_sel:[0,1,0]
    ds_write_b128 v5, v[16:19] offset:0
    v_pk_fma_f32 v[20:21], v[52:53], v[8:9], v[20:21] op_sel:[0,1,0]
    v_pk_fma_f32 v[22:23], v[54:55], v[8:9], v[22:23] op_sel:[0,1,0]
    ds_write_b128 v5, v[20:23] offset:1024
    v_pk_fma_f32 v[24:25], v[56:57], v[8:9], v[24:25] op_sel:[0,1,0]
    v_pk_fma_f32 v[26:27], v[58:59], v[8:9], v[26:27] op_sel:[0,1,0]
    ds_write_b128 v5, v[24:27] offset:2048
    v_pk_fma_f32 v[28:29], v[60:61], v[8:9], v[28:29] op_sel:[0,1,0]
    v_pk_fma_f32 v[30:31], v[62:63], v[8:9], v[30:31] op_sel:[0,1,0]
    ds_write_b128 v5, v[28:31] offset:3072
    v_mov_b32 v12, 10
    ds_write_b32 v11, v12
    v_pk_fma_f32 v[32:33], v[64:65], v[8:9], v[32:33] op_sel:[0,1,0]
    v_pk_fma_f32 v[34:35], v[66:67], v[8:9], v[34:35] op_sel:[0,1,0]
    v_pk_fma_f32 v[36:37], v[68:69], v[8:9], v[36:37] op_sel:[0,1,0]
    v_pk_fma_f32 v[38:39], v[70:71], v[8:9], v[38:39] op_sel:[0,1,0]
    v_pk_fma_f32 v[40:41], v[72:73], v[8:9], v[40:41] op_sel:[0,1,0]
    v_pk_fma_f32 v[42:43], v[74:75], v[8:9], v[42:43] op_sel:[0,1,0]
    v_pk_fma_f32 v[44:45], v[76:77], v[8:9], v[44:45] op_sel:[0,1,0]
    v_pk_fma_f32 v[46:47], v[78:79], v[8:9], v[46:47] op_sel:[0,1,0]
L_cb10:
    ds_read_b32 v15, v10
    ds_read_b128 v[48:51], v6 offset:0
    ds_read_b128 v[52:55], v6 offset:1024
    ds_read_b128 v[56:59], v6 offset:2048
    ds_read_b128 v[60:63], v6 offset:3072
    s_add_u32 s65, s65, 1
    s_cmp_gt_u32 s65, 1600000
    s_cbranch_scc1 L_cbk10
    s_waitcnt lgkmcnt(4)
    v_cmp_gt_u32 vcc, 10, v15
    s_and_b32 s60, vcc_lo, s83
    s_cbranch_scc1 L_cb10
L_cbk10:
    s_waitcnt lgkmcnt(3)
    v_pk_add_f32 v[32:33], v[32:33], v[48:49]
    v_pk_add_f32 v[34:35], v[34:35], v[50:51]
    s_waitcnt lgkmcnt(2)
    v_pk_add_f32 v[36:37], v[36:37], v[52:53]
    v_pk_add_f32 v[38:39], v[38:39], v[54:55]
    s_waitcnt lgkmcnt(1)
    v_pk_add_f32 v[40:41], v[40:41], v[56:57]
    v_pk_add_f32 v[42:43], v[42:43], v[58:59]
    s_waitcnt lgkmcnt(0)
    v_pk_add_f32 v[44:45], v[44:45], v[60:61]
    v_pk_add_f32 v[46:47], v[46:47], v[62:63]
    v_mov_b32 v5, 0
    v_mov_b32 v15, 0xffff0000
L_pr10:
    s_waitcnt vmcnt(0)
    v_xor_b32 v144, v112, v128
    v_xor_b32 v145, v113, v129
    v_xor_b32 v146, v114, v130
    v_xor_b32 v147, v115, v131
    v_xor_b32 v148, v116, v132
    v_xor_b32 v149, v117, v133
    v_xor_b32 v150, v118, v134
    v_xor_b32 v151, v119, v135
    v_min3_u32 v14, v144, v145, v146
    v_min3_u32 v147, v147, v148, v149
    v_min3_u32 v14, v14, v150, v151
    v_min_u32 v14, v14, v147
    v_cmp_eq_u32 vcc, 0, v14
    s_cbranch_vccz L_prk10
    v_cmp_eq_u32 vcc, s64, v136
    s_add_u32 s65, s65, 8
    s_cbranch_vccnz L_prk10
    v_mov_b32 v136, v5
    buffer_load_dwordx4 v[112:115], v2, s[24:27], s82 offen offset:0 sc1
    buffer_load_dwordx4 v[116:119], v2, s[24:27], s82 offen offset:1024 sc1
    buffer_load_dword v5, off, s[24:27], s13 sc1
    s_cmp_gt_u32 s65, 1600000
    s_cbranch_scc0 L_pr10
    s_waitcnt vmcnt(0)
L_prk10:
    v_lshlrev_b32 v48, 16, v112
    v_bitop3_b32 v49, v112, s14, v15 bitop3:0x28
    v_lshlrev_b32 v50, 16, v113
    v_bitop3_b32 v51, v113, s14, v15 bitop3:0x28
    v_pk_add_f32 v[32:33], v[32:33], v[48:49]
    v_pk_add_f32 v[34:35], v[34:35], v[50:51]
    v_cvt_pk_bf16_f32 v80, v32, v33
    v_cvt_pk_bf16_f32 v81, v34, v35
    v_lshlrev_b32 v52, 16, v114
    v_bitop3_b32 v53, v114, s14, v15 bitop3:0x28
    v_lshlrev_b32 v54, 16, v115
    v_bitop3_b32 v55, v115, s14, v15 bitop3:0x28
    v_pk_add_f32 v[36:37], v[36:37], v[52:53]
    v_pk_add_f32 v[38:39], v[38:39], v[54:55]
    v_cvt_pk_bf16_f32 v82, v36, v37
    v_cvt_pk_bf16_f32 v83, v38, v39
    buffer_store_dwordx4 v[80:83], v0, s[28:31], s62 offen offset:0
    v_lshlrev_b32 v56, 16, v116
    v_bitop3_b32 v57, v116, s14, v15 bitop3:0x28
    v_lshlrev_b32 v58, 16, v117
    v_bitop3_b32 v59, v117, s14, v15 bitop3:0x28
    v_pk_add_f32 v[40:41], v[40:41], v[56:57]
    v_pk_add_f32 v[42:43], v[42:43], v[58:59]
    v_cvt_pk_bf16_f32 v84, v40, v41
    v_cvt_pk_bf16_f32 v85, v42, v43
    v_lshlrev_b32 v60, 16, v118
    v_bitop3_b32 v61, v118, s14, v15 bitop3:0x28
    v_lshlrev_b32 v62, 16, v119
    v_bitop3_b32 v63, v119, s14, v15 bitop3:0x28
    v_pk_add_f32 v[44:45], v[44:45], v[60:61]
    v_pk_add_f32 v[46:47], v[46:47], v[62:63]
    v_cvt_pk_bf16_f32 v86, v44, v45
    v_cvt_pk_bf16_f32 v87, v46, v47
    buffer_store_dwordx4 v[84:87], v0, s[28:31], s62 offen offset:16
    s_waitcnt vmcnt(0)
    s_endpgm
L_tagsq:
    s_add_u32 s65, s65, 8
    s_cmp_gt_u32 s65, 1600000
    s_cbranch_scc1 L_tagkq
    s_sleep 1
    buffer_load_dword v7, off, s[36:39], 0 sc1
    s_waitcnt vmcnt(0)
    s_branch L_tagq
L_fv11:
    s_waitcnt lgkmcnt(0)
    s_add_u32 s65, s65, 8
    s_cmp_gt_u32 s65, 1600000
    s_cbranch_scc1 L_fk11
    buffer_load_dword v8, v5, s[24:27], s80 offen sc1
    s_waitcnt vmcnt(0)
    v_cmp_ne_u32 vcc, s64, v8
    s_cbranch_vccz L_fk11
    s_sleep 1
    s_branch L_fv11
L_fv12:
    s_waitcnt lgkmcnt(0)
    s_add_u32 s65, s65, 8
    s_cmp_gt_u32 s65, 1600000
    s_cbranch_scc1 L_fk12
    buffer_load_dword v8, v6, s[24:27], s80 offen offset:384 sc1
    s_waitcnt vmcnt(0)
    v_cmp_ne_u32 vcc, s64, v8
    s_cbranch_vccz L_fk12
    s_sleep 1
    s_branch L_fv12
L_fv13:
    s_waitcnt lgkmcnt(0)
    s_add_u32 s65, s65, 8
    s_cmp_gt_u32 s65, 1600000
    s_cbranch_scc1 L_fk13
    buffer_load_dword v8, v6, s[24:27], s80 offen offset:512 sc1
    s_waitcnt vmcnt(0)
    v_cmp_ne_u32 vcc, s64, v8
    s_cbranch_vccz L_fk13
    s_sleep 1
    s_branch L_fv13
L_Aq:
    s_and_b32 s60, s2, 3
    s_lshl_b32 s60, s60, 5
    s_lshr_b32 s62, s2, 3
    s_add_u32 s60, s60, s62
    s_lshl_b32 s62, s45, 7
    s_add_u32 s62, s62, s60
    s_mov_b32 s91, 0x20000
    s_waitcnt lgkmcnt(0)
    s_cmp_lt_u32 s41, 2
    s_cbranch_scc0 L_pf2q
    s_cmp_eq_u32 s41, 0
    s_cbranch_scc0 L_pf1q
    v_lshrrev_b32 v27, 4, v1
    v_min_u32 v27, 2, v27
    s_add_u32 s61, s3, 3
    v_add_u32 v27, s61, v27
    v_and_b32 v27, 7, v27
    v_and_b32 v14, 7, v1
    v_lshl_add_u32 v27, v27, 6, v14
    v_mul_u32_u24 v27, 3072, v27
    v_bfe_u32 v14, v1, 3, 1
    v_lshl_add_u32 v27, v14, 10, v27
    s_and_b32 s61, s42, 7
    s_mul_i32 s53, s61, 24576
    s_lshl_b32 s61, s43, 7
    s_add_u32 s61, s61, 1024
    s_add_u32 s53, s53, s61
    s_mov_b32 s88, s94
    s_mov_b32 s89, s95
    s_mov_b32 s90, 0x180000
    buffer_load_dword v200, v27, s[88:91], s53 offen
    s_lshl_b32 s53, s62, 11
    v_and_b32 v26, 15, v1
    v_lshlrev_b32 v26, 7, v26
    s_mov_b32 s88, s20
    s_mov_b32 s89, s21
    s_mov_b32 s90, 0x80000
    s_mov_b32 s52, 7
    s_branch L_pfeq
L_pf1q:
    s_mul_i32 s53, s60, 12288
    s_lshl_b32 s61, s45, 9
    s_add_u32 s53, s53, s61
    v_bfe_u32 v14, v1, 2, 2
    v_mul_u32_u24 v14, 3072, v14
    v_and_b32 v26, 3, v1
    v_lshl_add_u32 v26, v26, 7, v14
    s_mov_b32 s88, s94
    s_mov_b32 s89, s95
    s_mov_b32 s90, 0x180000
    s_mov_b32 s52, 4
    s_branch L_pfeq
L_pf2q:
    s_cmp_eq_u32 s41, 2
    s_cbranch_scc0 L_pf3q
    s_mul_i32 s53, s60, 14336
    s_mul_i32 s61, s45, 1792
    s_add_u32 s53, s53, s61
    v_bfe_u32 v14, v1, 3, 2
    v_mul_u32_u24 v14, 3584, v14
    v_and_b32 v26, 7, v1
    v_lshlrev_b32 v26, 2, v26
    s_mov_b32 s61, 0xddda9632
    v_bfe_u32 v26, s61, v26, 4
    v_lshl_add_u32 v26, v26, 7, v14
    s_mov_b32 s88, s96
    s_mov_b32 s89, s97
    s_mov_b32 s90, 0x1c0000
    s_mov_b32 s52, 4
    s_branch L_pfeq
L_pf3q:
    s_mul_i32 s53, s62, 7168
    v_min_u32 v26, 55, v1
    v_lshlrev_b32 v26, 7, v26
    s_mov_b32 s88, s4
    s_mov_b32 s89, s5
    s_mov_b32 s90, 0x1c0000
    s_mov_b32 s52, 3
L_pfeq:
    s_mov_b32 s14, 0x180000
    s_mov_b32 s34, 3584
    s_waitcnt lgkmcnt(0)
    s_mov_b32 s8, s92
    s_mov_b32 s9, s93
    s_mov_b32 s12, s94
    s_mov_b32 s13, s95
    s_mov_b32 s32, s98
    s_mov_b32 s33, s99
    s_lshr_b32 s73, s41, 1
    s_and_b32 s74, s41, 1
    s_mov_b32 s16, s4
    s_mov_b32 s17, s5
    s_mov_b32 s18, 0x1c0000
    s_mov_b32 s19, 0x20000
    s_mov_b32 s22, 0x80000
    s_mov_b32 s23, 0x20000
    s_mov_b32 s26, 0x1100000
    s_mov_b32 s27, 0x20000
    s_mov_b32 s30, 0x200000
    s_mov_b32 s31, 0x20000
    s_mov_b32 s38, 0x100
    s_mov_b32 s39, 0x20000
    ds_write_b32 v11, v12
    s_mov_b32 s66, 0x3fb8aa3b
    s_mov_b32 s67, 0x358637bd
    s_mov_b32 s68, 0.5
    s_mov_b32 s70, 0x3fb8aa3b
    s_mov_b32 s69, 0.5
    s_mov_b32 s71, 0x3fb8aa3b
    s_mov_b32 s4, 0x7060500
    s_mov_b32 s5, 0x7060501
    s_mov_b32 s6, 0x7060502
    s_mov_b32 s7, 0x7060503
    s_and_b32 s47, s2, 1
    s_bfe_u32 s60, s2, 0x10001
    s_lshl1_add_u32 s47, s47, s60
    s_bfe_u32 s60, s2, 0x20003
    s_lshl2_add_u32 s47, s47, s60
    s_lshl1_add_u32 s47, s47, s45
    s_and_b32 s48, s43, 3
    v_and_b32 v14, 7, v1
    v_lshlrev_b32 v10, 2, v14
    v_add_u32 v10, 147456, v10
    v_bfe_u32 v15, v1, 4, 1
    v_lshlrev_b32 v15, 2, v15
    v_xor_b32 v14, v14, v15
    v_lshlrev_b32 v14, 4, v14
    v_lshrrev_b32 v15, 3, v1
    v_lshl_add_u32 v22, v15, 10, v14
    s_lshl_b32 s60, s45, 2
    s_add_u32 s60, s60, s41
    s_lshl_b32 s61, s46, 7
    s_mul_i32 s57, s60, 229376
    s_add_u32 s57, s57, s61
    s_lshl_b32 s58, s60, 16
    s_add_u32 s58, s58, s61
    s_and_b32 s62, s41, 1
    s_lshl_b32 s56, s62, 15
    s_add_u32 s56, s56, s57
    s_cmp_eq_u32 s62, 0
    s_cselect_b32 s62, 196608, 0
    s_add_u32 s57, s57, s62
    s_mul_i32 s55, s41, 9216
    v_lshrrev_b32 v14, 5, v1
    v_bfe_u32 v15, v1, 2, 2
    v_lshl_add_u32 v14, v14, 2, v15
    v_lshlrev_b32 v14, 7, v14
    v_bfe_u32 v15, v1, 3, 1
    v_lshl_add_u32 v14, v15, 6, v14
    v_and_b32 v15, 1, v1
    v_lshl_add_u32 v14, v15, 5, v14
    v_and_b32 v15, 16, v1
    v_add_u32 v14, v14, v15
    v_and_b32 v15, 2, v1
    v_lshl_add_u32 v14, v15, 2, v14
    s_lshr_b32 s60, s41, 1
    s_lshl_b32 s61, s60, 6
    v_xor_b32 v14, s61, v14
    s_mul_i32 s61, s60, 18432
    v_add_u32 v4, s61, v14
    v_xor_b32 v3, 64, v4
    s_lshr_b32 s61, s40, 2
    s_lshl_b32 s61, s61, 1
    s_and_b32 s62, s41, 1
    s_add_u32 s61, s61, s62
    s_lshl_b32 s63, s47, 2
    s_add_u32 s61, s61, s63
    s_lshl_b32 s61, s61, 1
    s_add_u32 s61, s61, s60
    s_lshl_b32 s61, s61, 1
    s_mul_i32 s78, s61, 14336
    s_mul_i32 s79, s61, 4096
    s_add_u32 s79, s79, 0x800000
    s_mul_i32 s80, s61, 1024
    s_add_u32 s80, s80, 0xc00000
    s_mul_i32 s81, s61, 128
    s_add_u32 s81, s81, 0xa00000
    s_lshl_b32 s82, s47, 3
    s_add_u32 s82, s82, s46
    s_lshl_b32 s82, s82, 2
    s_add_u32 s82, s82, s41
    s_cmp_lt_u32 s40, 4
    s_cselect_b32 s62, 32, 0
    s_xor_b32 s82, s82, s62
    s_mul_i32 s82, s82, 4096
    s_add_u32 s82, s82, 0xd00000
    v_bfe_u32 v14, v1, 2, 1
    v_mul_u32_u24 v6, 1024, v14
    v_and_b32 v14, 1, v1
    v_lshl_add_u32 v5, v14, 7, v6
    v_bfe_u32 v14, v1, 1, 3
    v_lshrrev_b32 v15, 5, v1
    v_xor_b32 v14, v14, v15
    v_lshlrev_b32 v14, 4, v14
    v_and_b32 v15, 31, v1
    v_lshl_add_u32 v14, v15, 7, v14
    s_lshl_b32 s60, s74, 12
    s_add_u32 s60, s60, 36864
    v_add_u32 v16, s60, v14
    v_xor_b32 v17, 32, v16
    v_xor_b32 v18, 64, v16
    v_xor_b32 v19, 96, v16
    v_lshrrev_b32 v14, 5, v1
    v_bfe_u32 v15, v1, 2, 2
    v_lshl_add_u32 v14, v14, 3, v15
    v_lshlrev_b32 v14, 7, v14
    v_bfe_u32 v15, v1, 3, 1
    v_lshl_add_u32 v14, v15, 6, v14
    v_and_b32 v15, 16, v1
    v_lshl_add_u32 v14, v15, 1, v14
    v_and_b32 v15, 3, v1
    v_lshl_add_u32 v21, v15, 3, v14
    v_add_u32 v21, 36864, v21
    s_lshl_b32 s60, s73, 6
    v_xor_b32 v21, s60, v21
    s_lshl_b32 s60, s74, 4
    v_xor_b32 v20, s60, v21
    v_pk_mov_b32 v[64:65], 0, 0
    v_pk_mov_b32 v[66:67], 0, 0
    v_pk_mov_b32 v[68:69], 0, 0
    v_pk_mov_b32 v[70:71], 0, 0
    v_pk_mov_b32 v[72:73], 0, 0
    v_pk_mov_b32 v[74:75], 0, 0
    v_pk_mov_b32 v[76:77], 0, 0
    v_pk_mov_b32 v[78:79], 0, 0
    v_pk_mov_b32 v[80:81], 0, 0
    v_pk_mov_b32 v[82:83], 0, 0
    v_pk_mov_b32 v[84:85], 0, 0
    v_pk_mov_b32 v[86:87], 0, 0
    v_pk_mov_b32 v[88:89], 0, 0
    v_pk_mov_b32 v[90:91], 0, 0
    v_pk_mov_b32 v[92:93], 0, 0
    v_pk_mov_b32 v[94:95], 0, 0
    v_pk_mov_b32 v[96:97], 0, 0
    v_pk_mov_b32 v[98:99], 0, 0
    v_pk_mov_b32 v[100:101], 0, 0
    v_pk_mov_b32 v[102:103], 0, 0
    v_pk_mov_b32 v[104:105], 0, 0
    v_pk_mov_b32 v[106:107], 0, 0
    v_pk_mov_b32 v[108:109], 0, 0
    v_pk_mov_b32 v[110:111], 0, 0
    v_pk_mov_b32 v[112:113], 0, 0
    v_pk_mov_b32 v[114:115], 0, 0
    v_pk_mov_b32 v[116:117], 0, 0
    v_pk_mov_b32 v[118:119], 0, 0
    v_pk_mov_b32 v[120:121], 0, 0
    v_pk_mov_b32 v[122:123], 0, 0
    v_pk_mov_b32 v[124:125], 0, 0
    v_pk_mov_b32 v[126:127], 0, 0
    s_lshl_b32 s60, s43, 2
    s_add_u32 s60, s60, s41
    s_lshl_b32 s100, s60, 14
    s_add_u32 s100, s100, 0xb00000
    s_lshl_b32 s101, s60, 11
    s_add_u32 s101, s101, 0xb80000
    s_lshl_b32 s60, s42, 10
    s_add_u32 s100, s100, s60
    s_lshl_b32 s60, s42, 7
    s_add_u32 s101, s101, s60
    s_lshl_b32 s60, s41, 11
    s_add_u32 s60, s60, 149504
    v_add_u32 v23, s60, v2
    v_and_b32 v25, 0x30, v1
    s_xor_b32 s60, s41, 1
    s_lshl_b32 s83, 1, s60
    s_lshl_b32 s60, s60, 11
    s_add_u32 s60, s60, 149504
    v_add_u32 v24, s60, v2
    s_mov_b32 s92, 0xffff0000
    s_mov_b32 s93, 0xffff0000
    v_mov_b32 v28, 0x3f803f80
    v_mov_b32 v29, 0x3f803f80
    v_mov_b32 v30, 0x3f803f80
    v_mov_b32 v31, 0x3f803f80
    s_mov_b32 s49, 1
    s_setprio 1
    s_waitcnt lgkmcnt(0)
    s_barrier
    ds_read_b128 v[32:35], v16 offset:0
    ds_read_b64_tr_b16 v[40:41], v20 offset:16384
    ds_read_b64_tr_b16 v[42:43], v20 offset:16896
    ds_read_b128 v[36:39], v16 offset:8192
    ds_read_b64_tr_b16 v[44:45], v21 offset:24576
    ds_read_b64_tr_b16 v[46:47], v21 offset:25088
    .p2align 4
L_loop_q:
    s_waitcnt lgkmcnt(3)
    v_mfma_f32_32x32x16_bf16 v[64:79], v[32:35], v[40:43], v[64:79]
    ds_read_b128 v[48:51], v17 offset:0
    ds_read_b64_tr_b16 v[56:57], v20 offset:18432
    ds_read_b64_tr_b16 v[58:59], v20 offset:18944
    s_waitcnt lgkmcnt(5)
    v_mfma_f32_32x32x16_bf16 v[96:111], v[36:39], v[40:43], v[96:111]
    ds_read_b128 v[52:55], v17 offset:8192
    ds_read_b64_tr_b16 v[60:61], v21 offset:26624
    ds_read_b64_tr_b16 v[62:63], v21 offset:27136
    s_waitcnt lgkmcnt(6)
    v_mfma_f32_32x32x16_bf16 v[80:95], v[32:35], v[44:47], v[80:95]
    s_add_u32 s49, s49, 1
    s_and_b32 s60, s49, 3
    s_mov_b32 s50, 0xfffe5000
    v_mfma_f32_32x32x16_bf16 v[112:127], v[36:39], v[44:47], v[112:127]
    s_cmov_b32 s50, 36864
    s_waitcnt lgkmcnt(3)
    v_mfma_f32_32x32x16_bf16 v[64:79], v[48:51], v[56:59], v[64:79]
    ds_read_b128 v[32:35], v18 offset:0
    ds_read_b64_tr_b16 v[40:41], v20 offset:20480
    ds_read_b64_tr_b16 v[42:43], v20 offset:20992
    s_waitcnt lgkmcnt(5)
    v_mfma_f32_32x32x16_bf16 v[96:111], v[52:55], v[56:59], v[96:111]
    ds_read_b128 v[36:39], v18 offset:8192
    ds_read_b64_tr_b16 v[44:45], v21 offset:28672
    ds_read_b64_tr_b16 v[46:47], v21 offset:29184
    s_waitcnt lgkmcnt(6)
    v_mfma_f32_32x32x16_bf16 v[80:95], v[48:51], v[60:63], v[80:95]
    v_add_u32 v16, s50, v16
    v_add_u32 v17, s50, v17
    v_add_u32 v18, s50, v18
    v_mfma_f32_32x32x16_bf16 v[112:127], v[52:55], v[60:63], v[112:127]
    s_waitcnt lgkmcnt(3)
    v_mfma_f32_32x32x16_bf16 v[64:79], v[32:35], v[40:43], v[64:79]
    ds_read_b128 v[48:51], v19 offset:0
    ds_read_b64_tr_b16 v[56:57], v20 offset:22528
    ds_read_b64_tr_b16 v[58:59], v20 offset:23040
    s_waitcnt lgkmcnt(5)
    v_mfma_f32_32x32x16_bf16 v[96:111], v[36:39], v[40:43], v[96:111]
    ds_read_b128 v[52:55], v19 offset:8192
    ds_read_b64_tr_b16 v[60:61], v21 offset:30720
    ds_read_b64_tr_b16 v[62:63], v21 offset:31232
    s_waitcnt lgkmcnt(6)
    v_mfma_f32_32x32x16_bf16 v[80:95], v[32:35], v[44:47], v[80:95]
    v_add_u32 v19, s50, v19
    v_add_u32 v20, s50, v20
    v_add_u32 v21, s50, v21
    v_mfma_f32_32x32x16_bf16 v[112:127], v[36:39], v[44:47], v[112:127]
    s_waitcnt lgkmcnt(3)
    v_mfma_f32_32x32x16_bf16 v[64:79], v[48:51], v[56:59], v[64:79]
    s_waitcnt lgkmcnt(0)
    s_barrier
    v_mfma_f32_32x32x16_bf16 v[96:111], v[52:55], v[56:59], v[96:111]
    ds_read_b128 v[32:35], v16 offset:0
    ds_read_b64_tr_b16 v[40:41], v20 offset:16384
    ds_read_b64_tr_b16 v[42:43], v20 offset:16896
    v_mfma_f32_32x32x16_bf16 v[80:95], v[48:51], v[60:63], v[80:95]
    ds_read_b128 v[36:39], v16 offset:8192
    ds_read_b64_tr_b16 v[44:45], v21 offset:24576
    ds_read_b64_tr_b16 v[46:47], v21 offset:25088
    v_mfma_f32_32x32x16_bf16 v[112:127], v[52:55], v[60:63], v[112:127]
    s_cmp_lg_u32 s49, s52
    s_cbranch_scc1 L_nt_q
    buffer_load_dword v26, v26, s[88:91], s53 offen
L_nt_q:
    s_cmp_lt_u32 s49, 9
    s_cbranch_scc1 L_loop_q
    s_setprio 3
    ds_read_b32 v7, v10 offset:64
    s_waitcnt lgkmcnt(1)
    s_nop 5
    v_mul_f32 v32, s66, v64
    v_mul_f32 v33, s66, v65
    v_mul_f32 v34, s66, v66
    v_mul_f32 v35, s66, v67
    v_mul_f32 v36, s66, v68
    v_mul_f32 v37, s66, v69
    v_mul_f32 v38, s66, v70
    v_mul_f32 v39, s66, v71
    v_exp_f32 v32, v32 clamp
    v_exp_f32 v33, v33 clamp
    v_exp_f32 v34, v34 clamp
    v_exp_f32 v35, v35 clamp
    v_exp_f32 v36, v36 clamp
    v_exp_f32 v37, v37 clamp
    v_exp_f32 v38, v38 clamp
    v_exp_f32 v39, v39 clamp
    v_max_f32 v64, s67, v64
    v_max_f32 v65, s67, v65
    v_max_f32 v66, s67, v66
    v_max_f32 v67, s67, v67
    v_max_f32 v68, s67, v68
    v_max_f32 v69, s67, v69
    v_max_f32 v70, s67, v70
    v_max_f32 v71, s67, v71
    v_add_f32 v32, v32, v64
    v_add_f32 v33, v33, v65
    v_add_f32 v34, v34, v66
    v_add_f32 v35, v35, v67
    v_add_f32 v36, v36, v68
    v_add_f32 v37, v37, v69
    v_add_f32 v38, v38, v70
    v_add_f32 v39, v39, v71
    v_cvt_pk_bf16_f32 v128, v32, v33
    v_cvt_pk_bf16_f32 v129, v34, v35
    v_cvt_pk_bf16_f32 v130, v36, v37
    v_cvt_pk_bf16_f32 v131, v38, v39
    v_cvt_pk_bf16_f32 v144, v80, v81
    v_cvt_pk_bf16_f32 v145, v82, v83
    v_cvt_pk_bf16_f32 v146, v84, v85
    v_cvt_pk_bf16_f32 v147, v86, v87
    s_waitcnt lgkmcnt(0)
    v_readfirstlane_b32 s64, v7
    s_bfe_u32 s96, s64, 0x80000
    s_bfe_u32 s97, s64, 0x80008
    s_bfe_u32 s98, s64, 0x80010
    s_bfe_u32 s99, s64, 0x80018
    v_mfma_f32_32x32x16_bf16 v[176:191], v[128:131], v[28:31], 0
    s_nop 0
    v_mfma_f32_32x32x16_bf16 v[160:175], v[128:131], v[144:147], 0
    v_mul_f32 v32, s66, v72
    v_mul_f32 v33, s66, v73
    v_mul_f32 v34, s66, v74
    v_mul_f32 v35, s66, v75
    v_mul_f32 v36, s66, v76
    v_mul_f32 v37, s66, v77
    v_mul_f32 v38, s66, v78
    v_mul_f32 v39, s66, v79
    v_exp_f32 v32, v32 clamp
    v_exp_f32 v33, v33 clamp
    v_exp_f32 v34, v34 clamp
    v_exp_f32 v35, v35 clamp
    v_exp_f32 v36, v36 clamp
    v_exp_f32 v37, v37 clamp
    v_exp_f32 v38, v38 clamp
    v_exp_f32 v39, v39 clamp
    v_max_f32 v72, s67, v72
    v_max_f32 v73, s67, v73
    v_max_f32 v74, s67, v74
    v_max_f32 v75, s67, v75
    v_max_f32 v76, s67, v76
    v_max_f32 v77, s67, v77
    v_max_f32 v78, s67, v78
    v_max_f32 v79, s67, v79
    v_add_f32 v32, v32, v72
    v_add_f32 v33, v33, v73
    v_add_f32 v34, v34, v74
    v_add_f32 v35, v35, v75
    v_add_f32 v36, v36, v76
    v_add_f32 v37, v37, v77
    v_add_f32 v38, v38, v78
    v_add_f32 v39, v39, v79
    v_cvt_pk_bf16_f32 v132, v32, v33
    v_cvt_pk_bf16_f32 v133, v34, v35
    v_cvt_pk_bf16_f32 v134, v36, v37
    v_cvt_pk_bf16_f32 v135, v38, v39
    v_cvt_pk_bf16_f32 v148, v88, v89
    v_cvt_pk_bf16_f32 v149, v90, v91
    v_cvt_pk_bf16_f32 v150, v92, v93
    v_cvt_pk_bf16_f32 v151, v94, v95
    v_mfma_f32_32x32x16_bf16 v[176:191], v[132:135], v[28:31], v[176:191]
    s_nop 0
    v_mfma_f32_32x32x16_bf16 v[160:175], v[132:135], v[148:151], v[160:175]
    v_mul_f32 v32, s66, v96
    v_mul_f32 v33, s66, v97
    v_mul_f32 v34, s66, v98
    v_mul_f32 v35, s66, v99
    v_mul_f32 v36, s66, v100
    v_mul_f32 v37, s66, v101
    v_mul_f32 v38, s66, v102
    v_mul_f32 v39, s66, v103
    v_exp_f32 v32, v32 clamp
    v_exp_f32 v33, v33 clamp
    v_exp_f32 v34, v34 clamp
    v_exp_f32 v35, v35 clamp
    v_exp_f32 v36, v36 clamp
    v_exp_f32 v37, v37 clamp
    v_exp_f32 v38, v38 clamp
    v_exp_f32 v39, v39 clamp
    v_max_f32 v96, s67, v96
    v_max_f32 v97, s67, v97
    v_max_f32 v98, s67, v98
    v_max_f32 v99, s67, v99
    v_max_f32 v100, s67, v100
    v_max_f32 v101, s67, v101
    v_max_f32 v102, s67, v102
    v_max_f32 v103, s67, v103
    v_add_f32 v32, v32, v96
    v_add_f32 v33, v33, v97
    v_add_f32 v34, v34, v98
    v_add_f32 v35, v35, v99
    v_add_f32 v36, v36, v100
    v_add_f32 v37, v37, v101
    v_add_f32 v38, v38, v102
    v_add_f32 v39, v39, v103
    v_cvt_pk_bf16_f32 v136, v32, v33
    v_cvt_pk_bf16_f32 v137, v34, v35
    v_cvt_pk_bf16_f32 v138, v36, v37
    v_cvt_pk_bf16_f32 v139, v38, v39
    v_cvt_pk_bf16_f32 v152, v112, v113
    v_cvt_pk_bf16_f32 v153, v114, v115
    v_cvt_pk_bf16_f32 v154, v116, v117
    v_cvt_pk_bf16_f32 v155, v118, v119
    v_mfma_f32_32x32x16_bf16 v[176:191], v[136:139], v[28:31], v[176:191]
    s_nop 0
    v_mfma_f32_32x32x16_bf16 v[160:175], v[136:139], v[152:155], v[160:175]
    v_mul_f32 v32, s66, v104
    v_mul_f32 v33, s66, v105
    v_mul_f32 v34, s66, v106
    v_mul_f32 v35, s66, v107
    v_mul_f32 v36, s66, v108
    v_mul_f32 v37, s66, v109
    v_mul_f32 v38, s66, v110
    v_mul_f32 v39, s66, v111
    v_exp_f32 v32, v32 clamp
    v_exp_f32 v33, v33 clamp
    v_exp_f32 v34, v34 clamp
    v_exp_f32 v35, v35 clamp
    v_exp_f32 v36, v36 clamp
    v_exp_f32 v37, v37 clamp
    v_exp_f32 v38, v38 clamp
    v_exp_f32 v39, v39 clamp
    v_max_f32 v104, s67, v104
    v_max_f32 v105, s67, v105
    v_max_f32 v106, s67, v106
    v_max_f32 v107, s67, v107
    v_max_f32 v108, s67, v108
    v_max_f32 v109, s67, v109
    v_max_f32 v110, s67, v110
    v_max_f32 v111, s67, v111
    v_add_f32 v32, v32, v104
    v_add_f32 v33, v33, v105
    v_add_f32 v34, v34, v106
    v_add_f32 v35, v35, v107
    v_add_f32 v36, v36, v108
    v_add_f32 v37, v37, v109
    v_add_f32 v38, v38, v110
    v_add_f32 v39, v39, v111
    v_cvt_pk_bf16_f32 v140, v32, v33
    v_cvt_pk_bf16_f32 v141, v34, v35
    v_cvt_pk_bf16_f32 v142, v36, v37
    v_cvt_pk_bf16_f32 v143, v38, v39
    v_cvt_pk_bf16_f32 v156, v120, v121
    v_cvt_pk_bf16_f32 v157, v122, v123
    v_cvt_pk_bf16_f32 v158, v124, v125
    v_cvt_pk_bf16_f32 v159, v126, v127
    v_mfma_f32_32x32x16_bf16 v[176:191], v[140:143], v[28:31], v[176:191]
    s_nop 0
    v_mfma_f32_32x32x16_bf16 v[160:175], v[140:143], v[156:159], v[160:175]
    s_nop 9
    v_cndmask_b32 v36, v180, v188, s[92:93]
    v_cndmask_b32 v37, v181, v189, s[92:93]
    v_cndmask_b32 v38, v182, v190, s[92:93]
    v_cndmask_b32 v39, v183, v191, s[92:93]
    v_cndmask_b32 v32, v164, v172, s[92:93]
    v_cndmask_b32 v33, v165, v173, s[92:93]
    v_cndmask_b32 v34, v166, v174, s[92:93]
    v_cndmask_b32 v35, v167, v175, s[92:93]
    ds_write_b128 v23, v[36:39] offset:1024
    ds_write_b128 v23, v[32:35]
    v_mov_b32 v12, 1
    ds_write_b32 v11, v12
    v_cndmask_b32 v44, v176, v184, s[92:93]
    v_cndmask_b32 v45, v177, v185, s[92:93]
    v_cndmask_b32 v46, v178, v186, s[92:93]
    v_cndmask_b32 v47, v179, v187, s[92:93]
    v_cndmask_b32 v40, v160, v168, s[92:93]
    v_cndmask_b32 v41, v161, v169, s[92:93]
    v_cndmask_b32 v42, v162, v170, s[92:93]
    v_cndmask_b32 v43, v163, v171, s[92:93]
L_kx:
    ds_read_b32 v15, v10
    ds_read_b128 v[48:51], v24
    ds_read_b128 v[52:55], v24 offset:1024
    s_add_u32 s65, s65, 1
    s_cmp_gt_u32 s65, 1600000
    s_cbranch_scc1 L_kxk
    s_waitcnt lgkmcnt(2)
    v_cmp_gt_u32 vcc, 1, v15
    s_and_b32 s60, vcc_lo, s83
    s_cbranch_scc1 L_kx
L_kxk:
    s_waitcnt lgkmcnt(0)
    v_add_f32 v40, v40, v48
    v_add_f32 v41, v41, v49
    v_add_f32 v42, v42, v50
    v_add_f32 v43, v43, v51
    v_add_f32 v44, v44, v52
    v_add_f32 v45, v45, v53
    v_add_f32 v46, v46, v54
    v_add_f32 v47, v47, v55
    v_perm_b32 v40, v40, v7, s4
    v_perm_b32 v41, v41, v7, s5
    v_perm_b32 v42, v42, v7, s6
    v_perm_b32 v43, v43, v7, s7
    buffer_store_dwordx4 v[40:43], v2, s[24:27], s100 offen sc1
    v_perm_b32 v44, v44, v7, s4
    v_perm_b32 v45, v45, v7, s5
    v_perm_b32 v46, v46, v7, s6
    v_perm_b32 v47, v47, v7, s7
    buffer_store_dwordx4 v[44:47], v25, s[24:27], s101 offen sc1
    s_setprio 1
    s_add_u32 m0, s55, 0
    s_nop 0
    buffer_load_dwordx4 v22, s[16:19], s56 offen lds
    s_add_u32 m0, s55, 1024
    s_add_u32 s59, s56, 8192
    buffer_load_dwordx4 v22, s[16:19], s59 offen lds
    s_add_u32 m0, s55, 2048
    s_add_u32 s59, s56, 16384
    buffer_load_dwordx4 v22, s[16:19], s59 offen lds
    s_add_u32 m0, s55, 3072
    s_add_u32 s59, s56, 24576
    buffer_load_dwordx4 v22, s[16:19], s59 offen lds
    s_add_u32 m0, s55, 4096
    s_add_u32 s59, s56, 32768
    buffer_load_dwordx4 v22, s[16:19], s59 offen lds
    s_add_u32 m0, s55, 5120
    s_add_u32 s59, s56, 40960
    buffer_load_dwordx4 v22, s[16:19], s59 offen lds
    s_add_u32 m0, s55, 6144
    s_add_u32 s59, s56, 49152
    buffer_load_dwordx4 v22, s[16:19], s59 offen lds
    s_add_u32 m0, s55, 7168
    s_add_u32 s59, s56, 57344
    buffer_load_dwordx4 v22, s[16:19], s59 offen lds
    s_add_u32 m0, s55, 8192
    s_add_u32 s59, s56, 65536
    buffer_load_dwordx4 v22, s[16:19], s59 offen lds
    ds_read_b32 v15, v10
    s_waitcnt lgkmcnt(0)
L_pc16:
    v_cmp_gt_u32 vcc, 2, v15
    s_and_b32 s60, vcc_lo, 240
    s_cbranch_scc0 L_pk16
    s_add_u32 s65, s65, 1
    s_sleep 1
    ds_read_b32 v15, v10
    s_cmp_gt_u32 s65, 1600000
    s_waitcnt lgkmcnt(0)
    s_cbranch_scc0 L_pc16
L_pk16:
    s_add_u32 m0, s55, 36864
    s_add_u32 s59, s56, 73728
    buffer_load_dwordx4 v22, s[16:19], s59 offen lds
    s_add_u32 m0, s55, 37888
    s_add_u32 s59, s56, 81920
    buffer_load_dwordx4 v22, s[16:19], s59 offen lds
    s_add_u32 m0, s55, 38912
    s_add_u32 s59, s56, 90112
    buffer_load_dwordx4 v22, s[16:19], s59 offen lds
    s_add_u32 m0, s55, 39936
    s_add_u32 s59, s56, 98304
    buffer_load_dwordx4 v22, s[16:19], s59 offen lds
    s_add_u32 m0, s55, 40960
    s_add_u32 s59, s56, 106496
    buffer_load_dwordx4 v22, s[16:19], s59 offen lds
    s_add_u32 m0, s55, 41984
    s_add_u32 s59, s56, 114688
    buffer_load_dwordx4 v22, s[16:19], s59 offen lds
    s_add_u32 m0, s55, 43008
    s_add_u32 s59, s56, 122880
    buffer_load_dwordx4 v22, s[16:19], s59 offen lds
    s_add_u32 m0, s55, 44032
    s_nop 0
    buffer_load_dwordx4 v22, s[16:19], s57 offen lds
    s_add_u32 m0, s55, 45056
    s_add_u32 s59, s57, 8192
    buffer_load_dwordx4 v22, s[16:19], s59 offen lds
    ds_read_b32 v15, v10
    s_waitcnt lgkmcnt(0)
L_pc17:
    v_cmp_gt_u32 vcc, 4, v15
    s_and_b32 s60, vcc_lo, 240
    s_cbranch_scc0 L_pk17
    s_add_u32 s65, s65, 1
    s_sleep 1
    ds_read_b32 v15, v10
    s_cmp_gt_u32 s65, 1600000
    s_waitcnt lgkmcnt(0)
    s_cbranch_scc0 L_pc17
L_pk17:
    s_load_dword s8, s[24:25], s80 offset:0 glc
    s_load_dword s9, s[24:25], s80 offset:128 glc
    s_load_dword s10, s[24:25], s80 offset:1024 glc
    s_load_dword s11, s[24:25], s80 offset:1152 glc
    s_add_u32 m0, s55, 73728
    s_add_u32 s59, s57, 16384
    buffer_load_dwordx4 v22, s[16:19], s59 offen lds
    s_add_u32 m0, s55, 74752
    s_add_u32 s59, s57, 24576
    buffer_load_dwordx4 v22, s[16:19], s59 offen lds
    s_add_u32 m0, s55, 75776
    s_add_u32 s59, s56, 131072
    buffer_load_dwordx4 v22, s[16:19], s59 offen lds
    s_add_u32 m0, s55, 76800
    s_add_u32 s59, s56, 139264
    buffer_load_dwordx4 v22, s[16:19], s59 offen lds
    s_add_u32 m0, s55, 77824
    s_add_u32 s59, s56, 147456
    buffer_load_dwordx4 v22, s[16:19], s59 offen lds
    s_add_u32 m0, s55, 78848
    s_add_u32 s59, s56, 155648
    buffer_load_dwordx4 v22, s[16:19], s59 offen lds
    s_add_u32 m0, s55, 79872
    s_add_u32 s59, s56, 163840
    buffer_load_dwordx4 v22, s[16:19], s59 offen lds
    s_add_u32 m0, s55, 80896
    s_add_u32 s59, s56, 172032
    buffer_load_dwordx4 v22, s[16:19], s59 offen lds
    s_add_u32 m0, s55, 81920
    s_add_u32 s59, s56, 180224
    buffer_load_dwordx4 v22, s[16:19], s59 offen lds
    s_mov_b32 s12, 0
L_fc18:
    s_waitcnt lgkmcnt(0)
    s_xor_b32 s8, s8, s64
    s_xor_b32 s9, s9, s64
    s_xor_b32 s10, s10, s64
    s_xor_b32 s11, s11, s64
    s_or_b32 s8, s8, s10
    s_or_b32 s9, s9, s11
    s_or_b32 s8, s8, s9
    s_cbranch_scc0 L_fk18
    s_add_u32 s12, s12, 1
    s_sleep 1
    s_load_dword s8, s[24:25], s80 offset:0 glc
    s_load_dword s9, s[24:25], s80 offset:128 glc
    s_load_dword s10, s[24:25], s80 offset:1024 glc
    s_load_dword s11, s[24:25], s80 offset:1152 glc
    s_cmp_gt_u32 s12, 20
    s_cbranch_scc0 L_fc18
    s_branch L_fv18
L_fk18:
    s_waitcnt vmcnt(9)
    v_mov_b32 v12, 6
    ds_write_b32 v11, v12
    s_add_u32 s59, s78, 0
    buffer_load_dwordx4 v[112:115], v2, s[24:27], s59 offen offset:0 sc1
    s_add_u32 s59, s78, 12288
    buffer_load_dwordx4 v[116:119], v2, s[24:27], s59 offen offset:2048 sc1
    s_add_u32 s59, s78, 0
    buffer_load_dwordx4 v[120:123], v2, s[24:27], s59 offen offset:1024 sc1
    s_add_u32 s59, s78, 12288
    buffer_load_dwordx4 v[124:127], v2, s[24:27], s59 offen offset:3072 sc1
    s_add_u32 s59, s78, 0
    buffer_load_dwordx4 v[128:131], v2, s[24:27], s59 offen offset:2048 sc1
    s_add_u32 s59, s78, 16384
    buffer_load_dwordx4 v[132:135], v2, s[24:27], s59 offen offset:0 sc1
    s_add_u32 s59, s78, 0
    buffer_load_dwordx4 v[136:139], v2, s[24:27], s59 offen offset:3072 sc1
    s_add_u32 s59, s78, 16384
    buffer_load_dwordx4 v[140:143], v2, s[24:27], s59 offen offset:1024 sc1
    s_add_u32 s59, s78, 4096
    buffer_load_dwordx4 v[144:147], v2, s[24:27], s59 offen offset:0 sc1
    s_add_u32 s59, s78, 16384
    buffer_load_dwordx4 v[148:151], v2, s[24:27], s59 offen offset:2048 sc1
    s_add_u32 s59, s78, 4096
    buffer_load_dwordx4 v[152:155], v2, s[24:27], s59 offen offset:1024 sc1
    s_add_u32 s59, s78, 16384
    buffer_load_dwordx4 v[156:159], v2, s[24:27], s59 offen offset:3072 sc1
    s_add_u32 s59, s78, 4096
    buffer_load_dwordx4 v[160:163], v2, s[24:27], s59 offen offset:2048 sc1
    s_add_u32 s59, s78, 20480
    buffer_load_dwordx4 v[164:167], v2, s[24:27], s59 offen offset:0 sc1
    s_add_u32 s59, s78, 4096
    buffer_load_dwordx4 v[168:171], v2, s[24:27], s59 offen offset:3072 sc1
    s_add_u32 s59, s78, 20480
    buffer_load_dwordx4 v[172:175], v2, s[24:27], s59 offen offset:1024 sc1
    ds_read_b32 v15, v10
    s_waitcnt lgkmcnt(0)
L_pc19:
    v_cmp_gt_u32 vcc, 5, v15
    s_and_b32 s60, vcc_lo, 240
    s_cbranch_scc0 L_pk19
    s_add_u32 s65, s65, 1
    s_sleep 1
    ds_read_b32 v15, v10
    s_cmp_gt_u32 s65, 1600000
    s_waitcnt lgkmcnt(0)
    s_cbranch_scc0 L_pc19
L_pk19:
    s_add_u32 m0, s55, 110592
    s_add_u32 s59, s56, 188416
    buffer_load_dwordx4 v22, s[16:19], s59 offen lds
    s_add_u32 m0, s55, 111616
    s_nop 0
    buffer_load_dwordx4 v22, s[20:23], s58 offen lds
    s_add_u32 m0, s55, 112640
    s_add_u32 s59, s58, 8192
    buffer_load_dwordx4 v22, s[20:23], s59 offen lds
    s_add_u32 m0, s55, 113664
    s_add_u32 s59, s58, 16384
    buffer_load_dwordx4 v22, s[20:23], s59 offen lds
    s_add_u32 m0, s55, 114688
    s_add_u32 s59, s58, 24576
    buffer_load_dwordx4 v22, s[20:23], s59 offen lds
    s_add_u32 m0, s55, 115712
    s_add_u32 s59, s58, 32768
    buffer_load_dwordx4 v22, s[20:23], s59 offen lds
    s_add_u32 m0, s55, 116736
    s_add_u32 s59, s58, 40960
    buffer_load_dwordx4 v22, s[20:23], s59 offen lds
    s_add_u32 m0, s55, 117760
    s_add_u32 s59, s58, 49152
    buffer_load_dwordx4 v22, s[20:23], s59 offen lds
    s_add_u32 m0, s55, 118784
    s_add_u32 s59, s58, 57344
    buffer_load_dwordx4 v22, s[20:23], s59 offen lds
    s_setprio 1
    s_sub_u32 s13, s82, 0xd00000
    s_lshr_b32 s13, s13, 5
    s_add_u32 s13, s13, 0xc80000
    s_lshl_b32 s14, s64, 11
    s_and_b32 s14, s14, 0xffff0000
    ds_read_b32 v15, v10
    s_waitcnt lgkmcnt(0)
L_pc20:
    v_cmp_gt_u32 vcc, 6, v15
    s_and_b32 s60, vcc_lo, 15
    s_cbranch_scc0 L_pk20
    s_add_u32 s65, s65, 1
    s_sleep 1
    ds_read_b32 v15, v10
    s_cmp_gt_u32 s65, 1600000
    s_waitcnt lgkmcnt(0)
    s_cbranch_scc0 L_pc20
L_pk20:
    ds_read_b64_tr_b16 v[80:81], v3 offset:0
    ds_read_b64_tr_b16 v[82:83], v3 offset:1024
    ds_read_b64_tr_b16 v[84:85], v4 offset:0
    ds_read_b64_tr_b16 v[86:87], v4 offset:1024
    ds_read_b64_tr_b16 v[88:89], v3 offset:9216
    ds_read_b64_tr_b16 v[90:91], v3 offset:10240
    ds_read_b64_tr_b16 v[92:93], v4 offset:9216
    ds_read_b64_tr_b16 v[94:95], v4 offset:10240
    ds_read_b64_tr_b16 v[96:97], v3 offset:2048
    ds_read_b64_tr_b16 v[98:99], v3 offset:3072
    ds_read_b64_tr_b16 v[100:101], v4 offset:2048
    ds_read_b64_tr_b16 v[102:103], v4 offset:3072
    ds_read_b64_tr_b16 v[104:105], v3 offset:11264
    ds_read_b64_tr_b16 v[106:107], v3 offset:12288
    ds_read_b64_tr_b16 v[108:109], v4 offset:11264
    ds_read_b64_tr_b16 v[110:111], v4 offset:12288
    s_xor_b32 s60, s40, 2
    s_lshl_b32 s83, 1, s60
    v_add_u32 v5, s55, v2
    s_waitcnt vmcnt(24)
    s_waitcnt lgkmcnt(12)
    v_mfma_f32_32x32x16_bf16 v[16:31], v[80:83], v[112:115], 0
    v_mfma_f32_32x32x16_bf16 v[32:47], v[84:87], v[112:115], 0
    s_waitcnt vmcnt(23)
    s_waitcnt lgkmcnt(8)
    v_mfma_f32_32x32x16_bf16 v[16:31], v[88:91], v[116:119], v[16:31]
    ds_read_b64_tr_b16 v[80:81], v3 offset:4096
    ds_read_b64_tr_b16 v[82:83], v3 offset:5120
    v_mfma_f32_32x32x16_bf16 v[32:47], v[92:95], v[116:119], v[32:47]
    ds_read_b64_tr_b16 v[84:85], v4 offset:4096
    ds_read_b64_tr_b16 v[86:87], v4 offset:5120
    s_waitcnt vmcnt(22)
    s_waitcnt lgkmcnt(8)
    v_mfma_f32_32x32x16_bf16 v[16:31], v[96:99], v[120:123], v[16:31]
    ds_read_b64_tr_b16 v[88:89], v3 offset:13312
    ds_read_b64_tr_b16 v[90:91], v3 offset:14336
    v_mfma_f32_32x32x16_bf16 v[32:47], v[100:103], v[120:123], v[32:47]
    ds_read_b64_tr_b16 v[92:93], v4 offset:13312
    ds_read_b64_tr_b16 v[94:95], v4 offset:14336
    s_waitcnt vmcnt(21)
    s_waitcnt lgkmcnt(8)
    v_mfma_f32_32x32x16_bf16 v[16:31], v[104:107], v[124:127], v[16:31]
    ds_read_b64_tr_b16 v[96:97], v3 offset:6144
    ds_read_b64_tr_b16 v[98:99], v3 offset:7168
    v_mfma_f32_32x32x16_bf16 v[32:47], v[108:111], v[124:127], v[32:47]
    ds_read_b64_tr_b16 v[100:101], v4 offset:6144
    ds_read_b64_tr_b16 v[102:103], v4 offset:7168
    s_waitcnt vmcnt(20)
    s_waitcnt lgkmcnt(8)
    v_mfma_f32_32x32x16_bf16 v[16:31], v[80:83], v[128:131], v[16:31]
    ds_read_b64_tr_b16 v[104:105], v3 offset:15360
    ds_read_b64_tr_b16 v[106:107], v3 offset:16384
    v_mfma_f32_32x32x16_bf16 v[32:47], v[84:87], v[128:131], v[32:47]
    ds_read_b64_tr_b16 v[108:109], v4 offset:15360
    ds_read_b64_tr_b16 v[110:111], v4 offset:16384
    s_waitcnt vmcnt(19)
    s_waitcnt lgkmcnt(8)
    v_mfma_f32_32x32x16_bf16 v[16:31], v[88:91], v[132:135], v[16:31]
    ds_read_b64_tr_b16 v[80:81], v3 offset:8192
    ds_read_b64_tr_b16 v[82:83], v3 offset:36864
    v_mfma_f32_32x32x16_bf16 v[32:47], v[92:95], v[132:135], v[32:47]
    ds_read_b64_tr_b16 v[84:85], v4 offset:8192
    ds_read_b64_tr_b16 v[86:87], v4 offset:36864
    s_waitcnt vmcnt(18)
    s_waitcnt lgkmcnt(8)
    v_mfma_f32_32x32x16_bf16 v[16:31], v[96:99], v[136:139], v[16:31]
    ds_read_b64_tr_b16 v[88:89], v3 offset:17408
    ds_read_b64_tr_b16 v[90:91], v3 offset:46080
    v_mfma_f32_32x32x16_bf16 v[32:47], v[100:103], v[136:139], v[32:47]
    ds_read_b64_tr_b16 v[92:93], v4 offset:17408
    ds_read_b64_tr_b16 v[94:95], v4 offset:46080
    s_waitcnt vmcnt(17)
    s_waitcnt lgkmcnt(8)
    v_mfma_f32_32x32x16_bf16 v[16:31], v[104:107], v[140:143], v[16:31]
    ds_read_b64_tr_b16 v[96:97], v3 offset:37888
    ds_read_b64_tr_b16 v[98:99], v3 offset:38912
    v_mfma_f32_32x32x16_bf16 v[32:47], v[108:111], v[140:143], v[32:47]
    ds_read_b64_tr_b16 v[100:101], v4 offset:37888
    ds_read_b64_tr_b16 v[102:103], v4 offset:38912
    s_waitcnt vmcnt(16)
    s_waitcnt lgkmcnt(8)
    v_mfma_f32_32x32x16_bf16 v[16:31], v[80:83], v[144:147], v[16:31]
    ds_read_b64_tr_b16 v[104:105], v3 offset:47104
    ds_read_b64_tr_b16 v[106:107], v3 offset:48128
    v_mfma_f32_32x32x16_bf16 v[32:47], v[84:87], v[144:147], v[32:47]
    ds_read_b64_tr_b16 v[108:109], v4 offset:47104
    ds_read_b64_tr_b16 v[110:111], v4 offset:48128
    s_waitcnt vmcnt(15)
    s_waitcnt lgkmcnt(8)
    v_mfma_f32_32x32x16_bf16 v[16:31], v[88:91], v[148:151], v[16:31]
    ds_read_b64_tr_b16 v[80:81], v3 offset:39936
    ds_read_b64_tr_b16 v[82:83], v3 offset:40960
    v_mfma_f32_32x32x16_bf16 v[32:47], v[92:95], v[148:151], v[32:47]
    ds_read_b64_tr_b16 v[84:85], v4 offset:39936
    ds_read_b64_tr_b16 v[86:87], v4 offset:40960
    s_waitcnt vmcnt(14)
    s_waitcnt lgkmcnt(8)
    v_mfma_f32_32x32x16_bf16 v[16:31], v[96:99], v[152:155], v[16:31]
    ds_read_b64_tr_b16 v[88:89], v3 offset:49152
    ds_read_b64_tr_b16 v[90:91], v3 offset:50176
    v_mfma_f32_32x32x16_bf16 v[32:47], v[100:103], v[152:155], v[32:47]
    ds_read_b64_tr_b16 v[92:93], v4 offset:49152
    ds_read_b64_tr_b16 v[94:95], v4 offset:50176
    s_load_dword s8, s[24:25], s80 offset:384 glc
    s_load_dword s9, s[24:25], s80 offset:1408 glc
    s_waitcnt vmcnt(13)
    s_waitcnt lgkmcnt(8)
    s_waitcnt vmcnt(0)
    v_mov_b32 v12, 9
    ds_write_b32 v11, v12
    v_mfma_f32_32x32x16_bf16 v[16:31], v[104:107], v[156:159], v[16:31]
    ds_read_b64_tr_b16 v[96:97], v3 offset:41984
    ds_read_b64_tr_b16 v[98:99], v3 offset:43008
    v_mfma_f32_32x32x16_bf16 v[32:47], v[108:111], v[156:159], v[32:47]
    ds_read_b64_tr_b16 v[100:101], v4 offset:41984
    ds_read_b64_tr_b16 v[102:103], v4 offset:43008
    s_mov_b32 s12, 0
L_fc21:
    s_waitcnt lgkmcnt(0)
    s_xor_b32 s8, s8, s64
    s_xor_b32 s9, s9, s64
    s_or_b32 s8, s8, s9
    s_cbranch_scc0 L_fk21
    s_add_u32 s12, s12, 1
    s_sleep 1
    s_load_dword s8, s[24:25], s80 offset:384 glc
    s_load_dword s9, s[24:25], s80 offset:1408 glc
    s_cmp_gt_u32 s12, 20
    s_cbranch_scc0 L_fc21
    s_branch L_fv21
L_fk21:
    s_add_u32 s59, s78, 8192
    buffer_load_dwordx4 v[176:179], v2, s[24:27], s59 offen offset:0 sc1
    s_add_u32 s59, s78, 20480
    buffer_load_dwordx4 v[180:183], v2, s[24:27], s59 offen offset:2048 sc1
    s_add_u32 s59, s78, 8192
    buffer_load_dwordx4 v[184:187], v2, s[24:27], s59 offen offset:1024 sc1
    s_add_u32 s59, s78, 20480
    buffer_load_dwordx4 v[188:191], v2, s[24:27], s59 offen offset:3072 sc1
    s_add_u32 s59, s78, 8192
    buffer_load_dwordx4 v[192:195], v2, s[24:27], s59 offen offset:2048 sc1
    s_add_u32 s59, s78, 24576
    buffer_load_dwordx4 v[196:199], v2, s[24:27], s59 offen offset:0 sc1
    s_add_u32 s59, s78, 8192
    buffer_load_dwordx4 v[200:203], v2, s[24:27], s59 offen offset:3072 sc1
    v_mfma_f32_32x32x16_bf16 v[16:31], v[80:83], v[160:163], v[16:31]
    ds_read_b64_tr_b16 v[104:105], v3 offset:51200
    ds_read_b64_tr_b16 v[106:107], v3 offset:52224
    s_add_u32 s59, s78, 24576
    buffer_load_dwordx4 v[204:207], v2, s[24:27], s59 offen offset:1024 sc1
    v_mfma_f32_32x32x16_bf16 v[32:47], v[84:87], v[160:163], v[32:47]
    ds_read_b64_tr_b16 v[108:109], v4 offset:51200
    ds_read_b64_tr_b16 v[110:111], v4 offset:52224
    v_mfma_f32_32x32x16_bf16 v[16:31], v[88:91], v[164:167], v[16:31]
    ds_read_b64_tr_b16 v[80:81], v3 offset:44032
    ds_read_b64_tr_b16 v[82:83], v3 offset:45056
    s_add_u32 s59, s78, 12288
    buffer_load_dwordx4 v[208:211], v2, s[24:27], s59 offen offset:0 sc1
    v_mfma_f32_32x32x16_bf16 v[32:47], v[92:95], v[164:167], v[32:47]
    ds_read_b64_tr_b16 v[84:85], v4 offset:44032
    ds_read_b64_tr_b16 v[86:87], v4 offset:45056
    ds_read_b32 v15, v10
    v_mfma_f32_32x32x16_bf16 v[16:31], v[96:99], v[168:171], v[16:31]
    ds_read_b64_tr_b16 v[88:89], v3 offset:53248
    ds_read_b64_tr_b16 v[90:91], v3 offset:54272
    s_add_u32 s59, s78, 24576
    buffer_load_dwordx4 v[212:215], v2, s[24:27], s59 offen offset:2048 sc1
    v_mfma_f32_32x32x16_bf16 v[32:47], v[100:103], v[168:171], v[32:47]
    ds_read_b64_tr_b16 v[92:93], v4 offset:53248
    ds_read_b64_tr_b16 v[94:95], v4 offset:54272
    s_waitcnt lgkmcnt(4)
L_pc22:
    v_cmp_gt_u32 vcc, 9, v15
    s_and_b32 s60, vcc_lo, 15
    s_cbranch_scc0 L_pk22
    s_add_u32 s65, s65, 1
    s_sleep 1
    ds_read_b32 v15, v10
    s_cmp_gt_u32 s65, 1600000
    s_waitcnt lgkmcnt(0)
    s_cbranch_scc0 L_pc22
L_pk22:
    v_mfma_f32_32x32x16_bf16 v[16:31], v[104:107], v[172:175], v[16:31]
    v_add_u32 v3, 73728, v3
    v_add_u32 v4, 73728, v4
    ds_read_b64_tr_b16 v[96:97], v3 offset:0
    s_add_u32 s59, s78, 12288
    buffer_load_dwordx4 v[216:219], v2, s[24:27], s59 offen offset:1024 sc1
    v_mfma_f32_32x32x16_bf16 v[32:47], v[108:111], v[172:175], v[32:47]
    ds_read_b64_tr_b16 v[98:99], v3 offset:1024
    ds_read_b64_tr_b16 v[100:101], v4 offset:0
    ds_read_b64_tr_b16 v[102:103], v4 offset:1024
    s_waitcnt vmcnt(10)
    v_mfma_f32_32x32x16_bf16 v[16:31], v[80:83], v[176:179], v[16:31]
    ds_read_b64_tr_b16 v[104:105], v3 offset:9216
    ds_read_b64_tr_b16 v[106:107], v3 offset:10240
    s_add_u32 s59, s78, 24576
    buffer_load_dwordx4 v[220:223], v2, s[24:27], s59 offen offset:3072 sc1
    v_mfma_f32_32x32x16_bf16 v[32:47], v[84:87], v[176:179], v[32:47]
    ds_read_b64_tr_b16 v[108:109], v4 offset:9216
    ds_read_b64_tr_b16 v[110:111], v4 offset:10240
    s_load_dword s8, s[24:25], s80 offset:512 glc
    s_load_dword s9, s[24:25], s80 offset:1536 glc
    s_waitcnt vmcnt(10)
    s_waitcnt lgkmcnt(8)
    v_mfma_f32_32x32x16_bf16 v[16:31], v[88:91], v[180:183], v[16:31]
    ds_read_b64_tr_b16 v[80:81], v3 offset:2048
    ds_read_b64_tr_b16 v[82:83], v3 offset:3072
    v_mfma_f32_32x32x16_bf16 v[32:47], v[92:95], v[180:183], v[32:47]
    ds_read_b64_tr_b16 v[84:85], v4 offset:2048
    ds_read_b64_tr_b16 v[86:87], v4 offset:3072
    s_mov_b32 s12, 0
L_fc23:
    s_waitcnt lgkmcnt(0)
    s_xor_b32 s8, s8, s64
    s_xor_b32 s9, s9, s64
    s_or_b32 s8, s8, s9
    s_cbranch_scc0 L_fk23
    s_add_u32 s12, s12, 1
    s_sleep 1
    s_load_dword s8, s[24:25], s80 offset:512 glc
    s_load_dword s9, s[24:25], s80 offset:1536 glc
    s_cmp_gt_u32 s12, 20
    s_cbranch_scc0 L_fc23
    s_branch L_fv23
L_fk23:
    v_and_b32 v14, 31, v1
    v_lshlrev_b32 v14, 2, v14
    buffer_load_dword v9, v14, s[24:27], s81 offen sc1
    s_add_u32 s59, s79, 0
    buffer_load_dwordx4 v[224:227], v2, s[24:27], s59 offen offset:0 sc1
    s_waitcnt vmcnt(11)
    v_mfma_f32_32x32x16_bf16 v[16:31], v[96:99], v[184:187], v[16:31]
    ds_read_b64_tr_b16 v[88:89], v3 offset:11264
    ds_read_b64_tr_b16 v[90:91], v3 offset:12288
    s_add_u32 s59, s79, 4096
    buffer_load_dwordx4 v[228:231], v2, s[24:27], s59 offen offset:0 sc1
    v_mfma_f32_32x32x16_bf16 v[32:47], v[100:103], v[184:187], v[32:47]
    ds_read_b64_tr_b16 v[92:93], v4 offset:11264
    ds_read_b64_tr_b16 v[94:95], v4 offset:12288
    s_waitcnt vmcnt(11)
    v_mfma_f32_32x32x16_bf16 v[16:31], v[104:107], v[188:191], v[16:31]
    ds_read_b64_tr_b16 v[96:97], v3 offset:4096
    ds_read_b64_tr_b16 v[98:99], v3 offset:5120
    s_add_u32 s59, s79, 0
    buffer_load_dwordx4 v[232:235], v2, s[24:27], s59 offen offset:1024 sc1
    v_mfma_f32_32x32x16_bf16 v[32:47], v[108:111], v[188:191], v[32:47]
    ds_read_b64_tr_b16 v[100:101], v4 offset:4096
    ds_read_b64_tr_b16 v[102:103], v4 offset:5120
    s_waitcnt vmcnt(11)
    v_mfma_f32_32x32x16_bf16 v[16:31], v[80:83], v[192:195], v[16:31]
    ds_read_b64_tr_b16 v[104:105], v3 offset:13312
    ds_read_b64_tr_b16 v[106:107], v3 offset:14336
    s_add_u32 s59, s79, 4096
    buffer_load_dwordx4 v[236:239], v2, s[24:27], s59 offen offset:1024 sc1
    v_mfma_f32_32x32x16_bf16 v[32:47], v[84:87], v[192:195], v[32:47]
    ds_read_b64_tr_b16 v[108:109], v4 offset:13312
    ds_read_b64_tr_b16 v[110:111], v4 offset:14336
    s_waitcnt vmcnt(11)
    s_waitcnt lgkmcnt(8)
    v_mfma_f32_32x32x16_bf16 v[16:31], v[88:91], v[196:199], v[16:31]
    ds_read_b64_tr_b16 v[80:81], v3 offset:6144
    ds_read_b64_tr_b16 v[82:83], v3 offset:7168
    s_add_u32 s59, s79, 0
    buffer_load_dwordx4 v[240:243], v2, s[24:27], s59 offen offset:2048 sc1
    v_mfma_f32_32x32x16_bf16 v[32:47], v[92:95], v[196:199], v[32:47]
    ds_read_b64_tr_b16 v[84:85], v4 offset:6144
    ds_read_b64_tr_b16 v[86:87], v4 offset:7168
    s_waitcnt vmcnt(11)
    s_waitcnt lgkmcnt(8)
    v_mfma_f32_32x32x16_bf16 v[16:31], v[96:99], v[200:203], v[16:31]
    ds_read_b64_tr_b16 v[88:89], v3 offset:15360
    ds_read_b64_tr_b16 v[90:91], v3 offset:16384
    s_add_u32 s59, s79, 4096
    buffer_load_dwordx4 v[244:247], v2, s[24:27], s59 offen offset:2048 sc1
    v_mfma_f32_32x32x16_bf16 v[32:47], v[100:103], v[200:203], v[32:47]
    ds_read_b64_tr_b16 v[92:93], v4 offset:15360
    ds_read_b64_tr_b16 v[94:95], v4 offset:16384
    s_waitcnt vmcnt(11)
    s_waitcnt lgkmcnt(8)
    v_mfma_f32_32x32x16_bf16 v[16:31], v[104:107], v[204:207], v[16:31]
    ds_read_b64_tr_b16 v[96:97], v3 offset:8192
    ds_read_b64_tr_b16 v[98:99], v3 offset:36864
    s_add_u32 s59, s79, 0
    buffer_load_dwordx4 v[248:251], v2, s[24:27], s59 offen offset:3072 sc1
    v_mfma_f32_32x32x16_bf16 v[32:47], v[108:111], v[204:207], v[32:47]
    ds_read_b64_tr_b16 v[100:101], v4 offset:8192
    ds_read_b64_tr_b16 v[102:103], v4 offset:36864
    s_waitcnt vmcnt(11)
    s_waitcnt lgkmcnt(8)
    v_mfma_f32_32x32x16_bf16 v[16:31], v[80:83], v[208:211], v[16:31]
    ds_read_b64_tr_b16 v[104:105], v3 offset:17408
    ds_read_b64_tr_b16 v[106:107], v3 offset:46080
    s_add_u32 s59, s79, 4096
    buffer_load_dwordx4 v[252:255], v2, s[24:27], s59 offen offset:3072 sc1
    v_mfma_f32_32x32x16_bf16 v[32:47], v[84:87], v[208:211], v[32:47]
    ds_read_b64_tr_b16 v[108:109], v4 offset:17408
    ds_read_b64_tr_b16 v[110:111], v4 offset:46080
    s_waitcnt vmcnt(11)
    s_waitcnt lgkmcnt(8)
    v_mfma_f32_32x32x16_bf16 v[16:31], v[88:91], v[212:215], v[16:31]
    ds_read_b64_tr_b16 v[80:81], v3 offset:37888
    ds_read_b64_tr_b16 v[82:83], v3 offset:38912
    v_mfma_f32_32x32x16_bf16 v[32:47], v[92:95], v[212:215], v[32:47]
    ds_read_b64_tr_b16 v[84:85], v4 offset:37888
    ds_read_b64_tr_b16 v[86:87], v4 offset:38912
    s_waitcnt vmcnt(10)
    s_waitcnt lgkmcnt(8)
    v_mfma_f32_32x32x16_bf16 v[16:31], v[96:99], v[216:219], v[16:31]
    ds_read_b64_tr_b16 v[88:89], v3 offset:47104
    ds_read_b64_tr_b16 v[90:91], v3 offset:48128
    v_mfma_f32_32x32x16_bf16 v[32:47], v[100:103], v[216:219], v[32:47]
    ds_read_b64_tr_b16 v[92:93], v4 offset:47104
    ds_read_b64_tr_b16 v[94:95], v4 offset:48128
    s_waitcnt vmcnt(9)
    s_waitcnt lgkmcnt(8)
    v_mfma_f32_32x32x16_bf16 v[16:31], v[104:107], v[220:223], v[16:31]
    ds_read_b64_tr_b16 v[96:97], v3 offset:39936
    ds_read_b64_tr_b16 v[98:99], v3 offset:40960
    v_mfma_f32_32x32x16_bf16 v[32:47], v[108:111], v[220:223], v[32:47]
    ds_read_b64_tr_b16 v[100:101], v4 offset:39936
    ds_read_b64_tr_b16 v[102:103], v4 offset:40960
    s_waitcnt vmcnt(7)
    s_waitcnt lgkmcnt(8)
    v_mfma_f32_32x32x16_bf16 v[48:63], v[80:83], v[224:227], 0
    ds_read_b64_tr_b16 v[104:105], v3 offset:49152
    ds_read_b64_tr_b16 v[106:107], v3 offset:50176
    v_mfma_f32_32x32x16_bf16 v[64:79], v[84:87], v[224:227], 0
    ds_read_b64_tr_b16 v[108:109], v4 offset:49152
    ds_read_b64_tr_b16 v[110:111], v4 offset:50176
    s_xor_b32 s60, s41, 2
    s_mul_i32 s60, s60, 9216
    v_add_u32 v6, s60, v2
    s_waitcnt vmcnt(6)
    s_waitcnt lgkmcnt(8)
    v_mfma_f32_32x32x16_bf16 v[48:63], v[88:91], v[228:231], v[48:63]
    ds_read_b64_tr_b16 v[80:81], v3 offset:41984
    ds_read_b64_tr_b16 v[82:83], v3 offset:43008
    v_sub_f32 v8, 1.0, v9
    v_cvt_pk_bf16_f32 v8, v8, v8
    v_mfma_f32_32x32x16_bf16 v[64:79], v[92:95], v[228:231], v[64:79]
    ds_read_b64_tr_b16 v[84:85], v4 offset:41984
    ds_read_b64_tr_b16 v[86:87], v4 offset:43008
    v_and_b32 v8, 0xffff0000, v8
    v_mul_f32 v16, v16, v8
    v_mul_f32 v17, v17, v8
    s_waitcnt vmcnt(5)
    s_waitcnt lgkmcnt(8)
    v_mfma_f32_32x32x16_bf16 v[48:63], v[96:99], v[232:235], v[48:63]
    ds_read_b64_tr_b16 v[88:89], v3 offset:51200
    ds_read_b64_tr_b16 v[90:91], v3 offset:52224
    v_mul_f32 v18, v18, v8
    v_mul_f32 v19, v19, v8
    v_mul_f32 v20, v20, v8
    v_mfma_f32_32x32x16_bf16 v[64:79], v[100:103], v[232:235], v[64:79]
    ds_read_b64_tr_b16 v[92:93], v4 offset:51200
    ds_read_b64_tr_b16 v[94:95], v4 offset:52224
    v_mul_f32 v21, v21, v8
    v_mul_f32 v22, v22, v8
    v_mul_f32 v23, v23, v8
    s_waitcnt vmcnt(4)
    s_waitcnt lgkmcnt(8)
    v_mfma_f32_32x32x16_bf16 v[48:63], v[104:107], v[236:239], v[48:63]
    ds_read_b64_tr_b16 v[96:97], v3 offset:44032
    ds_read_b64_tr_b16 v[98:99], v3 offset:45056
    v_mul_f32 v24, v24, v8
    v_mul_f32 v25, v25, v8
    v_mul_f32 v26, v26, v8
    v_mfma_f32_32x32x16_bf16 v[64:79], v[108:111], v[236:239], v[64:79]
    ds_read_b64_tr_b16 v[100:101], v4 offset:44032
    ds_read_b64_tr_b16 v[102:103], v4 offset:45056
    v_mul_f32 v27, v27, v8
    v_mul_f32 v28, v28, v8
    v_mul_f32 v29, v29, v8
    s_waitcnt vmcnt(3)
    s_waitcnt lgkmcnt(8)
    v_mfma_f32_32x32x16_bf16 v[48:63], v[80:83], v[240:243], v[48:63]
    ds_read_b64_tr_b16 v[104:105], v3 offset:53248
    ds_read_b64_tr_b16 v[106:107], v3 offset:54272
    v_mul_f32 v30, v30, v8
    v_mul_f32 v31, v31, v8
    v_mul_f32 v32, v32, v8
    v_mfma_f32_32x32x16_bf16 v[64:79], v[84:87], v[240:243], v[64:79]
    ds_read_b64_tr_b16 v[108:109], v4 offset:53248
    ds_read_b64_tr_b16 v[110:111], v4 offset:54272
    v_mul_f32 v33, v33, v8
    v_mul_f32 v34, v34, v8
    v_mul_f32 v35, v35, v8
    s_waitcnt vmcnt(2)
    s_waitcnt lgkmcnt(8)
    v_mfma_f32_32x32x16_bf16 v[48:63], v[88:91], v[244:247], v[48:63]
    v_mul_f32 v36, v36, v8
    v_mul_f32 v37, v37, v8
    v_mul_f32 v38, v38, v8
    v_mfma_f32_32x32x16_bf16 v[64:79], v[92:95], v[244:247], v[64:79]
    v_mul_f32 v39, v39, v8
    v_mul_f32 v40, v40, v8
    v_mul_f32 v41, v41, v8
    s_waitcnt vmcnt(1)
    s_waitcnt lgkmcnt(4)
    v_mfma_f32_32x32x16_bf16 v[48:63], v[96:99], v[248:251], v[48:63]
    v_mul_f32 v42, v42, v8
    v_mul_f32 v43, v43, v8
    v_mul_f32 v44, v44, v8
    v_mfma_f32_32x32x16_bf16 v[64:79], v[100:103], v[248:251], v[64:79]
    v_mul_f32 v45, v45, v8
    v_mul_f32 v46, v46, v8
    v_mul_f32 v47, v47, v8
    ds_read_b32 v15, v10
    s_waitcnt vmcnt(0)
    s_waitcnt lgkmcnt(1)
    v_mfma_f32_32x32x16_bf16 v[48:63], v[104:107], v[252:255], v[48:63]
    v_mfma_f32_32x32x16_bf16 v[64:79], v[108:111], v[252:255], v[64:79]
    s_waitcnt lgkmcnt(0)
L_pc24:
    v_cmp_gt_u32 vcc, 8, v15
    s_and_b32 s60, vcc_lo, 255
    s_cbranch_scc0 L_pk24
    s_add_u32 s65, s65, 1
    s_sleep 1
    ds_read_b32 v15, v10
    s_cmp_gt_u32 s65, 1600000
    s_waitcnt lgkmcnt(0)
    s_cbranch_scc0 L_pc24
L_pk24:
    s_nop 9
    v_fma_f32 v16, v48, v9, v16
    v_fma_f32 v17, v49, v9, v17
    v_fma_f32 v18, v50, v9, v18
    v_fma_f32 v19, v51, v9, v19
    ds_write_b128 v5, v[16:19] offset:0
    v_fma_f32 v20, v52, v9, v20
    v_fma_f32 v21, v53, v9, v21
    v_fma_f32 v22, v54, v9, v22
    v_fma_f32 v23, v55, v9, v23
    ds_write_b128 v5, v[20:23] offset:1024
    v_fma_f32 v24, v56, v9, v24
    v_fma_f32 v25, v57, v9, v25
    v_fma_f32 v26, v58, v9, v26
    v_fma_f32 v27, v59, v9, v27
    ds_write_b128 v5, v[24:27] offset:2048
    v_fma_f32 v28, v60, v9, v28
    v_fma_f32 v29, v61, v9, v29
    v_fma_f32 v30, v62, v9, v30
    v_fma_f32 v31, v63, v9, v31
    ds_write_b128 v5, v[28:31] offset:3072
    v_mov_b32 v12, 10
    ds_write_b32 v11, v12
    v_fma_f32 v32, v64, v9, v32
    v_fma_f32 v33, v65, v9, v33
    v_fma_f32 v34, v66, v9, v34
    v_fma_f32 v35, v67, v9, v35
    v_fma_f32 v36, v68, v9, v36
    v_fma_f32 v37, v69, v9, v37
    v_fma_f32 v38, v70, v9, v38
    v_fma_f32 v39, v71, v9, v39
    v_fma_f32 v40, v72, v9, v40
    v_fma_f32 v41, v73, v9, v41
    v_fma_f32 v42, v74, v9, v42
    v_fma_f32 v43, v75, v9, v43
    v_fma_f32 v44, v76, v9, v44
    v_fma_f32 v45, v77, v9, v45
    v_fma_f32 v46, v78, v9, v46
    v_fma_f32 v47, v79, v9, v47
L_cb00:
    ds_read_b32 v15, v10
    ds_read_b128 v[48:51], v6 offset:0
    ds_read_b128 v[52:55], v6 offset:1024
    ds_read_b128 v[56:59], v6 offset:2048
    ds_read_b128 v[60:63], v6 offset:3072
    s_add_u32 s65, s65, 1
    s_cmp_gt_u32 s65, 1600000
    s_cbranch_scc1 L_cbk00
    s_waitcnt lgkmcnt(4)
    v_cmp_gt_u32 vcc, 10, v15
    s_and_b32 s60, vcc_lo, s83
    s_cbranch_scc1 L_cb00
L_cbk00:
    s_waitcnt lgkmcnt(3)
    v_add_f32 v32, v32, v48
    v_add_f32 v33, v33, v49
    v_add_f32 v34, v34, v50
    v_add_f32 v35, v35, v51
    v_cvt_pk_bf16_f32 v80, v32, v33
    v_cvt_pk_bf16_f32 v81, v34, v35
    v_xor_b32 v80, s14, v80
    v_xor_b32 v81, s14, v81
    s_waitcnt lgkmcnt(2)
    v_add_f32 v36, v36, v52
    v_add_f32 v37, v37, v53
    v_add_f32 v38, v38, v54
    v_add_f32 v39, v39, v55
    v_cvt_pk_bf16_f32 v82, v36, v37
    v_cvt_pk_bf16_f32 v83, v38, v39
    v_xor_b32 v82, s14, v82
    v_xor_b32 v83, s14, v83
    buffer_store_dwordx4 v[80:83], v2, s[24:27], s82 offen offset:0 sc1
    s_waitcnt lgkmcnt(1)
    v_add_f32 v40, v40, v56
    v_add_f32 v41, v41, v57
    v_add_f32 v42, v42, v58
    v_add_f32 v43, v43, v59
    v_cvt_pk_bf16_f32 v84, v40, v41
    v_cvt_pk_bf16_f32 v85, v42, v43
    v_xor_b32 v84, s14, v84
    v_xor_b32 v85, s14, v85
    s_waitcnt lgkmcnt(0)
    v_add_f32 v44, v44, v60
    v_add_f32 v45, v45, v61
    v_add_f32 v46, v46, v62
    v_add_f32 v47, v47, v63
    v_cvt_pk_bf16_f32 v86, v44, v45
    v_cvt_pk_bf16_f32 v87, v46, v47
    v_xor_b32 v86, s14, v86
    v_xor_b32 v87, s14, v87
    buffer_store_dwordx4 v[84:87], v2, s[24:27], s82 offen offset:1024 sc1
    v_mov_b32 v12, 11
    ds_write_b32 v11, v12
    s_waitcnt lgkmcnt(0)
    s_waitcnt vmcnt(0)
    buffer_store_dword v7, off, s[24:27], s13 sc1
    s_endpgm
L_fv18:
    s_waitcnt lgkmcnt(0)
    s_add_u32 s65, s65, 8
    s_cmp_gt_u32 s65, 1600000
    s_cbranch_scc1 L_fk18
    buffer_load_dword v8, v5, s[24:27], s80 offen sc1
    s_waitcnt vmcnt(0)
    v_cmp_ne_u32 vcc, s64, v8
    s_cbranch_vccz L_fk18
    s_sleep 1
    s_branch L_fv18
L_fv21:
    s_waitcnt lgkmcnt(0)
    s_add_u32 s65, s65, 8
    s_cmp_gt_u32 s65, 1600000
    s_cbranch_scc1 L_fk21
    buffer_load_dword v8, v6, s[24:27], s80 offen offset:384 sc1
    s_waitcnt vmcnt(0)
    v_cmp_ne_u32 vcc, s64, v8
    s_cbranch_vccz L_fk21
    s_sleep 1
    s_branch L_fv21
L_fv23:
    s_waitcnt lgkmcnt(0)
    s_add_u32 s65, s65, 8
    s_cmp_gt_u32 s65, 1600000
    s_cbranch_scc1 L_fk23
    buffer_load_dword v8, v6, s[24:27], s80 offen offset:512 sc1
    s_waitcnt vmcnt(0)
    v_cmp_ne_u32 vcc, s64, v8
    s_cbranch_vccz L_fk23
    s_sleep 1
    s_branch L_fv23
L_Ah:
    s_and_b32 s60, s2, 3
    s_lshl_b32 s60, s60, 5
    s_lshr_b32 s62, s2, 3
    s_add_u32 s60, s60, s62
    s_lshl_b32 s62, s45, 7
    s_add_u32 s62, s62, s60
    s_mov_b32 s91, 0x20000
    s_waitcnt lgkmcnt(0)
    s_cmp_lt_u32 s41, 2
    s_cbranch_scc0 L_pf2h
    s_cmp_eq_u32 s41, 0
    s_cbranch_scc0 L_pf1h
    v_lshrrev_b32 v27, 4, v1
    v_min_u32 v27, 2, v27
    s_add_u32 s61, s3, 3
    v_add_u32 v27, s61, v27
    v_and_b32 v27, 7, v27
    v_and_b32 v14, 7, v1
    v_lshl_add_u32 v27, v27, 6, v14
    v_mul_u32_u24 v27, 3584, v27
    v_bfe_u32 v14, v1, 3, 1
    v_lshl_add_u32 v27, v14, 7, v27
    s_and_b32 s61, s42, 7
    s_mul_i32 s53, s61, 28672
    s_mul_i32 s61, s43, 448
    s_add_u32 s61, s61, 64
    s_andn2_b32 s61, s61, 127
    s_add_u32 s53, s53, s61
    s_mov_b32 s88, s96
    s_mov_b32 s89, s97
    s_mov_b32 s90, 0x1c0000
    buffer_load_dword v200, v27, s[88:91], s53 offen
    s_lshl_b32 s53, s62, 11
    v_and_b32 v26, 15, v1
    v_lshlrev_b32 v26, 7, v26
    s_mov_b32 s88, s20
    s_mov_b32 s89, s21
    s_mov_b32 s90, 0x80000
    s_mov_b32 s52, 7
    s_branch L_pfeh
L_pf1h:
    s_mul_i32 s53, s60, 12288
    s_lshl_b32 s61, s45, 9
    s_add_u32 s53, s53, s61
    v_bfe_u32 v14, v1, 2, 2
    v_mul_u32_u24 v14, 3072, v14
    v_and_b32 v26, 3, v1
    v_lshl_add_u32 v26, v26, 7, v14
    s_mov_b32 s88, s94
    s_mov_b32 s89, s95
    s_mov_b32 s90, 0x180000
    s_mov_b32 s52, 4
    s_branch L_pfeh
L_pf2h:
    s_cmp_eq_u32 s41, 2
    s_cbranch_scc0 L_pf3h
    s_mul_i32 s53, s60, 14336
    s_mul_i32 s61, s45, 1792
    s_add_u32 s53, s53, s61
    v_bfe_u32 v14, v1, 3, 2
    v_mul_u32_u24 v14, 3584, v14
    v_and_b32 v26, 7, v1
    v_lshlrev_b32 v26, 2, v26
    s_mov_b32 s61, 0xddda9632
    v_bfe_u32 v26, s61, v26, 4
    v_lshl_add_u32 v26, v26, 7, v14
    s_mov_b32 s88, s96
    s_mov_b32 s89, s97
    s_mov_b32 s90, 0x1c0000
    s_mov_b32 s52, 4
    s_branch L_pfeh
L_pf3h:
    s_mul_i32 s53, s62, 7168
    v_min_u32 v26, 55, v1
    v_lshlrev_b32 v26, 7, v26
    s_mov_b32 s88, s4
    s_mov_b32 s89, s5
    s_mov_b32 s90, 0x1c0000
    s_mov_b32 s52, 3
L_pfeh:
    s_mul_i32 s75, s43, 448
    s_and_b32 s63, s43, 1
    s_lshl_b32 s72, s63, 6
    s_add_u32 s72, s72, s75
    s_add_u32 s73, s72, 256
    s_cmp_eq_u32 s63, 0
    s_cselect_b32 s74, 384, 0
    s_add_u32 s74, s74, s75
    s_mov_b32 s14, 0x1c0000
    s_mov_b32 s34, 3584
    s_waitcnt lgkmcnt(0)
    s_mov_b32 s8, s92
    s_mov_b32 s9, s93
    s_mov_b32 s12, s96
    s_mov_b32 s13, s97
    s_mov_b32 s32, s98
    s_mov_b32 s33, s99
    s_lshr_b32 s73, s41, 1
    s_and_b32 s74, s41, 1
    s_lshl_b32 s60, s73, 6
    s_add_u32 s72, s72, s60
    s_sub_u32 s72, s72, s75
    v_pk_mov_b32 v[128:129], 0, 0
    v_pk_mov_b32 v[130:131], 0, 0
    v_pk_mov_b32 v[132:133], 0, 0
    v_pk_mov_b32 v[134:135], 0, 0
    v_pk_mov_b32 v[136:137], 0, 0
    v_pk_mov_b32 v[138:139], 0, 0
    v_cmp_gt_u32 vcc, 32, v1
    v_mov_b32 v14, 0x3f80
    v_and_b32 v15, 31, v1
    v_cndmask_b32 v128, 0, v14, vcc
    v_lshlrev_b32 v14, 1, v15
    v_add_u32 v14, 148480, v14
    v_add_u32 v23, s72, v14
    s_mov_b32 s16, s4
    s_mov_b32 s17, s5
    s_mov_b32 s18, 0x1c0000
    s_mov_b32 s19, 0x20000
    s_mov_b32 s22, 0x80000
    s_mov_b32 s23, 0x20000
    s_mov_b32 s26, 0x1100000
    s_mov_b32 s27, 0x20000
    s_mov_b32 s30, 0x200000
    s_mov_b32 s31, 0x20000
    s_mov_b32 s38, 0x100
    s_mov_b32 s39, 0x20000
    ds_write_b32 v11, v12
    s_mov_b32 s66, 0x3fb8aa3b
    s_mov_b32 s67, 0x358637bd
    s_mov_b32 s68, 0.5
    s_mov_b32 s70, 0x3fb8aa3b
    s_mov_b32 s69, 0.5
    s_mov_b32 s71, 0x3fb8aa3b
    s_mov_b32 s4, 0x7060500
    s_mov_b32 s5, 0x7060501
    s_mov_b32 s6, 0x7060502
    s_mov_b32 s7, 0x7060503
    s_and_b32 s47, s2, 1
    s_bfe_u32 s60, s2, 0x10001
    s_lshl1_add_u32 s47, s47, s60
    s_bfe_u32 s60, s2, 0x20003
    s_lshl2_add_u32 s47, s47, s60
    s_lshl1_add_u32 s47, s47, s45
    s_and_b32 s48, s43, 3
    v_and_b32 v14, 7, v1
    v_lshlrev_b32 v10, 2, v14
    v_add_u32 v10, 147456, v10
    v_bfe_u32 v15, v1, 4, 1
    v_lshlrev_b32 v15, 2, v15
    v_xor_b32 v14, v14, v15
    v_lshlrev_b32 v14, 4, v14
    v_lshrrev_b32 v15, 3, v1
    v_lshl_add_u32 v22, v15, 10, v14
    s_lshl_b32 s60, s45, 2
    s_add_u32 s60, s60, s41
    s_lshl_b32 s61, s46, 7
    s_mul_i32 s57, s60, 229376
    s_add_u32 s57, s57, s61
    s_lshl_b32 s58, s60, 16
    s_add_u32 s58, s58, s61
    s_and_b32 s62, s41, 1
    s_lshl_b32 s56, s62, 15
    s_add_u32 s56, s56, s57
    s_cmp_eq_u32 s62, 0
    s_cselect_b32 s62, 196608, 0
    s_add_u32 s57, s57, s62
    s_mul_i32 s55, s41, 9216
    v_lshrrev_b32 v14, 5, v1
    v_bfe_u32 v15, v1, 2, 2
    v_lshl_add_u32 v14, v14, 2, v15
    v_lshlrev_b32 v14, 7, v14
    v_bfe_u32 v15, v1, 3, 1
    v_lshl_add_u32 v14, v15, 6, v14
    v_and_b32 v15, 1, v1
    v_lshl_add_u32 v14, v15, 5, v14
    v_and_b32 v15, 16, v1
    v_add_u32 v14, v14, v15
    v_and_b32 v15, 2, v1
    v_lshl_add_u32 v14, v15, 2, v14
    s_lshr_b32 s60, s41, 1
    s_lshl_b32 s61, s60, 6
    v_xor_b32 v14, s61, v14
    s_mul_i32 s61, s60, 18432
    v_add_u32 v4, s61, v14
    v_xor_b32 v3, 64, v4
    s_lshr_b32 s61, s40, 2
    s_lshl_b32 s61, s61, 1
    s_and_b32 s62, s41, 1
    s_add_u32 s61, s61, s62
    s_lshl_b32 s63, s47, 2
    s_add_u32 s61, s61, s63
    s_lshl_b32 s61, s61, 1
    s_add_u32 s61, s61, s60
    s_lshl_b32 s61, s61, 1
    s_mul_i32 s78, s61, 14336
    s_mul_i32 s79, s61, 4096
    s_add_u32 s79, s79, 0x800000
    s_mul_i32 s80, s61, 1024
    s_add_u32 s80, s80, 0xc00000
    s_mul_i32 s81, s61, 128
    s_add_u32 s81, s81, 0xa00000
    s_lshl_b32 s82, s47, 3
    s_add_u32 s82, s82, s46
    s_lshl_b32 s82, s82, 2
    s_add_u32 s82, s82, s41
    s_cmp_lt_u32 s40, 4
    s_cselect_b32 s62, 32, 0
    s_xor_b32 s82, s82, s62
    s_mul_i32 s82, s82, 4096
    s_add_u32 s82, s82, 0xd00000
    v_bfe_u32 v14, v1, 2, 1
    v_mul_u32_u24 v6, 1024, v14
    v_and_b32 v14, 1, v1
    v_lshl_add_u32 v5, v14, 7, v6
    v_bfe_u32 v14, v1, 1, 3
    v_lshrrev_b32 v15, 5, v1
    v_xor_b32 v14, v14, v15
    v_lshlrev_b32 v14, 4, v14
    v_and_b32 v15, 31, v1
    v_lshl_add_u32 v14, v15, 7, v14
    s_lshl_b32 s60, s74, 12
    s_add_u32 s60, s60, 36864
    v_add_u32 v16, s60, v14
    v_xor_b32 v17, 32, v16
    v_xor_b32 v18, 64, v16
    v_xor_b32 v19, 96, v16
    v_lshrrev_b32 v14, 5, v1
    v_bfe_u32 v15, v1, 2, 2
    v_lshl_add_u32 v14, v14, 3, v15
    v_lshlrev_b32 v14, 7, v14
    v_bfe_u32 v15, v1, 3, 1
    v_lshl_add_u32 v14, v15, 6, v14
    v_and_b32 v15, 16, v1
    v_lshl_add_u32 v14, v15, 1, v14
    v_and_b32 v15, 3, v1
    v_lshl_add_u32 v21, v15, 3, v14
    v_add_u32 v21, 36864, v21
    s_lshl_b32 s60, s73, 6
    v_xor_b32 v21, s60, v21
    v_mov_b32 v20, v21
    s_lshl1_add_u32 s61, s42, s45
    s_lshl2_add_u32 s61, s61, s74
    s_lshl_b32 s61, s61, 2
    s_add_u32 s61, s61, s48
    s_mul_i32 s76, s61, 1024
    s_add_u32 s76, s76, 0xc00000
    s_lshl_b32 s60, s73, 7
    s_add_u32 s76, s76, s60
    s_mul_i32 s77, s61, 14336
    s_lshl_b32 s60, s73, 11
    s_add_u32 s77, s77, s60
    s_mov_b32 s49, 1
    s_setprio 1
    s_waitcnt lgkmcnt(0)
    s_barrier
    ds_read_u16 v132, v23 offset:0
    ds_read_u16 v136, v23 offset:128
    ds_read_b128 v[32:35], v16 offset:0
    ds_read_b64_tr_b16 v[40:41], v20 offset:16384
    ds_read_b64_tr_b16 v[42:43], v20 offset:16896
    ds_read_b128 v[36:39], v16 offset:8192
    ds_read_b64_tr_b16 v[44:45], v21 offset:24576
    ds_read_b64_tr_b16 v[46:47], v21 offset:25088
    s_waitcnt lgkmcnt(6)
    v_mfma_f32_32x32x16_bf16 v[64:79], v[132:135], v[128:131], 0
    v_mfma_f32_32x32x16_bf16 v[96:111], v[132:135], v[128:131], 0
    v_mfma_f32_32x32x16_bf16 v[80:95], v[136:139], v[128:131], 0
    v_mfma_f32_32x32x16_bf16 v[112:127], v[136:139], v[128:131], 0
    .p2align 4
L_loop_h:
    s_waitcnt lgkmcnt(3)
    v_mfma_f32_32x32x16_bf16 v[64:79], v[40:43], v[32:35], v[64:79]
    ds_read_b128 v[48:51], v17 offset:0
    ds_read_b64_tr_b16 v[56:57], v20 offset:18432
    ds_read_b64_tr_b16 v[58:59], v20 offset:18944
    s_waitcnt lgkmcnt(5)
    v_mfma_f32_32x32x16_bf16 v[96:111], v[40:43], v[36:39], v[96:111]
    ds_read_b128 v[52:55], v17 offset:8192
    ds_read_b64_tr_b16 v[60:61], v21 offset:26624
    ds_read_b64_tr_b16 v[62:63], v21 offset:27136
    s_waitcnt lgkmcnt(6)
    v_mfma_f32_32x32x16_bf16 v[80:95], v[44:47], v[32:35], v[80:95]
    s_add_u32 s49, s49, 1
    s_and_b32 s60, s49, 3
    s_mov_b32 s50, 0xfffe5000
    v_mfma_f32_32x32x16_bf16 v[112:127], v[44:47], v[36:39], v[112:127]
    s_cmov_b32 s50, 36864
    s_waitcnt lgkmcnt(3)
    v_mfma_f32_32x32x16_bf16 v[64:79], v[56:59], v[48:51], v[64:79]
    ds_read_b128 v[32:35], v18 offset:0
    ds_read_b64_tr_b16 v[40:41], v20 offset:20480
    ds_read_b64_tr_b16 v[42:43], v20 offset:20992
    s_waitcnt lgkmcnt(5)
    v_mfma_f32_32x32x16_bf16 v[96:111], v[56:59], v[52:55], v[96:111]
    ds_read_b128 v[36:39], v18 offset:8192
    ds_read_b64_tr_b16 v[44:45], v21 offset:28672
    ds_read_b64_tr_b16 v[46:47], v21 offset:29184
    s_waitcnt lgkmcnt(6)
    v_mfma_f32_32x32x16_bf16 v[80:95], v[60:63], v[48:51], v[80:95]
    v_add_u32 v16, s50, v16
    v_add_u32 v17, s50, v17
    v_add_u32 v18, s50, v18
    v_mfma_f32_32x32x16_bf16 v[112:127], v[60:63], v[52:55], v[112:127]
    s_waitcnt lgkmcnt(3)
    v_mfma_f32_32x32x16_bf16 v[64:79], v[40:43], v[32:35], v[64:79]
    ds_read_b128 v[48:51], v19 offset:0
    ds_read_b64_tr_b16 v[56:57], v20 offset:22528
    ds_read_b64_tr_b16 v[58:59], v20 offset:23040
    s_waitcnt lgkmcnt(5)
    v_mfma_f32_32x32x16_bf16 v[96:111], v[40:43], v[36:39], v[96:111]
    ds_read_b128 v[52:55], v19 offset:8192
    ds_read_b64_tr_b16 v[60:61], v21 offset:30720
    ds_read_b64_tr_b16 v[62:63], v21 offset:31232
    s_waitcnt lgkmcnt(6)
    v_mfma_f32_32x32x16_bf16 v[80:95], v[44:47], v[32:35], v[80:95]
    v_add_u32 v19, s50, v19
    v_add_u32 v20, s50, v20
    v_add_u32 v21, s50, v21
    v_mfma_f32_32x32x16_bf16 v[112:127], v[44:47], v[36:39], v[112:127]
    s_waitcnt lgkmcnt(3)
    v_mfma_f32_32x32x16_bf16 v[64:79], v[56:59], v[48:51], v[64:79]
    s_waitcnt lgkmcnt(0)
    s_barrier
    v_mfma_f32_32x32x16_bf16 v[96:111], v[56:59], v[52:55], v[96:111]
    ds_read_b128 v[32:35], v16 offset:0
    ds_read_b64_tr_b16 v[40:41], v20 offset:16384
    ds_read_b64_tr_b16 v[42:43], v20 offset:16896
    v_mfma_f32_32x32x16_bf16 v[80:95], v[60:63], v[48:51], v[80:95]
    ds_read_b128 v[36:39], v16 offset:8192
    ds_read_b64_tr_b16 v[44:45], v21 offset:24576
    ds_read_b64_tr_b16 v[46:47], v21 offset:25088
    v_mfma_f32_32x32x16_bf16 v[112:127], v[60:63], v[52:55], v[112:127]
    s_cmp_lg_u32 s49, s52
    s_cbranch_scc1 L_nt_h
    buffer_load_dword v26, v26, s[88:91], s53 offen
L_nt_h:
    s_cmp_lt_u32 s49, 9
    s_cbranch_scc1 L_loop_h
    s_setprio 3
    ds_read_b32 v7, v10 offset:64
    s_waitcnt lgkmcnt(1)
    s_mov_b32 s51, s77
    v_and_b32 v14, 15, v1
    v_lshlrev_b32 v14, 7, v14
    v_and_b32 v15, 16, v1
    v_lshl_add_u32 v23, v15, 8, v14
    s_nop 2
    v_mul_f32 v32, s66, v64
    v_mul_f32 v33, s66, v65
    v_mul_f32 v34, s66, v66
    v_mul_f32 v35, s66, v67
    v_mul_f32 v36, s66, v68
    v_mul_f32 v37, s66, v69
    v_mul_f32 v38, s66, v70
    v_mul_f32 v39, s66, v71
    v_exp_f32 v32, v32
    v_exp_f32 v33, v33
    v_exp_f32 v34, v34
    v_exp_f32 v35, v35
    v_exp_f32 v36, v36
    v_exp_f32 v37, v37
    v_exp_f32 v38, v38
    v_exp_f32 v39, v39
    v_fma_f32 v40, v32, 0.5, 1.0
    v_fma_f32 v41, v33, 0.5, 1.0
    v_fma_f32 v42, v34, 0.5, 1.0
    v_fma_f32 v43, v35, 0.5, 1.0
    v_fma_f32 v44, v36, 0.5, 1.0
    v_fma_f32 v45, v37, 0.5, 1.0
    v_fma_f32 v46, v38, 0.5, 1.0
    v_fma_f32 v47, v39, 0.5, 1.0
    v_fma_f32 v40, v40, v32, 1.0
    v_fma_f32 v41, v41, v33, 1.0
    v_fma_f32 v42, v42, v34, 1.0
    v_fma_f32 v43, v43, v35, 1.0
    v_fma_f32 v44, v44, v36, 1.0
    v_fma_f32 v45, v45, v37, 1.0
    v_fma_f32 v46, v46, v38, 1.0
    v_fma_f32 v47, v47, v39, 1.0
    v_rcp_f32 v40, v40
    v_rcp_f32 v41, v41
    v_rcp_f32 v42, v42
    v_rcp_f32 v43, v43
    v_rcp_f32 v44, v44
    v_rcp_f32 v45, v45
    v_rcp_f32 v46, v46
    v_rcp_f32 v47, v47
    v_fma_f32 v40, -v40, v64, v64
    v_fma_f32 v41, -v41, v65, v65
    v_fma_f32 v42, -v42, v66, v66
    v_fma_f32 v43, -v43, v67, v67
    v_fma_f32 v44, -v44, v68, v68
    v_fma_f32 v45, -v45, v69, v69
    v_fma_f32 v46, -v46, v70, v70
    v_fma_f32 v47, -v47, v71, v71
    v_cvt_pk_bf16_f32 v48, v40, v41
    v_cvt_pk_bf16_f32 v49, v42, v43
    v_cvt_pk_bf16_f32 v50, v44, v45
    v_cvt_pk_bf16_f32 v51, v46, v47
    buffer_store_dwordx4 v[48:51], v2, s[24:27], s77 offen offset:0 sc1
    s_waitcnt lgkmcnt(0)
    v_readfirstlane_b32 s64, v7
    s_bfe_u32 s96, s64, 0x80000
    s_bfe_u32 s97, s64, 0x80008
    s_bfe_u32 s98, s64, 0x80010
    s_bfe_u32 s99, s64, 0x80018
    v_mul_f32 v32, s66, v72
    v_mul_f32 v33, s66, v73
    v_mul_f32 v34, s66, v74
    v_mul_f32 v35, s66, v75
    v_mul_f32 v36, s66, v76
    v_mul_f32 v37, s66, v77
    v_mul_f32 v38, s66, v78
    v_mul_f32 v39, s66, v79
    v_exp_f32 v32, v32
    v_exp_f32 v33, v33
    v_exp_f32 v34, v34
    v_exp_f32 v35, v35
    v_exp_f32 v36, v36
    v_exp_f32 v37, v37
    v_exp_f32 v38, v38
    v_exp_f32 v39, v39
    v_fma_f32 v40, v32, 0.5, 1.0
    v_fma_f32 v41, v33, 0.5, 1.0
    v_fma_f32 v42, v34, 0.5, 1.0
    v_fma_f32 v43, v35, 0.5, 1.0
    v_fma_f32 v44, v36, 0.5, 1.0
    v_fma_f32 v45, v37, 0.5, 1.0
    v_fma_f32 v46, v38, 0.5, 1.0
    v_fma_f32 v47, v39, 0.5, 1.0
    v_fma_f32 v40, v40, v32, 1.0
    v_fma_f32 v41, v41, v33, 1.0
    v_fma_f32 v42, v42, v34, 1.0
    v_fma_f32 v43, v43, v35, 1.0
    v_fma_f32 v44, v44, v36, 1.0
    v_fma_f32 v45, v45, v37, 1.0
    v_fma_f32 v46, v46, v38, 1.0
    v_fma_f32 v47, v47, v39, 1.0
    v_rcp_f32 v40, v40
    v_rcp_f32 v41, v41
    v_rcp_f32 v42, v42
    v_rcp_f32 v43, v43
    v_rcp_f32 v44, v44
    v_rcp_f32 v45, v45
    v_rcp_f32 v46, v46
    v_rcp_f32 v47, v47
    v_fma_f32 v40, -v40, v72, v72
    v_fma_f32 v41, -v41, v73, v73
    v_fma_f32 v42, -v42, v74, v74
    v_fma_f32 v43, -v43, v75, v75
    v_fma_f32 v44, -v44, v76, v76
    v_fma_f32 v45, -v45, v77, v77
    v_fma_f32 v46, -v46, v78, v78
    v_fma_f32 v47, -v47, v79, v79
    v_cvt_pk_bf16_f32 v52, v40, v41
    v_cvt_pk_bf16_f32 v53, v42, v43
    v_cvt_pk_bf16_f32 v54, v44, v45
    v_cvt_pk_bf16_f32 v55, v46, v47
    buffer_store_dwordx4 v[52:55], v2, s[24:27], s77 offen offset:1024 sc1
    v_mul_f32 v32, s66, v80
    v_mul_f32 v33, s66, v81
    v_mul_f32 v34, s66, v82
    v_mul_f32 v35, s66, v83
    v_mul_f32 v36, s66, v84
    v_mul_f32 v37, s66, v85
    v_mul_f32 v38, s66, v86
    v_mul_f32 v39, s66, v87
    v_exp_f32 v32, v32
    v_exp_f32 v33, v33
    v_exp_f32 v34, v34
    v_exp_f32 v35, v35
    v_exp_f32 v36, v36
    v_exp_f32 v37, v37
    v_exp_f32 v38, v38
    v_exp_f32 v39, v39
    v_fma_f32 v40, v32, 0.5, 1.0
    v_fma_f32 v41, v33, 0.5, 1.0
    v_fma_f32 v42, v34, 0.5, 1.0
    v_fma_f32 v43, v35, 0.5, 1.0
    v_fma_f32 v44, v36, 0.5, 1.0
    v_fma_f32 v45, v37, 0.5, 1.0
    v_fma_f32 v46, v38, 0.5, 1.0
    v_fma_f32 v47, v39, 0.5, 1.0
    v_fma_f32 v40, v40, v32, 1.0
    v_fma_f32 v41, v41, v33, 1.0
    v_fma_f32 v42, v42, v34, 1.0
    v_fma_f32 v43, v43, v35, 1.0
    v_fma_f32 v44, v44, v36, 1.0
    v_fma_f32 v45, v45, v37, 1.0
    v_fma_f32 v46, v46, v38, 1.0
    v_fma_f32 v47, v47, v39, 1.0
    v_rcp_f32 v40, v40
    v_rcp_f32 v41, v41
    v_rcp_f32 v42, v42
    v_rcp_f32 v43, v43
    v_rcp_f32 v44, v44
    v_rcp_f32 v45, v45
    v_rcp_f32 v46, v46
    v_rcp_f32 v47, v47
    v_fma_f32 v40, -v40, v80, v80
    v_fma_f32 v41, -v41, v81, v81
    v_fma_f32 v42, -v42, v82, v82
    v_fma_f32 v43, -v43, v83, v83
    v_fma_f32 v44, -v44, v84, v84
    v_fma_f32 v45, -v45, v85, v85
    v_fma_f32 v46, -v46, v86, v86
    v_fma_f32 v47, -v47, v87, v87
    v_cvt_pk_bf16_f32 v48, v40, v41
    v_cvt_pk_bf16_f32 v49, v42, v43
    v_cvt_pk_bf16_f32 v50, v44, v45
    v_cvt_pk_bf16_f32 v51, v46, v47
    s_add_u32 s77, s77, 4096
    buffer_store_dwordx4 v[48:51], v2, s[24:27], s77 offen offset:0 sc1
    v_mul_f32 v32, s66, v88
    v_mul_f32 v33, s66, v89
    v_mul_f32 v34, s66, v90
    v_mul_f32 v35, s66, v91
    v_mul_f32 v36, s66, v92
    v_mul_f32 v37, s66, v93
    v_mul_f32 v38, s66, v94
    v_mul_f32 v39, s66, v95
    v_exp_f32 v32, v32
    v_exp_f32 v33, v33
    v_exp_f32 v34, v34
    v_exp_f32 v35, v35
    v_exp_f32 v36, v36
    v_exp_f32 v37, v37
    v_exp_f32 v38, v38
    v_exp_f32 v39, v39
    v_fma_f32 v40, v32, 0.5, 1.0
    v_fma_f32 v41, v33, 0.5, 1.0
    v_fma_f32 v42, v34, 0.5, 1.0
    v_fma_f32 v43, v35, 0.5, 1.0
    v_fma_f32 v44, v36, 0.5, 1.0
    v_fma_f32 v45, v37, 0.5, 1.0
    v_fma_f32 v46, v38, 0.5, 1.0
    v_fma_f32 v47, v39, 0.5, 1.0
    v_fma_f32 v40, v40, v32, 1.0
    v_fma_f32 v41, v41, v33, 1.0
    v_fma_f32 v42, v42, v34, 1.0
    v_fma_f32 v43, v43, v35, 1.0
    v_fma_f32 v44, v44, v36, 1.0
    v_fma_f32 v45, v45, v37, 1.0
    v_fma_f32 v46, v46, v38, 1.0
    v_fma_f32 v47, v47, v39, 1.0
    v_rcp_f32 v40, v40
    v_rcp_f32 v41, v41
    v_rcp_f32 v42, v42
    v_rcp_f32 v43, v43
    v_rcp_f32 v44, v44
    v_rcp_f32 v45, v45
    v_rcp_f32 v46, v46
    v_rcp_f32 v47, v47
    v_fma_f32 v40, -v40, v88, v88
    v_fma_f32 v41, -v41, v89, v89
    v_fma_f32 v42, -v42, v90, v90
    v_fma_f32 v43, -v43, v91, v91
    v_fma_f32 v44, -v44, v92, v92
    v_fma_f32 v45, -v45, v93, v93
    v_fma_f32 v46, -v46, v94, v94
    v_fma_f32 v47, -v47, v95, v95
    v_cvt_pk_bf16_f32 v52, v40, v41
    v_cvt_pk_bf16_f32 v53, v42, v43
    v_cvt_pk_bf16_f32 v54, v44, v45
    v_cvt_pk_bf16_f32 v55, v46, v47
    buffer_store_dwordx4 v[52:55], v2, s[24:27], s77 offen offset:1024 sc1
    s_setprio 3
    v_mul_f32 v32, s66, v96
    v_mul_f32 v33, s66, v97
    v_mul_f32 v34, s66, v98
    v_mul_f32 v35, s66, v99
    v_mul_f32 v36, s66, v100
    v_mul_f32 v37, s66, v101
    v_mul_f32 v38, s66, v102
    v_mul_f32 v39, s66, v103
    v_exp_f32 v32, v32
    v_exp_f32 v33, v33
    v_exp_f32 v34, v34
    v_exp_f32 v35, v35
    v_exp_f32 v36, v36
    v_exp_f32 v37, v37
    v_exp_f32 v38, v38
    v_exp_f32 v39, v39
    v_fma_f32 v40, v32, 0.5, 1.0
    v_fma_f32 v41, v33, 0.5, 1.0
    v_fma_f32 v42, v34, 0.5, 1.0
    v_fma_f32 v43, v35, 0.5, 1.0
    v_fma_f32 v44, v36, 0.5, 1.0
    v_fma_f32 v45, v37, 0.5, 1.0
    v_fma_f32 v46, v38, 0.5, 1.0
    v_fma_f32 v47, v39, 0.5, 1.0
    v_fma_f32 v40, v40, v32, 1.0
    v_fma_f32 v41, v41, v33, 1.0
    v_fma_f32 v42, v42, v34, 1.0
    v_fma_f32 v43, v43, v35, 1.0
    v_fma_f32 v44, v44, v36, 1.0
    v_fma_f32 v45, v45, v37, 1.0
    v_fma_f32 v46, v46, v38, 1.0
    v_fma_f32 v47, v47, v39, 1.0
    v_rcp_f32 v40, v40
    v_rcp_f32 v41, v41
    v_rcp_f32 v42, v42
    v_rcp_f32 v43, v43
    v_rcp_f32 v44, v44
    v_rcp_f32 v45, v45
    v_rcp_f32 v46, v46
    v_rcp_f32 v47, v47
    v_fma_f32 v40, -v40, v96, v96
    v_fma_f32 v41, -v41, v97, v97
    v_fma_f32 v42, -v42, v98, v98
    v_fma_f32 v43, -v43, v99, v99
    v_fma_f32 v44, -v44, v100, v100
    v_fma_f32 v45, -v45, v101, v101
    v_fma_f32 v46, -v46, v102, v102
    v_fma_f32 v47, -v47, v103, v103
    v_cvt_pk_bf16_f32 v48, v40, v41
    v_cvt_pk_bf16_f32 v49, v42, v43
    v_cvt_pk_bf16_f32 v50, v44, v45
    v_cvt_pk_bf16_f32 v51, v46, v47
    s_add_u32 s77, s77, 110592
    buffer_store_dwordx4 v[48:51], v2, s[24:27], s77 offen offset:0 sc1
    v_mul_f32 v32, s66, v104
    v_mul_f32 v33, s66, v105
    v_mul_f32 v34, s66, v106
    v_mul_f32 v35, s66, v107
    v_mul_f32 v36, s66, v108
    v_mul_f32 v37, s66, v109
    v_mul_f32 v38, s66, v110
    v_mul_f32 v39, s66, v111
    v_exp_f32 v32, v32
    v_exp_f32 v33, v33
    v_exp_f32 v34, v34
    v_exp_f32 v35, v35
    v_exp_f32 v36, v36
    v_exp_f32 v37, v37
    v_exp_f32 v38, v38
    v_exp_f32 v39, v39
    v_fma_f32 v40, v32, 0.5, 1.0
    v_fma_f32 v41, v33, 0.5, 1.0
    v_fma_f32 v42, v34, 0.5, 1.0
    v_fma_f32 v43, v35, 0.5, 1.0
    v_fma_f32 v44, v36, 0.5, 1.0
    v_fma_f32 v45, v37, 0.5, 1.0
    v_fma_f32 v46, v38, 0.5, 1.0
    v_fma_f32 v47, v39, 0.5, 1.0
    v_fma_f32 v40, v40, v32, 1.0
    v_fma_f32 v41, v41, v33, 1.0
    v_fma_f32 v42, v42, v34, 1.0
    v_fma_f32 v43, v43, v35, 1.0
    v_fma_f32 v44, v44, v36, 1.0
    v_fma_f32 v45, v45, v37, 1.0
    v_fma_f32 v46, v46, v38, 1.0
    v_fma_f32 v47, v47, v39, 1.0
    v_rcp_f32 v40, v40
    v_rcp_f32 v41, v41
    v_rcp_f32 v42, v42
    v_rcp_f32 v43, v43
    v_rcp_f32 v44, v44
    v_rcp_f32 v45, v45
    v_rcp_f32 v46, v46
    v_rcp_f32 v47, v47
    v_fma_f32 v40, -v40, v104, v104
    v_fma_f32 v41, -v41, v105, v105
    v_fma_f32 v42, -v42, v106, v106
    v_fma_f32 v43, -v43, v107, v107
    v_fma_f32 v44, -v44, v108, v108
    v_fma_f32 v45, -v45, v109, v109
    v_fma_f32 v46, -v46, v110, v110
    v_fma_f32 v47, -v47, v111, v111
    v_cvt_pk_bf16_f32 v52, v40, v41
    v_cvt_pk_bf16_f32 v53, v42, v43
    v_cvt_pk_bf16_f32 v54, v44, v45
    v_cvt_pk_bf16_f32 v55, v46, v47
    buffer_store_dwordx4 v[52:55], v2, s[24:27], s77 offen offset:1024 sc1
    v_mul_f32 v32, s66, v112
    v_mul_f32 v33, s66, v113
    v_mul_f32 v34, s66, v114
    v_mul_f32 v35, s66, v115
    v_mul_f32 v36, s66, v116
    v_mul_f32 v37, s66, v117
    v_mul_f32 v38, s66, v118
    v_mul_f32 v39, s66, v119
    v_exp_f32 v32, v32
    v_exp_f32 v33, v33
    v_exp_f32 v34, v34
    v_exp_f32 v35, v35
    v_exp_f32 v36, v36
    v_exp_f32 v37, v37
    v_exp_f32 v38, v38
    v_exp_f32 v39, v39
    v_fma_f32 v40, v32, 0.5, 1.0
    v_fma_f32 v41, v33, 0.5, 1.0
    v_fma_f32 v42, v34, 0.5, 1.0
    v_fma_f32 v43, v35, 0.5, 1.0
    v_fma_f32 v44, v36, 0.5, 1.0
    v_fma_f32 v45, v37, 0.5, 1.0
    v_fma_f32 v46, v38, 0.5, 1.0
    v_fma_f32 v47, v39, 0.5, 1.0
    v_fma_f32 v40, v40, v32, 1.0
    v_fma_f32 v41, v41, v33, 1.0
    v_fma_f32 v42, v42, v34, 1.0
    v_fma_f32 v43, v43, v35, 1.0
    v_fma_f32 v44, v44, v36, 1.0
    v_fma_f32 v45, v45, v37, 1.0
    v_fma_f32 v46, v46, v38, 1.0
    v_fma_f32 v47, v47, v39, 1.0
    v_rcp_f32 v40, v40
    v_rcp_f32 v41, v41
    v_rcp_f32 v42, v42
    v_rcp_f32 v43, v43
    v_rcp_f32 v44, v44
    v_rcp_f32 v45, v45
    v_rcp_f32 v46, v46
    v_rcp_f32 v47, v47
    v_fma_f32 v40, -v40, v112, v112
    v_fma_f32 v41, -v41, v113, v113
    v_fma_f32 v42, -v42, v114, v114
    v_fma_f32 v43, -v43, v115, v115
    v_fma_f32 v44, -v44, v116, v116
    v_fma_f32 v45, -v45, v117, v117
    v_fma_f32 v46, -v46, v118, v118
    v_fma_f32 v47, -v47, v119, v119
    v_cvt_pk_bf16_f32 v48, v40, v41
    v_cvt_pk_bf16_f32 v49, v42, v43
    v_cvt_pk_bf16_f32 v50, v44, v45
    v_cvt_pk_bf16_f32 v51, v46, v47
    s_add_u32 s77, s77, 4096
    buffer_store_dwordx4 v[48:51], v2, s[24:27], s77 offen offset:0 sc1
    s_waitcnt vmcnt(3)
    buffer_store_dword v7, off, s[24:27], s76 offset:0 sc1
    s_add_u32 s76, s76, 8192
    v_mul_f32 v32, s66, v120
    v_mul_f32 v33, s66, v121
    v_mul_f32 v34, s66, v122
    v_mul_f32 v35, s66, v123
    v_mul_f32 v36, s66, v124
    v_mul_f32 v37, s66, v125
    v_mul_f32 v38, s66, v126
    v_mul_f32 v39, s66, v127
    v_exp_f32 v32, v32
    v_exp_f32 v33, v33
    v_exp_f32 v34, v34
    v_exp_f32 v35, v35
    v_exp_f32 v36, v36
    v_exp_f32 v37, v37
    v_exp_f32 v38, v38
    v_exp_f32 v39, v39
    v_fma_f32 v40, v32, 0.5, 1.0
    v_fma_f32 v41, v33, 0.5, 1.0
    v_fma_f32 v42, v34, 0.5, 1.0
    v_fma_f32 v43, v35, 0.5, 1.0
    v_fma_f32 v44, v36, 0.5, 1.0
    v_fma_f32 v45, v37, 0.5, 1.0
    v_fma_f32 v46, v38, 0.5, 1.0
    v_fma_f32 v47, v39, 0.5, 1.0
    v_fma_f32 v40, v40, v32, 1.0
    v_fma_f32 v41, v41, v33, 1.0
    v_fma_f32 v42, v42, v34, 1.0
    v_fma_f32 v43, v43, v35, 1.0
    v_fma_f32 v44, v44, v36, 1.0
    v_fma_f32 v45, v45, v37, 1.0
    v_fma_f32 v46, v46, v38, 1.0
    v_fma_f32 v47, v47, v39, 1.0
    v_rcp_f32 v40, v40
    v_rcp_f32 v41, v41
    v_rcp_f32 v42, v42
    v_rcp_f32 v43, v43
    v_rcp_f32 v44, v44
    v_rcp_f32 v45, v45
    v_rcp_f32 v46, v46
    v_rcp_f32 v47, v47
    v_fma_f32 v40, -v40, v120, v120
    v_fma_f32 v41, -v41, v121, v121
    v_fma_f32 v42, -v42, v122, v122
    v_fma_f32 v43, -v43, v123, v123
    v_fma_f32 v44, -v44, v124, v124
    v_fma_f32 v45, -v45, v125, v125
    v_fma_f32 v46, -v46, v126, v126
    v_fma_f32 v47, -v47, v127, v127
    v_cvt_pk_bf16_f32 v52, v40, v41
    v_cvt_pk_bf16_f32 v53, v42, v43
    v_cvt_pk_bf16_f32 v54, v44, v45
    v_cvt_pk_bf16_f32 v55, v46, v47
    buffer_store_dwordx4 v[52:55], v2, s[24:27], s77 offen offset:1024 sc1
    s_load_dword s8, s[24:25], s80 offset:0 glc
    s_load_dword s9, s[24:25], s80 offset:128 glc
    s_load_dword s10, s[24:25], s80 offset:1024 glc
    s_load_dword s11, s[24:25], s80 offset:1152 glc
    s_lshl_b32 s60, s43, 2
    s_add_u32 s60, s60, s41
    s_lshl_b32 s100, s60, 14
    s_add_u32 s100, s100, 0xb00000
    s_lshl_b32 s101, s60, 11
    s_add_u32 s101, s101, 0xb80000
    v_and_b32 v28, 15, v1
    v_and_b32 v29, 0x30, v1
    v_lshl_add_u32 v28, v28, 7, v29
    s_lshr_b32 s60, s41, 1
    s_mul_i32 s60, s60, 1152
    s_and_b32 s61, s41, 1
    s_lshl_b32 s61, s61, 3
    s_add_u32 s60, s60, s61
    s_add_u32 s60, s60, 157696
    v_bfe_u32 v14, v1, 4, 1
    v_mul_u32_u24 v14, 576, v14
    v_lshrrev_b32 v15, 5, v1
    v_lshlrev_b32 v15, 4, v15
    v_add3_u32 v30, v14, v15, s60
    v_and_b32 v14, 15, v1
    v_lshl_add_u32 v29, v14, 5, v30
    s_add_u32 s59, s100, 0
    buffer_load_dwordx4 v[32:35], v2, s[24:27], s59 offen offset:0 sc1
    s_add_u32 s59, s100, 0
    buffer_load_dwordx4 v[36:39], v2, s[24:27], s59 offen offset:1024 sc1
    s_add_u32 s59, s100, 0
    buffer_load_dwordx4 v[40:43], v2, s[24:27], s59 offen offset:2048 sc1
    s_add_u32 s59, s100, 0
    buffer_load_dwordx4 v[44:47], v2, s[24:27], s59 offen offset:3072 sc1
    s_add_u32 s59, s100, 4096
    buffer_load_dwordx4 v[48:51], v2, s[24:27], s59 offen offset:0 sc1
    s_add_u32 s59, s100, 4096
    buffer_load_dwordx4 v[52:55], v2, s[24:27], s59 offen offset:1024 sc1
    s_add_u32 s59, s100, 4096
    buffer_load_dwordx4 v[56:59], v2, s[24:27], s59 offen offset:2048 sc1
    s_add_u32 s59, s100, 4096
    buffer_load_dwordx4 v[60:63], v2, s[24:27], s59 offen offset:3072 sc1
    s_add_u32 s59, s100, 8192
    buffer_load_dwordx4 v[64:67], v2, s[24:27], s59 offen offset:0 sc1
    s_add_u32 s59, s100, 8192
    buffer_load_dwordx4 v[68:71], v2, s[24:27], s59 offen offset:1024 sc1
    s_add_u32 s59, s100, 8192
    buffer_load_dwordx4 v[72:75], v2, s[24:27], s59 offen offset:2048 sc1
    s_add_u32 s59, s100, 8192
    buffer_load_dwordx4 v[76:79], v2, s[24:27], s59 offen offset:3072 sc1
    s_add_u32 s59, s100, 12288
    buffer_load_dwordx4 v[80:83], v2, s[24:27], s59 offen offset:0 sc1
    s_add_u32 s59, s100, 12288
    buffer_load_dwordx4 v[84:87], v2, s[24:27], s59 offen offset:1024 sc1
    s_add_u32 s59, s100, 12288
    buffer_load_dwordx4 v[88:91], v2, s[24:27], s59 offen offset:2048 sc1
    s_add_u32 s59, s100, 12288
    buffer_load_dwordx4 v[92:95], v2, s[24:27], s59 offen offset:3072 sc1
    buffer_load_dwordx4 v[96:99], v28, s[24:27], s101 offen sc1
    s_waitcnt vmcnt(17)
    buffer_store_dword v7, off, s[24:27], s76 offset:0 sc1
    s_waitcnt vmcnt(17)
    v_xor_b32 v32, s96, v32
    v_xor_b32 v33, s97, v33
    v_xor_b32 v34, s98, v34
    v_xor_b32 v35, s99, v35
    v_or_b32 v236, v32, v33
    v_or3_b32 v236, v236, v34, v35
    s_waitcnt vmcnt(16)
    v_xor_b32 v36, s96, v36
    v_xor_b32 v37, s97, v37
    v_xor_b32 v38, s98, v38
    v_xor_b32 v39, s99, v39
    v_or_b32 v237, v36, v37
    v_or3_b32 v237, v237, v38, v39
    s_waitcnt vmcnt(15)
    v_xor_b32 v40, s96, v40
    v_xor_b32 v41, s97, v41
    v_xor_b32 v42, s98, v42
    v_xor_b32 v43, s99, v43
    v_or_b32 v238, v40, v41
    v_or3_b32 v238, v238, v42, v43
    s_waitcnt vmcnt(14)
    v_xor_b32 v44, s96, v44
    v_xor_b32 v45, s97, v45
    v_xor_b32 v46, s98, v46
    v_xor_b32 v47, s99, v47
    v_or_b32 v239, v44, v45
    v_or3_b32 v239, v239, v46, v47
    s_waitcnt vmcnt(13)
    v_xor_b32 v48, s96, v48
    v_xor_b32 v49, s97, v49
    v_xor_b32 v50, s98, v50
    v_xor_b32 v51, s99, v51
    v_or_b32 v240, v48, v49
    v_or3_b32 v240, v240, v50, v51
    s_waitcnt vmcnt(12)
    v_xor_b32 v52, s96, v52
    v_xor_b32 v53, s97, v53
    v_xor_b32 v54, s98, v54
    v_xor_b32 v55, s99, v55
    v_or_b32 v241, v52, v53
    v_or3_b32 v241, v241, v54, v55
    s_waitcnt vmcnt(11)
    v_xor_b32 v56, s96, v56
    v_xor_b32 v57, s97, v57
    v_xor_b32 v58, s98, v58
    v_xor_b32 v59, s99, v59
    v_or_b32 v242, v56, v57
    v_or3_b32 v242, v242, v58, v59
    s_waitcnt vmcnt(10)
    v_xor_b32 v60, s96, v60
    v_xor_b32 v61, s97, v61
    v_xor_b32 v62, s98, v62
    v_xor_b32 v63, s99, v63
    v_or_b32 v243, v60, v61
    v_or3_b32 v243, v243, v62, v63
    s_waitcnt vmcnt(9)
    v_xor_b32 v64, s96, v64
    v_xor_b32 v65, s97, v65
    v_xor_b32 v66, s98, v66
    v_xor_b32 v67, s99, v67
    v_or_b32 v244, v64, v65
    v_or3_b32 v244, v244, v66, v67
    s_waitcnt vmcnt(8)
    v_xor_b32 v68, s96, v68
    v_xor_b32 v69, s97, v69
    v_xor_b32 v70, s98, v70
    v_xor_b32 v71, s99, v71
    v_or_b32 v245, v68, v69
    v_or3_b32 v245, v245, v70, v71
    s_waitcnt vmcnt(7)
    v_xor_b32 v72, s96, v72
    v_xor_b32 v73, s97, v73
    v_xor_b32 v74, s98, v74
    v_xor_b32 v75, s99, v75
    v_or_b32 v246, v72, v73
    v_or3_b32 v246, v246, v74, v75
    s_waitcnt vmcnt(6)
    v_xor_b32 v76, s96, v76
    v_xor_b32 v77, s97, v77
    v_xor_b32 v78, s98, v78
    v_xor_b32 v79, s99, v79
    v_or_b32 v247, v76, v77
    v_or3_b32 v247, v247, v78, v79
    s_waitcnt vmcnt(5)
    v_xor_b32 v80, s96, v80
    v_xor_b32 v81, s97, v81
    v_xor_b32 v82, s98, v82
    v_xor_b32 v83, s99, v83
    v_or_b32 v248, v80, v81
    v_or3_b32 v248, v248, v82, v83
    s_waitcnt vmcnt(4)
    v_xor_b32 v84, s96, v84
    v_xor_b32 v85, s97, v85
    v_xor_b32 v86, s98, v86
    v_xor_b32 v87, s99, v87
    v_or_b32 v249, v84, v85
    v_or3_b32 v249, v249, v86, v87
    s_waitcnt vmcnt(3)
    v_xor_b32 v88, s96, v88
    v_xor_b32 v89, s97, v89
    v_xor_b32 v90, s98, v90
    v_xor_b32 v91, s99, v91
    v_or_b32 v250, v88, v89
    v_or3_b32 v250, v250, v90, v91
    s_waitcnt vmcnt(2)
    v_xor_b32 v92, s96, v92
    v_xor_b32 v93, s97, v93
    v_xor_b32 v94, s98, v94
    v_xor_b32 v95, s99, v95
    v_or_b32 v251, v92, v93
    v_or3_b32 v251, v251, v94, v95
    s_waitcnt vmcnt(1)
    v_xor_b32 v96, s96, v96
    v_xor_b32 v97, s97, v97
    v_xor_b32 v98, s98, v98
    v_xor_b32 v99, s99, v99
    v_or_b32 v252, v96, v97
    v_or3_b32 v252, v252, v98, v99
L_kv_chk:
    v_or3_b32 v14, v236, v237, v238
    v_or3_b32 v14, v14, v239, v240
    v_or3_b32 v14, v14, v241, v242
    v_or3_b32 v14, v14, v243, v244
    v_or3_b32 v14, v14, v245, v246
    v_or3_b32 v14, v14, v247, v248
    v_or3_b32 v14, v14, v249, v250
    v_or3_b32 v14, v14, v251, v252
    v_and_b32 v14, 0xff, v14
    v_cmp_ne_u32 vcc, 0, v14
    s_cbranch_vccnz L_kv_slow
L_kv_ok:
    v_add_f32_dpp v96, v96, v96 row_ror:8 row_mask:0xf bank_mask:0xf
    v_add_f32_dpp v97, v97, v97 row_ror:8 row_mask:0xf bank_mask:0xf
    v_add_f32_dpp v98, v98, v98 row_ror:8 row_mask:0xf bank_mask:0xf
    v_add_f32_dpp v99, v99, v99 row_ror:8 row_mask:0xf bank_mask:0xf
    v_add_f32 v32, v32, v64
    v_add_f32 v33, v33, v65
    v_add_f32 v34, v34, v66
    v_add_f32 v35, v35, v67
    v_add_f32 v36, v36, v68
    v_add_f32 v37, v37, v69
    v_add_f32 v38, v38, v70
    v_add_f32 v39, v39, v71
    v_add_f32 v40, v40, v72
    v_add_f32 v41, v41, v73
    v_add_f32 v42, v42, v74
    v_add_f32 v43, v43, v75
    v_add_f32 v44, v44, v76
    v_add_f32 v45, v45, v77
    v_add_f32 v46, v46, v78
    v_add_f32 v47, v47, v79
    v_add_f32 v48, v48, v80
    v_add_f32 v49, v49, v81
    v_add_f32 v50, v50, v82
    v_add_f32 v51, v51, v83
    v_add_f32 v52, v52, v84
    v_add_f32 v53, v53, v85
    v_add_f32 v54, v54, v86
    v_add_f32 v55, v55, v87
    v_add_f32 v56, v56, v88
    v_add_f32 v57, v57, v89
    v_add_f32 v58, v58, v90
    v_add_f32 v59, v59, v91
    v_add_f32 v60, v60, v92
    v_add_f32 v61, v61, v93
    v_add_f32 v62, v62, v94
    v_add_f32 v63, v63, v95
    v_add_f32_dpp v96, v96, v96 row_ror:4 row_mask:0xf bank_mask:0xf
    v_add_f32_dpp v97, v97, v97 row_ror:4 row_mask:0xf bank_mask:0xf
    v_add_f32_dpp v98, v98, v98 row_ror:4 row_mask:0xf bank_mask:0xf
    v_add_f32_dpp v99, v99, v99 row_ror:4 row_mask:0xf bank_mask:0xf
    v_add_f32 v32, v32, v48
    v_add_f32 v33, v33, v49
    v_add_f32 v34, v34, v50
    v_add_f32 v35, v35, v51
    v_add_f32 v36, v36, v52
    v_add_f32 v37, v37, v53
    v_add_f32 v38, v38, v54
    v_add_f32 v39, v39, v55
    v_add_f32 v40, v40, v56
    v_add_f32 v41, v41, v57
    v_add_f32 v42, v42, v58
    v_add_f32 v43, v43, v59
    v_add_f32 v44, v44, v60
    v_add_f32 v45, v45, v61
    v_add_f32 v46, v46, v62
    v_add_f32 v47, v47, v63
    v_add_f32_dpp v96, v96, v96 row_ror:2 row_mask:0xf bank_mask:0xf
    v_add_f32_dpp v97, v97, v97 row_ror:2 row_mask:0xf bank_mask:0xf
    v_add_f32_dpp v98, v98, v98 row_ror:2 row_mask:0xf bank_mask:0xf
    v_add_f32_dpp v99, v99, v99 row_ror:2 row_mask:0xf bank_mask:0xf
    v_add_f32 v32, v32, v40
    v_add_f32 v33, v33, v41
    v_add_f32 v34, v34, v42
    v_add_f32 v35, v35, v43
    v_add_f32 v36, v36, v44
    v_add_f32 v37, v37, v45
    v_add_f32 v38, v38, v46
    v_add_f32 v39, v39, v47
    v_add_f32_dpp v96, v96, v96 row_ror:1 row_mask:0xf bank_mask:0xf
    v_add_f32_dpp v97, v97, v97 row_ror:1 row_mask:0xf bank_mask:0xf
    v_add_f32_dpp v98, v98, v98 row_ror:1 row_mask:0xf bank_mask:0xf
    v_add_f32_dpp v99, v99, v99 row_ror:1 row_mask:0xf bank_mask:0xf
    v_add_f32 v32, v32, v36
    v_add_f32 v33, v33, v37
    v_add_f32 v34, v34, v38
    v_add_f32 v35, v35, v39
    v_cvt_pk_bf16_f32 v102, v96, v97
    v_cvt_pk_bf16_f32 v103, v98, v99
    v_cvt_pk_bf16_f32 v100, v32, v33
    v_cvt_pk_bf16_f32 v101, v34, v35
    ds_write_b64 v30, v[102:103] offset:512
    ds_write_b64 v29, v[100:101]
    v_mov_b32 v12, 6
    ds_write_b32 v11, v12
    s_mov_b32 s12, 0
L_fc25:
    s_waitcnt lgkmcnt(0)
    s_xor_b32 s8, s8, s64
    s_xor_b32 s9, s9, s64
    s_xor_b32 s10, s10, s64
    s_xor_b32 s11, s11, s64
    s_or_b32 s8, s8, s10
    s_or_b32 s9, s9, s11
    s_or_b32 s8, s8, s9
    s_cbranch_scc0 L_fk25
    s_add_u32 s12, s12, 1
    s_sleep 1
    s_load_dword s8, s[24:25], s80 offset:0 glc
    s_load_dword s9, s[24:25], s80 offset:128 glc
    s_load_dword s10, s[24:25], s80 offset:1024 glc
    s_load_dword s11, s[24:25], s80 offset:1152 glc
    s_cmp_gt_u32 s12, 20
    s_cbranch_scc0 L_fc25
    s_branch L_fv25
L_fk25:
    s_add_u32 s59, s78, 0
    buffer_load_dwordx4 v[112:115], v2, s[24:27], s59 offen offset:0 sc1
    s_add_u32 s59, s78, 12288
    buffer_load_dwordx4 v[116:119], v2, s[24:27], s59 offen offset:2048 sc1
    s_add_u32 s59, s78, 0
    buffer_load_dwordx4 v[120:123], v2, s[24:27], s59 offen offset:1024 sc1
    s_add_u32 s59, s78, 12288
    buffer_load_dwordx4 v[124:127], v2, s[24:27], s59 offen offset:3072 sc1
    s_add_u32 s59, s78, 0
    buffer_load_dwordx4 v[128:131], v2, s[24:27], s59 offen offset:2048 sc1
    s_add_u32 s59, s78, 16384
    buffer_load_dwordx4 v[132:135], v2, s[24:27], s59 offen offset:0 sc1
    s_add_u32 s59, s78, 0
    buffer_load_dwordx4 v[136:139], v2, s[24:27], s59 offen offset:3072 sc1
    s_add_u32 s59, s78, 16384
    buffer_load_dwordx4 v[140:143], v2, s[24:27], s59 offen offset:1024 sc1
    s_add_u32 s59, s78, 4096
    buffer_load_dwordx4 v[144:147], v2, s[24:27], s59 offen offset:0 sc1
    s_add_u32 s59, s78, 16384
    buffer_load_dwordx4 v[148:151], v2, s[24:27], s59 offen offset:2048 sc1
    s_add_u32 s59, s78, 4096
    buffer_load_dwordx4 v[152:155], v2, s[24:27], s59 offen offset:1024 sc1
    s_add_u32 s59, s78, 16384
    buffer_load_dwordx4 v[156:159], v2, s[24:27], s59 offen offset:3072 sc1
    s_add_u32 s59, s78, 4096
    buffer_load_dwordx4 v[160:163], v2, s[24:27], s59 offen offset:2048 sc1
    s_add_u32 s59, s78, 20480
    buffer_load_dwordx4 v[164:167], v2, s[24:27], s59 offen offset:0 sc1
    s_add_u32 s59, s78, 4096
    buffer_load_dwordx4 v[168:171], v2, s[24:27], s59 offen offset:3072 sc1
    s_add_u32 s59, s78, 20480
    buffer_load_dwordx4 v[172:175], v2, s[24:27], s59 offen offset:1024 sc1
    s_setprio 1
    ds_read_b32 v15, v10
    s_waitcnt lgkmcnt(0)
L_pc26:
    v_cmp_gt_u32 vcc, 5, v15
    s_and_b32 s60, vcc_lo, 240
    s_cbranch_scc0 L_pk26
    s_add_u32 s65, s65, 1
    s_sleep 1
    ds_read_b32 v15, v10
    s_cmp_gt_u32 s65, 1600000
    s_waitcnt lgkmcnt(0)
    s_cbranch_scc0 L_pc26
L_pk26:
    s_add_u32 m0, s55, 73728
    s_add_u32 s59, s57, 16384
    buffer_load_dwordx4 v22, s[16:19], s59 offen lds
    s_add_u32 m0, s55, 74752
    s_add_u32 s59, s57, 24576
    buffer_load_dwordx4 v22, s[16:19], s59 offen lds
    s_add_u32 m0, s55, 75776
    s_add_u32 s59, s56, 131072
    buffer_load_dwordx4 v22, s[16:19], s59 offen lds
    s_add_u32 m0, s55, 76800
    s_add_u32 s59, s56, 139264
    buffer_load_dwordx4 v22, s[16:19], s59 offen lds
    s_add_u32 m0, s55, 77824
    s_add_u32 s59, s56, 147456
    buffer_load_dwordx4 v22, s[16:19], s59 offen lds
    s_add_u32 m0, s55, 78848
    s_add_u32 s59, s56, 155648
    buffer_load_dwordx4 v22, s[16:19], s59 offen lds
    s_add_u32 m0, s55, 79872
    s_add_u32 s59, s56, 163840
    buffer_load_dwordx4 v22, s[16:19], s59 offen lds
    s_add_u32 m0, s55, 80896
    s_add_u32 s59, s56, 172032
    buffer_load_dwordx4 v22, s[16:19], s59 offen lds
    s_add_u32 m0, s55, 81920
    s_add_u32 s59, s56, 180224
    buffer_load_dwordx4 v22, s[16:19], s59 offen lds
    s_setprio 1
    s_sub_u32 s13, s82, 0xd00000
    s_lshr_b32 s13, s13, 5
    s_add_u32 s13, s13, 0xc80000
    s_lshl_b32 s14, s64, 11
    s_and_b32 s14, s14, 0xffff0000
    ds_read_b32 v15, v10
    s_waitcnt lgkmcnt(0)
L_pc27:
    v_cmp_gt_u32 vcc, 6, v15
    s_and_b32 s60, vcc_lo, 255
    s_cbranch_scc0 L_pk27
    s_add_u32 s65, s65, 1
    s_sleep 1
    ds_read_b32 v15, v10
    s_cmp_gt_u32 s65, 1600000
    s_waitcnt lgkmcnt(0)
    s_cbranch_scc0 L_pc27
L_pk27:
    ds_read_b64_tr_b16 v[80:81], v3 offset:0
    ds_read_b64_tr_b16 v[82:83], v3 offset:1024
    ds_read_b64_tr_b16 v[84:85], v4 offset:0
    ds_read_b64_tr_b16 v[86:87], v4 offset:1024
    ds_read_b64_tr_b16 v[88:89], v3 offset:9216
    ds_read_b64_tr_b16 v[90:91], v3 offset:10240
    ds_read_b64_tr_b16 v[92:93], v4 offset:9216
    ds_read_b64_tr_b16 v[94:95], v4 offset:10240
    ds_read_b64_tr_b16 v[96:97], v3 offset:2048
    ds_read_b64_tr_b16 v[98:99], v3 offset:3072
    ds_read_b64_tr_b16 v[100:101], v4 offset:2048
    ds_read_b64_tr_b16 v[102:103], v4 offset:3072
    ds_read_b64_tr_b16 v[104:105], v3 offset:11264
    ds_read_b64_tr_b16 v[106:107], v3 offset:12288
    ds_read_b64_tr_b16 v[108:109], v4 offset:11264
    ds_read_b64_tr_b16 v[110:111], v4 offset:12288
    s_xor_b32 s60, s40, 2
    s_lshl_b32 s83, 1, s60
    v_add_u32 v5, s55, v2
    s_waitcnt vmcnt(24)
    s_waitcnt lgkmcnt(12)
    v_mfma_f32_32x32x16_bf16 v[16:31], v[80:83], v[112:115], 0
    v_mfma_f32_32x32x16_bf16 v[32:47], v[84:87], v[112:115], 0
    s_waitcnt vmcnt(23)
    s_waitcnt lgkmcnt(8)
    v_mfma_f32_32x32x16_bf16 v[16:31], v[88:91], v[116:119], v[16:31]
    ds_read_b64_tr_b16 v[80:81], v3 offset:4096
    ds_read_b64_tr_b16 v[82:83], v3 offset:5120
    v_mfma_f32_32x32x16_bf16 v[32:47], v[92:95], v[116:119], v[32:47]
    ds_read_b64_tr_b16 v[84:85], v4 offset:4096
    ds_read_b64_tr_b16 v[86:87], v4 offset:5120
    s_waitcnt vmcnt(22)
    s_waitcnt lgkmcnt(8)
    v_mfma_f32_32x32x16_bf16 v[16:31], v[96:99], v[120:123], v[16:31]
    ds_read_b64_tr_b16 v[88:89], v3 offset:13312
    ds_read_b64_tr_b16 v[90:91], v3 offset:14336
    v_mfma_f32_32x32x16_bf16 v[32:47], v[100:103], v[120:123], v[32:47]
    ds_read_b64_tr_b16 v[92:93], v4 offset:13312
    ds_read_b64_tr_b16 v[94:95], v4 offset:14336
    s_waitcnt vmcnt(21)
    s_waitcnt lgkmcnt(8)
    v_mfma_f32_32x32x16_bf16 v[16:31], v[104:107], v[124:127], v[16:31]
    ds_read_b64_tr_b16 v[96:97], v3 offset:6144
    ds_read_b64_tr_b16 v[98:99], v3 offset:7168
    v_mfma_f32_32x32x16_bf16 v[32:47], v[108:111], v[124:127], v[32:47]
    ds_read_b64_tr_b16 v[100:101], v4 offset:6144
    ds_read_b64_tr_b16 v[102:103], v4 offset:7168
    s_waitcnt vmcnt(20)
    s_waitcnt lgkmcnt(8)
    v_mfma_f32_32x32x16_bf16 v[16:31], v[80:83], v[128:131], v[16:31]
    ds_read_b64_tr_b16 v[104:105], v3 offset:15360
    ds_read_b64_tr_b16 v[106:107], v3 offset:16384
    v_mfma_f32_32x32x16_bf16 v[32:47], v[84:87], v[128:131], v[32:47]
    ds_read_b64_tr_b16 v[108:109], v4 offset:15360
    ds_read_b64_tr_b16 v[110:111], v4 offset:16384
    s_waitcnt vmcnt(19)
    s_waitcnt lgkmcnt(8)
    v_mfma_f32_32x32x16_bf16 v[16:31], v[88:91], v[132:135], v[16:31]
    ds_read_b64_tr_b16 v[80:81], v3 offset:8192
    ds_read_b64_tr_b16 v[82:83], v3 offset:36864
    v_mfma_f32_32x32x16_bf16 v[32:47], v[92:95], v[132:135], v[32:47]
    ds_read_b64_tr_b16 v[84:85], v4 offset:8192
    ds_read_b64_tr_b16 v[86:87], v4 offset:36864
    s_waitcnt vmcnt(18)
    s_waitcnt lgkmcnt(8)
    v_mfma_f32_32x32x16_bf16 v[16:31], v[96:99], v[136:139], v[16:31]
    ds_read_b64_tr_b16 v[88:89], v3 offset:17408
    ds_read_b64_tr_b16 v[90:91], v3 offset:46080
    v_mfma_f32_32x32x16_bf16 v[32:47], v[100:103], v[136:139], v[32:47]
    ds_read_b64_tr_b16 v[92:93], v4 offset:17408
    ds_read_b64_tr_b16 v[94:95], v4 offset:46080
    s_waitcnt vmcnt(17)
    s_waitcnt lgkmcnt(8)
    v_mfma_f32_32x32x16_bf16 v[16:31], v[104:107], v[140:143], v[16:31]
    ds_read_b64_tr_b16 v[96:97], v3 offset:37888
    ds_read_b64_tr_b16 v[98:99], v3 offset:38912
    v_mfma_f32_32x32x16_bf16 v[32:47], v[108:111], v[140:143], v[32:47]
    ds_read_b64_tr_b16 v[100:101], v4 offset:37888
    ds_read_b64_tr_b16 v[102:103], v4 offset:38912
    s_waitcnt vmcnt(16)
    s_waitcnt lgkmcnt(8)
    v_mfma_f32_32x32x16_bf16 v[16:31], v[80:83], v[144:147], v[16:31]
    ds_read_b64_tr_b16 v[104:105], v3 offset:47104
    ds_read_b64_tr_b16 v[106:107], v3 offset:48128
    v_mfma_f32_32x32x16_bf16 v[32:47], v[84:87], v[144:147], v[32:47]
    ds_read_b64_tr_b16 v[108:109], v4 offset:47104
    ds_read_b64_tr_b16 v[110:111], v4 offset:48128
    s_waitcnt vmcnt(15)
    s_waitcnt lgkmcnt(8)
    v_mfma_f32_32x32x16_bf16 v[16:31], v[88:91], v[148:151], v[16:31]
    ds_read_b64_tr_b16 v[80:81], v3 offset:39936
    ds_read_b64_tr_b16 v[82:83], v3 offset:40960
    v_mfma_f32_32x32x16_bf16 v[32:47], v[92:95], v[148:151], v[32:47]
    ds_read_b64_tr_b16 v[84:85], v4 offset:39936
    ds_read_b64_tr_b16 v[86:87], v4 offset:40960
    s_waitcnt vmcnt(14)
    s_waitcnt lgkmcnt(8)
    v_mfma_f32_32x32x16_bf16 v[16:31], v[96:99], v[152:155], v[16:31]
    ds_read_b64_tr_b16 v[88:89], v3 offset:49152
    ds_read_b64_tr_b16 v[90:91], v3 offset:50176
    v_mfma_f32_32x32x16_bf16 v[32:47], v[100:103], v[152:155], v[32:47]
    ds_read_b64_tr_b16 v[92:93], v4 offset:49152
    ds_read_b64_tr_b16 v[94:95], v4 offset:50176
    s_load_dword s8, s[24:25], s80 offset:384 glc
    s_load_dword s9, s[24:25], s80 offset:1408 glc
    s_waitcnt vmcnt(13)
    s_waitcnt lgkmcnt(8)
    s_waitcnt vmcnt(0)
    v_mov_b32 v12, 9
    ds_write_b32 v11, v12
    v_mfma_f32_32x32x16_bf16 v[16:31], v[104:107], v[156:159], v[16:31]
    ds_read_b64_tr_b16 v[96:97], v3 offset:41984
    ds_read_b64_tr_b16 v[98:99], v3 offset:43008
    v_mfma_f32_32x32x16_bf16 v[32:47], v[108:111], v[156:159], v[32:47]
    ds_read_b64_tr_b16 v[100:101], v4 offset:41984
    ds_read_b64_tr_b16 v[102:103], v4 offset:43008
    s_mov_b32 s12, 0
L_fc28:
    s_waitcnt lgkmcnt(0)
    s_xor_b32 s8, s8, s64
    s_xor_b32 s9, s9, s64
    s_or_b32 s8, s8, s9
    s_cbranch_scc0 L_fk28
    s_add_u32 s12, s12, 1
    s_sleep 1
    s_load_dword s8, s[24:25], s80 offset:384 glc
    s_load_dword s9, s[24:25], s80 offset:1408 glc
    s_cmp_gt_u32 s12, 20
    s_cbranch_scc0 L_fc28
    s_branch L_fv28
L_fk28:
    s_add_u32 s59, s78, 8192
    buffer_load_dwordx4 v[176:179], v2, s[24:27], s59 offen offset:0 sc1
    s_add_u32 s59, s78, 20480
    buffer_load_dwordx4 v[180:183], v2, s[24:27], s59 offen offset:2048 sc1
    s_add_u32 s59, s78, 8192
    buffer_load_dwordx4 v[184:187], v2, s[24:27], s59 offen offset:1024 sc1
    s_add_u32 s59, s78, 20480
    buffer_load_dwordx4 v[188:191], v2, s[24:27], s59 offen offset:3072 sc1
    s_add_u32 s59, s78, 8192
    buffer_load_dwordx4 v[192:195], v2, s[24:27], s59 offen offset:2048 sc1
    s_add_u32 s59, s78, 24576
    buffer_load_dwordx4 v[196:199], v2, s[24:27], s59 offen offset:0 sc1
    s_add_u32 s59, s78, 8192
    buffer_load_dwordx4 v[200:203], v2, s[24:27], s59 offen offset:3072 sc1
    v_mfma_f32_32x32x16_bf16 v[16:31], v[80:83], v[160:163], v[16:31]
    ds_read_b64_tr_b16 v[104:105], v3 offset:51200
    ds_read_b64_tr_b16 v[106:107], v3 offset:52224
    s_add_u32 s59, s78, 24576
    buffer_load_dwordx4 v[204:207], v2, s[24:27], s59 offen offset:1024 sc1
    v_mfma_f32_32x32x16_bf16 v[32:47], v[84:87], v[160:163], v[32:47]
    ds_read_b64_tr_b16 v[108:109], v4 offset:51200
    ds_read_b64_tr_b16 v[110:111], v4 offset:52224
    v_mfma_f32_32x32x16_bf16 v[16:31], v[88:91], v[164:167], v[16:31]
    ds_read_b64_tr_b16 v[80:81], v3 offset:44032
    ds_read_b64_tr_b16 v[82:83], v3 offset:45056
    s_add_u32 s59, s78, 12288
    buffer_load_dwordx4 v[208:211], v2, s[24:27], s59 offen offset:0 sc1
    v_mfma_f32_32x32x16_bf16 v[32:47], v[92:95], v[164:167], v[32:47]
    ds_read_b64_tr_b16 v[84:85], v4 offset:44032
    ds_read_b64_tr_b16 v[86:87], v4 offset:45056
    ds_read_b32 v15, v10
    v_mfma_f32_32x32x16_bf16 v[16:31], v[96:99], v[168:171], v[16:31]
    ds_read_b64_tr_b16 v[88:89], v3 offset:53248
    ds_read_b64_tr_b16 v[90:91], v3 offset:54272
    s_add_u32 s59, s78, 24576
    buffer_load_dwordx4 v[212:215], v2, s[24:27], s59 offen offset:2048 sc1
    v_mfma_f32_32x32x16_bf16 v[32:47], v[100:103], v[168:171], v[32:47]
    ds_read_b64_tr_b16 v[92:93], v4 offset:53248
    ds_read_b64_tr_b16 v[94:95], v4 offset:54272
    s_waitcnt lgkmcnt(4)
L_pc29:
    v_cmp_gt_u32 vcc, 9, v15
    s_and_b32 s60, vcc_lo, 15
    s_cbranch_scc0 L_pk29
    s_add_u32 s65, s65, 1
    s_sleep 1
    ds_read_b32 v15, v10
    s_cmp_gt_u32 s65, 1600000
    s_waitcnt lgkmcnt(0)
    s_cbranch_scc0 L_pc29
L_pk29:
    v_mfma_f32_32x32x16_bf16 v[16:31], v[104:107], v[172:175], v[16:31]
    v_add_u32 v3, 73728, v3
    v_add_u32 v4, 73728, v4
    ds_read_b64_tr_b16 v[96:97], v3 offset:0
    s_add_u32 s59, s78, 12288
    buffer_load_dwordx4 v[216:219], v2, s[24:27], s59 offen offset:1024 sc1
    v_mfma_f32_32x32x16_bf16 v[32:47], v[108:111], v[172:175], v[32:47]
    ds_read_b64_tr_b16 v[98:99], v3 offset:1024
    ds_read_b64_tr_b16 v[100:101], v4 offset:0
    ds_read_b64_tr_b16 v[102:103], v4 offset:1024
    s_waitcnt vmcnt(10)
    v_mfma_f32_32x32x16_bf16 v[16:31], v[80:83], v[176:179], v[16:31]
    ds_read_b64_tr_b16 v[104:105], v3 offset:9216
    ds_read_b64_tr_b16 v[106:107], v3 offset:10240
    s_add_u32 s59, s78, 24576
    buffer_load_dwordx4 v[220:223], v2, s[24:27], s59 offen offset:3072 sc1
    v_mfma_f32_32x32x16_bf16 v[32:47], v[84:87], v[176:179], v[32:47]
    ds_read_b64_tr_b16 v[108:109], v4 offset:9216
    ds_read_b64_tr_b16 v[110:111], v4 offset:10240
    s_load_dword s8, s[24:25], s80 offset:512 glc
    s_load_dword s9, s[24:25], s80 offset:1536 glc
    s_waitcnt vmcnt(10)
    s_waitcnt lgkmcnt(8)
    v_mfma_f32_32x32x16_bf16 v[16:31], v[88:91], v[180:183], v[16:31]
    ds_read_b64_tr_b16 v[80:81], v3 offset:2048
    ds_read_b64_tr_b16 v[82:83], v3 offset:3072
    v_mfma_f32_32x32x16_bf16 v[32:47], v[92:95], v[180:183], v[32:47]
    ds_read_b64_tr_b16 v[84:85], v4 offset:2048
    ds_read_b64_tr_b16 v[86:87], v4 offset:3072
    s_mov_b32 s12, 0
L_fc30:
    s_waitcnt lgkmcnt(0)
    s_xor_b32 s8, s8, s64
    s_xor_b32 s9, s9, s64
    s_or_b32 s8, s8, s9
    s_cbranch_scc0 L_fk30
    s_add_u32 s12, s12, 1
    s_sleep 1
    s_load_dword s8, s[24:25], s80 offset:512 glc
    s_load_dword s9, s[24:25], s80 offset:1536 glc
    s_cmp_gt_u32 s12, 20
    s_cbranch_scc0 L_fc30
    s_branch L_fv30
L_fk30:
    v_and_b32 v14, 31, v1
    v_lshlrev_b32 v14, 2, v14
    buffer_load_dword v9, v14, s[24:27], s81 offen sc1
    s_add_u32 s59, s79, 0
    buffer_load_dwordx4 v[224:227], v2, s[24:27], s59 offen offset:0 sc1
    s_waitcnt vmcnt(11)
    v_mfma_f32_32x32x16_bf16 v[16:31], v[96:99], v[184:187], v[16:31]
    ds_read_b64_tr_b16 v[88:89], v3 offset:11264
    ds_read_b64_tr_b16 v[90:91], v3 offset:12288
    s_add_u32 s59, s79, 4096
    buffer_load_dwordx4 v[228:231], v2, s[24:27], s59 offen offset:0 sc1
    v_mfma_f32_32x32x16_bf16 v[32:47], v[100:103], v[184:187], v[32:47]
    ds_read_b64_tr_b16 v[92:93], v4 offset:11264
    ds_read_b64_tr_b16 v[94:95], v4 offset:12288
    s_waitcnt vmcnt(11)
    v_mfma_f32_32x32x16_bf16 v[16:31], v[104:107], v[188:191], v[16:31]
    ds_read_b64_tr_b16 v[96:97], v3 offset:4096
    ds_read_b64_tr_b16 v[98:99], v3 offset:5120
    s_add_u32 s59, s79, 0
    buffer_load_dwordx4 v[232:235], v2, s[24:27], s59 offen offset:1024 sc1
    v_mfma_f32_32x32x16_bf16 v[32:47], v[108:111], v[188:191], v[32:47]
    ds_read_b64_tr_b16 v[100:101], v4 offset:4096
    ds_read_b64_tr_b16 v[102:103], v4 offset:5120
    s_waitcnt vmcnt(11)
    v_mfma_f32_32x32x16_bf16 v[16:31], v[80:83], v[192:195], v[16:31]
    ds_read_b64_tr_b16 v[104:105], v3 offset:13312
    ds_read_b64_tr_b16 v[106:107], v3 offset:14336
    s_add_u32 s59, s79, 4096
    buffer_load_dwordx4 v[236:239], v2, s[24:27], s59 offen offset:1024 sc1
    v_mfma_f32_32x32x16_bf16 v[32:47], v[84:87], v[192:195], v[32:47]
    ds_read_b64_tr_b16 v[108:109], v4 offset:13312
    ds_read_b64_tr_b16 v[110:111], v4 offset:14336
    s_waitcnt vmcnt(11)
    s_waitcnt lgkmcnt(8)
    v_mfma_f32_32x32x16_bf16 v[16:31], v[88:91], v[196:199], v[16:31]
    ds_read_b64_tr_b16 v[80:81], v3 offset:6144
    ds_read_b64_tr_b16 v[82:83], v3 offset:7168
    s_add_u32 s59, s79, 0
    buffer_load_dwordx4 v[240:243], v2, s[24:27], s59 offen offset:2048 sc1
    v_mfma_f32_32x32x16_bf16 v[32:47], v[92:95], v[196:199], v[32:47]
    ds_read_b64_tr_b16 v[84:85], v4 offset:6144
    ds_read_b64_tr_b16 v[86:87], v4 offset:7168
    s_waitcnt vmcnt(11)
    s_waitcnt lgkmcnt(8)
    v_mfma_f32_32x32x16_bf16 v[16:31], v[96:99], v[200:203], v[16:31]
    ds_read_b64_tr_b16 v[88:89], v3 offset:15360
    ds_read_b64_tr_b16 v[90:91], v3 offset:16384
    s_add_u32 s59, s79, 4096
    buffer_load_dwordx4 v[244:247], v2, s[24:27], s59 offen offset:2048 sc1
    v_mfma_f32_32x32x16_bf16 v[32:47], v[100:103], v[200:203], v[32:47]
    ds_read_b64_tr_b16 v[92:93], v4 offset:15360
    ds_read_b64_tr_b16 v[94:95], v4 offset:16384
    s_waitcnt vmcnt(11)
    s_waitcnt lgkmcnt(8)
    v_mfma_f32_32x32x16_bf16 v[16:31], v[104:107], v[204:207], v[16:31]
    ds_read_b64_tr_b16 v[96:97], v3 offset:8192
    ds_read_b64_tr_b16 v[98:99], v3 offset:36864
    s_add_u32 s59, s79, 0
    buffer_load_dwordx4 v[248:251], v2, s[24:27], s59 offen offset:3072 sc1
    v_mfma_f32_32x32x16_bf16 v[32:47], v[108:111], v[204:207], v[32:47]
    ds_read_b64_tr_b16 v[100:101], v4 offset:8192
    ds_read_b64_tr_b16 v[102:103], v4 offset:36864
    s_waitcnt vmcnt(11)
    s_waitcnt lgkmcnt(8)
    v_mfma_f32_32x32x16_bf16 v[16:31], v[80:83], v[208:211], v[16:31]
    ds_read_b64_tr_b16 v[104:105], v3 offset:17408
    ds_read_b64_tr_b16 v[106:107], v3 offset:46080
    s_add_u32 s59, s79, 4096
    buffer_load_dwordx4 v[252:255], v2, s[24:27], s59 offen offset:3072 sc1
    v_mfma_f32_32x32x16_bf16 v[32:47], v[84:87], v[208:211], v[32:47]
    ds_read_b64_tr_b16 v[108:109], v4 offset:17408
    ds_read_b64_tr_b16 v[110:111], v4 offset:46080
    s_waitcnt vmcnt(11)
    s_waitcnt lgkmcnt(8)
    v_mfma_f32_32x32x16_bf16 v[16:31], v[88:91], v[212:215], v[16:31]
    ds_read_b64_tr_b16 v[80:81], v3 offset:37888
    ds_read_b64_tr_b16 v[82:83], v3 offset:38912
    v_mfma_f32_32x32x16_bf16 v[32:47], v[92:95], v[212:215], v[32:47]
    ds_read_b64_tr_b16 v[84:85], v4 offset:37888
    ds_read_b64_tr_b16 v[86:87], v4 offset:38912
    s_waitcnt vmcnt(10)
    s_waitcnt lgkmcnt(8)
    v_mfma_f32_32x32x16_bf16 v[16:31], v[96:99], v[216:219], v[16:31]
    ds_read_b64_tr_b16 v[88:89], v3 offset:47104
    ds_read_b64_tr_b16 v[90:91], v3 offset:48128
    v_mfma_f32_32x32x16_bf16 v[32:47], v[100:103], v[216:219], v[32:47]
    ds_read_b64_tr_b16 v[92:93], v4 offset:47104
    ds_read_b64_tr_b16 v[94:95], v4 offset:48128
    s_waitcnt vmcnt(9)
    s_waitcnt lgkmcnt(8)
    v_mfma_f32_32x32x16_bf16 v[16:31], v[104:107], v[220:223], v[16:31]
    ds_read_b64_tr_b16 v[96:97], v3 offset:39936
    ds_read_b64_tr_b16 v[98:99], v3 offset:40960
    v_mfma_f32_32x32x16_bf16 v[32:47], v[108:111], v[220:223], v[32:47]
    ds_read_b64_tr_b16 v[100:101], v4 offset:39936
    ds_read_b64_tr_b16 v[102:103], v4 offset:40960
    s_waitcnt vmcnt(7)
    s_waitcnt lgkmcnt(8)
    v_mfma_f32_32x32x16_bf16 v[48:63], v[80:83], v[224:227], 0
    ds_read_b64_tr_b16 v[104:105], v3 offset:49152
    ds_read_b64_tr_b16 v[106:107], v3 offset:50176
    v_mfma_f32_32x32x16_bf16 v[64:79], v[84:87], v[224:227], 0
    ds_read_b64_tr_b16 v[108:109], v4 offset:49152
    ds_read_b64_tr_b16 v[110:111], v4 offset:50176
    s_xor_b32 s60, s41, 2
    s_mul_i32 s60, s60, 9216
    v_add_u32 v6, s60, v2
    s_waitcnt vmcnt(6)
    s_waitcnt lgkmcnt(8)
    v_mfma_f32_32x32x16_bf16 v[48:63], v[88:91], v[228:231], v[48:63]
    ds_read_b64_tr_b16 v[80:81], v3 offset:41984
    ds_read_b64_tr_b16 v[82:83], v3 offset:43008
    v_sub_f32 v8, 1.0, v9
    v_cvt_pk_bf16_f32 v8, v8, v8
    v_mfma_f32_32x32x16_bf16 v[64:79], v[92:95], v[228:231], v[64:79]
    ds_read_b64_tr_b16 v[84:85], v4 offset:41984
    ds_read_b64_tr_b16 v[86:87], v4 offset:43008
    v_and_b32 v8, 0xffff0000, v8
    v_mul_f32 v16, v16, v8
    v_mul_f32 v17, v17, v8
    s_waitcnt vmcnt(5)
    s_waitcnt lgkmcnt(8)
    v_mfma_f32_32x32x16_bf16 v[48:63], v[96:99], v[232:235], v[48:63]
    ds_read_b64_tr_b16 v[88:89], v3 offset:51200
    ds_read_b64_tr_b16 v[90:91], v3 offset:52224
    v_mul_f32 v18, v18, v8
    v_mul_f32 v19, v19, v8
    v_mul_f32 v20, v20, v8
    v_mfma_f32_32x32x16_bf16 v[64:79], v[100:103], v[232:235], v[64:79]
    ds_read_b64_tr_b16 v[92:93], v4 offset:51200
    ds_read_b64_tr_b16 v[94:95], v4 offset:52224
    v_mul_f32 v21, v21, v8
    v_mul_f32 v22, v22, v8
    v_mul_f32 v23, v23, v8
    s_waitcnt vmcnt(4)
    s_waitcnt lgkmcnt(8)
    v_mfma_f32_32x32x16_bf16 v[48:63], v[104:107], v[236:239], v[48:63]
    ds_read_b64_tr_b16 v[96:97], v3 offset:44032
    ds_read_b64_tr_b16 v[98:99], v3 offset:45056
    v_mul_f32 v24, v24, v8
    v_mul_f32 v25, v25, v8
    v_mul_f32 v26, v26, v8
    v_mfma_f32_32x32x16_bf16 v[64:79], v[108:111], v[236:239], v[64:79]
    ds_read_b64_tr_b16 v[100:101], v4 offset:44032
    ds_read_b64_tr_b16 v[102:103], v4 offset:45056
    v_mul_f32 v27, v27, v8
    v_mul_f32 v28, v28, v8
    v_mul_f32 v29, v29, v8
    s_waitcnt vmcnt(3)
    s_waitcnt lgkmcnt(8)
    v_mfma_f32_32x32x16_bf16 v[48:63], v[80:83], v[240:243], v[48:63]
    ds_read_b64_tr_b16 v[104:105], v3 offset:53248
    ds_read_b64_tr_b16 v[106:107], v3 offset:54272
    v_mul_f32 v30, v30, v8
    v_mul_f32 v31, v31, v8
    v_mul_f32 v32, v32, v8
    v_mfma_f32_32x32x16_bf16 v[64:79], v[84:87], v[240:243], v[64:79]
    ds_read_b64_tr_b16 v[108:109], v4 offset:53248
    ds_read_b64_tr_b16 v[110:111], v4 offset:54272
    v_mul_f32 v33, v33, v8
    v_mul_f32 v34, v34, v8
    v_mul_f32 v35, v35, v8
    s_waitcnt vmcnt(2)
    s_waitcnt lgkmcnt(8)
    v_mfma_f32_32x32x16_bf16 v[48:63], v[88:91], v[244:247], v[48:63]
    v_mul_f32 v36, v36, v8
    v_mul_f32 v37, v37, v8
    v_mul_f32 v38, v38, v8
    v_mfma_f32_32x32x16_bf16 v[64:79], v[92:95], v[244:247], v[64:79]
    v_mul_f32 v39, v39, v8
    v_mul_f32 v40, v40, v8
    v_mul_f32 v41, v41, v8
    s_waitcnt vmcnt(1)
    s_waitcnt lgkmcnt(4)
    v_mfma_f32_32x32x16_bf16 v[48:63], v[96:99], v[248:251], v[48:63]
    v_mul_f32 v42, v42, v8
    v_mul_f32 v43, v43, v8
    v_mul_f32 v44, v44, v8
    v_mfma_f32_32x32x16_bf16 v[64:79], v[100:103], v[248:251], v[64:79]
    v_mul_f32 v45, v45, v8
    v_mul_f32 v46, v46, v8
    v_mul_f32 v47, v47, v8
    ds_read_b32 v15, v10
    s_waitcnt vmcnt(0)
    s_waitcnt lgkmcnt(1)
    v_mfma_f32_32x32x16_bf16 v[48:63], v[104:107], v[252:255], v[48:63]
    v_mfma_f32_32x32x16_bf16 v[64:79], v[108:111], v[252:255], v[64:79]
    s_waitcnt lgkmcnt(0)
L_pc31:
    v_cmp_gt_u32 vcc, 8, v15
    s_and_b32 s60, vcc_lo, 255
    s_cbranch_scc0 L_pk31
    s_add_u32 s65, s65, 1
    s_sleep 1
    ds_read_b32 v15, v10
    s_cmp_gt_u32 s65, 1600000
    s_waitcnt lgkmcnt(0)
    s_cbranch_scc0 L_pc31
L_pk31:
    s_nop 9
    v_fma_f32 v16, v48, v9, v16
    v_fma_f32 v17, v49, v9, v17
    v_fma_f32 v18, v50, v9, v18
    v_fma_f32 v19, v51, v9, v19
    ds_write_b128 v5, v[16:19] offset:0
    v_fma_f32 v20, v52, v9, v20
    v_fma_f32 v21, v53, v9, v21
    v_fma_f32 v22, v54, v9, v22
    v_fma_f32 v23, v55, v9, v23
    ds_write_b128 v5, v[20:23] offset:1024
    v_fma_f32 v24, v56, v9, v24
    v_fma_f32 v25, v57, v9, v25
    v_fma_f32 v26, v58, v9, v26
    v_fma_f32 v27, v59, v9, v27
    ds_write_b128 v5, v[24:27] offset:2048
    v_fma_f32 v28, v60, v9, v28
    v_fma_f32 v29, v61, v9, v29
    v_fma_f32 v30, v62, v9, v30
    v_fma_f32 v31, v63, v9, v31
    ds_write_b128 v5, v[28:31] offset:3072
    v_mov_b32 v12, 10
    ds_write_b32 v11, v12
    v_fma_f32 v32, v64, v9, v32
    v_fma_f32 v33, v65, v9, v33
    v_fma_f32 v34, v66, v9, v34
    v_fma_f32 v35, v67, v9, v35
    v_fma_f32 v36, v68, v9, v36
    v_fma_f32 v37, v69, v9, v37
    v_fma_f32 v38, v70, v9, v38
    v_fma_f32 v39, v71, v9, v39
    v_fma_f32 v40, v72, v9, v40
    v_fma_f32 v41, v73, v9, v41
    v_fma_f32 v42, v74, v9, v42
    v_fma_f32 v43, v75, v9, v43
    v_fma_f32 v44, v76, v9, v44
    v_fma_f32 v45, v77, v9, v45
    v_fma_f32 v46, v78, v9, v46
    v_fma_f32 v47, v79, v9, v47
L_cb01:
    ds_read_b32 v15, v10
    ds_read_b128 v[48:51], v6 offset:0
    ds_read_b128 v[52:55], v6 offset:1024
    ds_read_b128 v[56:59], v6 offset:2048
    ds_read_b128 v[60:63], v6 offset:3072
    s_add_u32 s65, s65, 1
    s_cmp_gt_u32 s65, 1600000
    s_cbranch_scc1 L_cbk01
    s_waitcnt lgkmcnt(4)
    v_cmp_gt_u32 vcc, 10, v15
    s_and_b32 s60, vcc_lo, s83
    s_cbranch_scc1 L_cb01
L_cbk01:
    s_waitcnt lgkmcnt(3)
    v_add_f32 v32, v32, v48
    v_add_f32 v33, v33, v49
    v_add_f32 v34, v34, v50
    v_add_f32 v35, v35, v51
    v_cvt_pk_bf16_f32 v80, v32, v33
    v_cvt_pk_bf16_f32 v81, v34, v35
    v_xor_b32 v80, s14, v80
    v_xor_b32 v81, s14, v81
    s_waitcnt lgkmcnt(2)
    v_add_f32 v36, v36, v52
    v_add_f32 v37, v37, v53
    v_add_f32 v38, v38, v54
    v_add_f32 v39, v39, v55
    v_cvt_pk_bf16_f32 v82, v36, v37
    v_cvt_pk_bf16_f32 v83, v38, v39
    v_xor_b32 v82, s14, v82
    v_xor_b32 v83, s14, v83
    buffer_store_dwordx4 v[80:83], v2, s[24:27], s82 offen offset:0 sc1
    s_waitcnt lgkmcnt(1)
    v_add_f32 v40, v40, v56
    v_add_f32 v41, v41, v57
    v_add_f32 v42, v42, v58
    v_add_f32 v43, v43, v59
    v_cvt_pk_bf16_f32 v84, v40, v41
    v_cvt_pk_bf16_f32 v85, v42, v43
    v_xor_b32 v84, s14, v84
    v_xor_b32 v85, s14, v85
    s_waitcnt lgkmcnt(0)
    v_add_f32 v44, v44, v60
    v_add_f32 v45, v45, v61
    v_add_f32 v46, v46, v62
    v_add_f32 v47, v47, v63
    v_cvt_pk_bf16_f32 v86, v44, v45
    v_cvt_pk_bf16_f32 v87, v46, v47
    v_xor_b32 v86, s14, v86
    v_xor_b32 v87, s14, v87
    buffer_store_dwordx4 v[84:87], v2, s[24:27], s82 offen offset:1024 sc1
    v_mov_b32 v12, 11
    ds_write_b32 v11, v12
    s_waitcnt lgkmcnt(0)
    s_waitcnt vmcnt(0)
    buffer_store_dword v7, off, s[24:27], s13 sc1
    s_endpgm
L_kv_slow:
    s_add_u32 s65, s65, 8
    s_cmp_gt_u32 s65, 1600000
    s_cbranch_scc1 L_kv_ok
    s_mov_b32 s85, 0
    v_and_b32 v14, 0xff, v236
    v_cmp_ne_u32 vcc, 0, v14
    s_cbranch_vccz L_ka0
    s_bitset1_b32 s85, 0
    s_add_u32 s59, s100, 0
    buffer_load_dwordx4 v[32:35], v2, s[24:27], s59 offen offset:0 sc1
L_ka0:
    v_and_b32 v14, 0xff, v237
    v_cmp_ne_u32 vcc, 0, v14
    s_cbranch_vccz L_ka1
    s_bitset1_b32 s85, 1
    s_add_u32 s59, s100, 0
    buffer_load_dwordx4 v[36:39], v2, s[24:27], s59 offen offset:1024 sc1
L_ka1:
    v_and_b32 v14, 0xff, v238
    v_cmp_ne_u32 vcc, 0, v14
    s_cbranch_vccz L_ka2
    s_bitset1_b32 s85, 2
    s_add_u32 s59, s100, 0
    buffer_load_dwordx4 v[40:43], v2, s[24:27], s59 offen offset:2048 sc1
L_ka2:
    v_and_b32 v14, 0xff, v239
    v_cmp_ne_u32 vcc, 0, v14
    s_cbranch_vccz L_ka3
    s_bitset1_b32 s85, 3
    s_add_u32 s59, s100, 0
    buffer_load_dwordx4 v[44:47], v2, s[24:27], s59 offen offset:3072 sc1
L_ka3:
    v_and_b32 v14, 0xff, v240
    v_cmp_ne_u32 vcc, 0, v14
    s_cbranch_vccz L_ka4
    s_bitset1_b32 s85, 4
    s_add_u32 s59, s100, 4096
    buffer_load_dwordx4 v[48:51], v2, s[24:27], s59 offen offset:0 sc1
L_ka4:
    v_and_b32 v14, 0xff, v241
    v_cmp_ne_u32 vcc, 0, v14
    s_cbranch_vccz L_ka5
    s_bitset1_b32 s85, 5
    s_add_u32 s59, s100, 4096
    buffer_load_dwordx4 v[52:55], v2, s[24:27], s59 offen offset:1024 sc1
L_ka5:
    v_and_b32 v14, 0xff, v242
    v_cmp_ne_u32 vcc, 0, v14
    s_cbranch_vccz L_ka6
    s_bitset1_b32 s85, 6
    s_add_u32 s59, s100, 4096
    buffer_load_dwordx4 v[56:59], v2, s[24:27], s59 offen offset:2048 sc1
L_ka6:
    v_and_b32 v14, 0xff, v243
    v_cmp_ne_u32 vcc, 0, v14
    s_cbranch_vccz L_ka7
    s_bitset1_b32 s85, 7
    s_add_u32 s59, s100, 4096
    buffer_load_dwordx4 v[60:63], v2, s[24:27], s59 offen offset:3072 sc1
L_ka7:
    v_and_b32 v14, 0xff, v244
    v_cmp_ne_u32 vcc, 0, v14
    s_cbranch_vccz L_ka8
    s_bitset1_b32 s85, 8
    s_add_u32 s59, s100, 8192
    buffer_load_dwordx4 v[64:67], v2, s[24:27], s59 offen offset:0 sc1
L_ka8:
    v_and_b32 v14, 0xff, v245
    v_cmp_ne_u32 vcc, 0, v14
    s_cbranch_vccz L_ka9
    s_bitset1_b32 s85, 9
    s_add_u32 s59, s100, 8192
    buffer_load_dwordx4 v[68:71], v2, s[24:27], s59 offen offset:1024 sc1
L_ka9:
    v_and_b32 v14, 0xff, v246
    v_cmp_ne_u32 vcc, 0, v14
    s_cbranch_vccz L_ka10
    s_bitset1_b32 s85, 10
    s_add_u32 s59, s100, 8192
    buffer_load_dwordx4 v[72:75], v2, s[24:27], s59 offen offset:2048 sc1
L_ka10:
    v_and_b32 v14, 0xff, v247
    v_cmp_ne_u32 vcc, 0, v14
    s_cbranch_vccz L_ka11
    s_bitset1_b32 s85, 11
    s_add_u32 s59, s100, 8192
    buffer_load_dwordx4 v[76:79], v2, s[24:27], s59 offen offset:3072 sc1
L_ka11:
    v_and_b32 v14, 0xff, v248
    v_cmp_ne_u32 vcc, 0, v14
    s_cbranch_vccz L_ka12
    s_bitset1_b32 s85, 12
    s_add_u32 s59, s100, 12288
    buffer_load_dwordx4 v[80:83], v2, s[24:27], s59 offen offset:0 sc1
L_ka12:
    v_and_b32 v14, 0xff, v249
    v_cmp_ne_u32 vcc, 0, v14
    s_cbranch_vccz L_ka13
    s_bitset1_b32 s85, 13
    s_add_u32 s59, s100, 12288
    buffer_load_dwordx4 v[84:87], v2, s[24:27], s59 offen offset:1024 sc1
L_ka13:
    v_and_b32 v14, 0xff, v250
    v_cmp_ne_u32 vcc, 0, v14
    s_cbranch_vccz L_ka14
    s_bitset1_b32 s85, 14
    s_add_u32 s59, s100, 12288
    buffer_load_dwordx4 v[88:91], v2, s[24:27], s59 offen offset:2048 sc1
L_ka14:
    v_and_b32 v14, 0xff, v251
    v_cmp_ne_u32 vcc, 0, v14
    s_cbranch_vccz L_ka15
    s_bitset1_b32 s85, 15
    s_add_u32 s59, s100, 12288
    buffer_load_dwordx4 v[92:95], v2, s[24:27], s59 offen offset:3072 sc1
L_ka15:
    v_and_b32 v14, 0xff, v252
    v_cmp_ne_u32 vcc, 0, v14
    s_cbranch_vccz L_ka16
    s_bitset1_b32 s85, 16
    buffer_load_dwordx4 v[96:99], v28, s[24:27], s101 offen sc1
L_ka16:
    s_waitcnt vmcnt(0)
    s_bitcmp1_b32 s85, 0
    s_cbranch_scc0 L_kb0
    v_xor_b32 v32, s96, v32
    v_xor_b32 v33, s97, v33
    v_xor_b32 v34, s98, v34
    v_xor_b32 v35, s99, v35
    v_or_b32 v236, v32, v33
    v_or3_b32 v236, v236, v34, v35
L_kb0:
    s_bitcmp1_b32 s85, 1
    s_cbranch_scc0 L_kb1
    v_xor_b32 v36, s96, v36
    v_xor_b32 v37, s97, v37
    v_xor_b32 v38, s98, v38
    v_xor_b32 v39, s99, v39
    v_or_b32 v237, v36, v37
    v_or3_b32 v237, v237, v38, v39
L_kb1:
    s_bitcmp1_b32 s85, 2
    s_cbranch_scc0 L_kb2
    v_xor_b32 v40, s96, v40
    v_xor_b32 v41, s97, v41
    v_xor_b32 v42, s98, v42
    v_xor_b32 v43, s99, v43
    v_or_b32 v238, v40, v41
    v_or3_b32 v238, v238, v42, v43
L_kb2:
    s_bitcmp1_b32 s85, 3
    s_cbranch_scc0 L_kb3
    v_xor_b32 v44, s96, v44
    v_xor_b32 v45, s97, v45
    v_xor_b32 v46, s98, v46
    v_xor_b32 v47, s99, v47
    v_or_b32 v239, v44, v45
    v_or3_b32 v239, v239, v46, v47
L_kb3:
    s_bitcmp1_b32 s85, 4
    s_cbranch_scc0 L_kb4
    v_xor_b32 v48, s96, v48
    v_xor_b32 v49, s97, v49
    v_xor_b32 v50, s98, v50
    v_xor_b32 v51, s99, v51
    v_or_b32 v240, v48, v49
    v_or3_b32 v240, v240, v50, v51
L_kb4:
    s_bitcmp1_b32 s85, 5
    s_cbranch_scc0 L_kb5
    v_xor_b32 v52, s96, v52
    v_xor_b32 v53, s97, v53
    v_xor_b32 v54, s98, v54
    v_xor_b32 v55, s99, v55
    v_or_b32 v241, v52, v53
    v_or3_b32 v241, v241, v54, v55
L_kb5:
    s_bitcmp1_b32 s85, 6
    s_cbranch_scc0 L_kb6
    v_xor_b32 v56, s96, v56
    v_xor_b32 v57, s97, v57
    v_xor_b32 v58, s98, v58
    v_xor_b32 v59, s99, v59
    v_or_b32 v242, v56, v57
    v_or3_b32 v242, v242, v58, v59
L_kb6:
    s_bitcmp1_b32 s85, 7
    s_cbranch_scc0 L_kb7
    v_xor_b32 v60, s96, v60
    v_xor_b32 v61, s97, v61
    v_xor_b32 v62, s98, v62
    v_xor_b32 v63, s99, v63
    v_or_b32 v243, v60, v61
    v_or3_b32 v243, v243, v62, v63
L_kb7:
    s_bitcmp1_b32 s85, 8
    s_cbranch_scc0 L_kb8
    v_xor_b32 v64, s96, v64
    v_xor_b32 v65, s97, v65
    v_xor_b32 v66, s98, v66
    v_xor_b32 v67, s99, v67
    v_or_b32 v244, v64, v65
    v_or3_b32 v244, v244, v66, v67
L_kb8:
    s_bitcmp1_b32 s85, 9
    s_cbranch_scc0 L_kb9
    v_xor_b32 v68, s96, v68
    v_xor_b32 v69, s97, v69
    v_xor_b32 v70, s98, v70
    v_xor_b32 v71, s99, v71
    v_or_b32 v245, v68, v69
    v_or3_b32 v245, v245, v70, v71
L_kb9:
    s_bitcmp1_b32 s85, 10
    s_cbranch_scc0 L_kb10
    v_xor_b32 v72, s96, v72
    v_xor_b32 v73, s97, v73
    v_xor_b32 v74, s98, v74
    v_xor_b32 v75, s99, v75
    v_or_b32 v246, v72, v73
    v_or3_b32 v246, v246, v74, v75
L_kb10:
    s_bitcmp1_b32 s85, 11
    s_cbranch_scc0 L_kb11
    v_xor_b32 v76, s96, v76
    v_xor_b32 v77, s97, v77
    v_xor_b32 v78, s98, v78
    v_xor_b32 v79, s99, v79
    v_or_b32 v247, v76, v77
    v_or3_b32 v247, v247, v78, v79
L_kb11:
    s_bitcmp1_b32 s85, 12
    s_cbranch_scc0 L_kb12
    v_xor_b32 v80, s96, v80
    v_xor_b32 v81, s97, v81
    v_xor_b32 v82, s98, v82
    v_xor_b32 v83, s99, v83
    v_or_b32 v248, v80, v81
    v_or3_b32 v248, v248, v82, v83
L_kb12:
    s_bitcmp1_b32 s85, 13
    s_cbranch_scc0 L_kb13
    v_xor_b32 v84, s96, v84
    v_xor_b32 v85, s97, v85
    v_xor_b32 v86, s98, v86
    v_xor_b32 v87, s99, v87
    v_or_b32 v249, v84, v85
    v_or3_b32 v249, v249, v86, v87
L_kb13:
    s_bitcmp1_b32 s85, 14
    s_cbranch_scc0 L_kb14
    v_xor_b32 v88, s96, v88
    v_xor_b32 v89, s97, v89
    v_xor_b32 v90, s98, v90
    v_xor_b32 v91, s99, v91
    v_or_b32 v250, v88, v89
    v_or3_b32 v250, v250, v90, v91
L_kb14:
    s_bitcmp1_b32 s85, 15
    s_cbranch_scc0 L_kb15
    v_xor_b32 v92, s96, v92
    v_xor_b32 v93, s97, v93
    v_xor_b32 v94, s98, v94
    v_xor_b32 v95, s99, v95
    v_or_b32 v251, v92, v93
    v_or3_b32 v251, v251, v94, v95
L_kb15:
    s_bitcmp1_b32 s85, 16
    s_cbranch_scc0 L_kb16
    v_xor_b32 v96, s96, v96
    v_xor_b32 v97, s97, v97
    v_xor_b32 v98, s98, v98
    v_xor_b32 v99, s99, v99
    v_or_b32 v252, v96, v97
    v_or3_b32 v252, v252, v98, v99
L_kb16:
    s_branch L_kv_chk
L_fv25:
    s_waitcnt lgkmcnt(0)
    s_add_u32 s65, s65, 8
    s_cmp_gt_u32 s65, 1600000
    s_cbranch_scc1 L_fk25
    buffer_load_dword v8, v5, s[24:27], s80 offen sc1
    s_waitcnt vmcnt(0)
    v_cmp_ne_u32 vcc, s64, v8
    s_cbranch_vccz L_fk25
    s_sleep 1
    s_branch L_fv25
L_fv28:
    s_waitcnt lgkmcnt(0)
    s_add_u32 s65, s65, 8
    s_cmp_gt_u32 s65, 1600000
    s_cbranch_scc1 L_fk28
    buffer_load_dword v8, v6, s[24:27], s80 offen offset:384 sc1
    s_waitcnt vmcnt(0)
    v_cmp_ne_u32 vcc, s64, v8
    s_cbranch_vccz L_fk28
    s_sleep 1
    s_branch L_fv28
L_fv30:
    s_waitcnt lgkmcnt(0)
    s_add_u32 s65, s65, 8
    s_cmp_gt_u32 s65, 1600000
    s_cbranch_scc1 L_fk30
    buffer_load_dword v8, v6, s[24:27], s80 offen offset:512 sc1
    s_waitcnt vmcnt(0)
    v_cmp_ne_u32 vcc, s64, v8
    s_cbranch_vccz L_fk30
    s_sleep 1
    s_branch L_fv30
L_end:
    s_endpgm
.section .rodata,"a"
.p2align 6
.amdhsa_kernel gated_mix__linear_attn_block__dense_activation_mish__prompt_kernel
  .amdhsa_next_free_vgpr 256
  .amdhsa_next_free_sgpr 102
  .amdhsa_accum_offset 256
  .amdhsa_group_segment_fixed_size 0
  .amdhsa_kernarg_size 88
  .amdhsa_user_sgpr_count 2
  .amdhsa_user_sgpr_kernarg_segment_ptr 1
  .amdhsa_system_sgpr_workgroup_id_x 1
.end_amdhsa_kernel
```
